```python
import torch

def _softmax(x, axis=-1):
    return torch.softmax(x, dim=axis)

def _gelu(x):
    return torch.nn.functional.gelu(x, approximate='tanh')

def _silu(x):
    return torch.nn.functional.silu(x)

def _sigmoid(x):
    return torch.sigmoid(x)

def _layernorm(x, axis=-1, eps=1e-05):
    m = x.mean(dim=axis, keepdim=True)
    v = x.var(dim=axis, keepdim=True, unbiased=False)
    return (x - m) / torch.sqrt(v + eps)

def _scatter_add(tgt, idx, src, axis=0):
    return tgt.clone().index_add_(axis, idx, src)

def _segment_sum(src, seg, n):
    out = torch.zeros((n,) + src.shape[1:], dtype=src.dtype)
    return out.index_add_(0, seg, src)

def _pad(x, pw):
    flat = tuple((v for pair in reversed(pw) for v in pair))
    return torch.nn.functional.pad(x, flat)
kernel_name = 'concat_heads__memory_aug_recurrent_mem_tr__ssm_conv_s5__prompt'

def setup_inputs():

    _w = lambda a: (lambda t: t.to(torch.bfloat16) if t.is_floating_point() else t)(torch.as_tensor(a))

    def _A_setup():
        B, S, Dm = (1, 2048, 640)
        H, Dh = (32, 192)
        M, seg = (8, 32)
        seg = min(seg, S)
        S = S // seg * seg
        return {'x': _w((lambda *s: torch.randn(*s, dtype=torch.bfloat16) * 0.05)(B, S, Dm)), 'mem0': _w((lambda *s: torch.randn(*s, dtype=torch.bfloat16) * 0.8)(B, M, Dm)), 'Wq': _w((lambda *s: torch.randn(*s, dtype=torch.bfloat16) * 1.6)(Dm, H, Dh) * Dm ** (-0.5)), 'Wk': _w((lambda *s: torch.randn(*s, dtype=torch.bfloat16) * 1.6)(Dm, H, Dh) * Dm ** (-0.5)), 'Wv': _w((lambda *s: torch.randn(*s, dtype=torch.bfloat16) * 0.8)(Dm, H, Dh) * Dm ** (-0.5)), 'Wo': _w((lambda *s: torch.randn(*s, dtype=torch.bfloat16) * 0.8)(H, Dh, Dm) * (H * Dh) ** (-0.5)), 'seg_len': seg}
    _A_in = _A_setup()

    def _B_setup():
        B, S, D = (1, 2048, 640)
        P = D
        Lambda_re = -0.5 * (lambda _x: torch.exp(torch.as_tensor(_x)))((lambda *s: torch.randn(*s, dtype=torch.bfloat16) * 0.8)(P))
        Lambda_im = (lambda *s: torch.randn(*s, dtype=torch.bfloat16) * 0.8)(P) * 1.0
        B_re = (lambda *s: torch.randn(*s, dtype=torch.bfloat16) * 0.8)(P, D) * D ** (-0.5)
        B_im = (lambda *s: torch.randn(*s, dtype=torch.bfloat16) * 0.8)(P, D) * D ** (-0.5)
        C_re = (lambda *s: torch.randn(*s, dtype=torch.bfloat16) * 0.8)(D, P) * P ** (-0.5)
        C_im = (lambda *s: torch.randn(*s, dtype=torch.bfloat16) * 0.8)(D, P) * P ** (-0.5)
        log_dt = (lambda *s: torch.randn(*s, dtype=torch.bfloat16) * 0.8)(P) * 0.3 - 2.0
        Dskip = (lambda *s: torch.randn(*s, dtype=torch.bfloat16) * 0.8)(D)
        return {'x': _w((lambda *s: torch.randn(*s, dtype=torch.bfloat16) * 0.05)(B, S, D)), 'Lambda_re': _w(Lambda_re), 'Lambda_im': _w(Lambda_im), 'B_re': _w(B_re), 'B_im': _w(B_im), 'C_re': _w(C_re), 'C_im': _w(C_im), 'log_dt': _w(log_dt), 'Dskip': _w(Dskip)}
    _B_in = _B_setup()
    return {'A_x': _A_in['x'], 'A_mem0': _A_in['mem0'], 'A_Wq': _A_in['Wq'], 'A_Wk': _A_in['Wk'], 'A_Wv': _A_in['Wv'], 'A_Wo': _A_in['Wo'], 'A_seg_len': _A_in['seg_len'], 'B_x': _B_in['x'], 'B_Lambda_re': _B_in['Lambda_re'], 'B_Lambda_im': _B_in['Lambda_im'], 'B_B_re': _B_in['B_re'], 'B_B_im': _B_in['B_im'], 'B_C_re': _B_in['C_re'], 'B_C_im': _B_in['C_im'], 'B_log_dt': _B_in['log_dt'], 'B_Dskip': _B_in['Dskip']}

def reference(A_x, A_mem0, A_Wq, A_Wk, A_Wv, A_Wo, A_seg_len, B_x, B_Lambda_re, B_Lambda_im, B_B_re, B_B_im, B_C_re, B_C_im, B_log_dt, B_Dskip):

    def _A_ref(x, mem0, Wq, Wk, Wv, Wo, seg_len):
        B, S, Dm = x.shape
        H, Dh = (Wq.shape[1], Wq.shape[2])
        M = mem0.shape[1]
        scale = Dh ** (-0.5)
        n_seg = S // seg_len
        L = M + seg_len
        idx = torch.arange(L)
        mask = (idx[:, None] < M) | (idx[:, None] >= idx[None, :])
        mem = mem0
        outs = []
        for s in range(n_seg):
            xs = x[:, s * seg_len:(s + 1) * seg_len, :].clone()
            h = torch.concatenate([mem, xs], axis=1)
            q = torch.einsum('btd,dhe->bhte', h, Wq)
            k = torch.einsum('btd,dhe->bhte', h, Wk)
            v = torch.einsum('btd,dhe->bhte', h, Wv)
            scores = torch.einsum('bhqe,bhke->bhqk', q, k) * scale
            scores = torch.where(mask[None, None], scores, -1000000000.0)
            p = _softmax(scores, axis=-1)
            o = torch.einsum('bhqk,bhke->bhqe', p, v)
            o = torch.einsum('bhte,hed->btd', o, Wo)
            mem = o[:, :M, :].clone()
            outs.append(o[:, M:, :])
        return torch.concatenate(outs, axis=1)

    def _B_ref(x, Lambda_re, Lambda_im, B_re, B_im, C_re, C_im, log_dt, Dskip):
        Bsz, L, H = x.shape
        Lam = Lambda_re + 1j * Lambda_im
        Bmat = B_re + 1j * B_im
        Cmat = C_re + 1j * C_im
        dt = torch.exp(log_dt)
        Lam_bar = torch.exp(dt * Lam)
        B_bar = ((Lam_bar - 1.0) / Lam)[:, None] * Bmat
        Bu = torch.einsum('bld,pd->blp', x + 0j, B_bar)
        h = torch.zeros_like(Bu[:, 0, :])
        hs = []
        for t in range(L):
            h = Lam_bar[None, :] * h + Bu[:, t, :]
            hs.append(h)
        hseq = torch.stack(hs, 1)
        y = 2.0 * torch.einsum('blp,dp->bld', hseq, Cmat).real + x * Dskip[None, None, :]
        return y
    a = _A_ref(A_x, A_mem0, A_Wq, A_Wk, A_Wv, A_Wo, A_seg_len)
    b = _B_ref(B_x, B_Lambda_re, B_Lambda_im, B_B_re, B_B_im, B_C_re, B_C_im, B_log_dt, B_Dskip)
    return torch.concatenate([a, b], axis=-1)
```

```asm
; @launch grid=(256,1,1) block=(256,1,1) lds=163840
.amdgcn_target "amdgcn-amd-amdhsa--gfx950"
.text
.globl concat_heads__memory_aug_recurrent_mem_tr__ssm_conv_s5__prompt_kernel
.p2align 8
.type concat_heads__memory_aug_recurrent_mem_tr__ssm_conv_s5__prompt_kernel,@function
concat_heads__memory_aug_recurrent_mem_tr__ssm_conv_s5__prompt_kernel:
    s_cmp_ge_u32 s2, 256
    s_cbranch_scc1 L_exit
    s_load_dwordx16 s[36:51], s[0:1], 0
    s_load_dwordx16 s[52:67], s[0:1], 64
    s_load_dwordx4 s[68:71], s[0:1], 128
    s_load_dwordx2 s[72:73], s[0:1], 144
    s_getreg_b32 s26, hwreg(HW_REG_XCC_ID)
    s_and_b32 s26, s26, 7
    v_and_b32 v1, 63, v0
    v_lshrrev_b32 v3, 6, v0
    v_lshlrev_b32 v2, 4, v1
    v_readfirstlane_b32 s24, v3
    s_mov_b32 s27, 400000
    s_waitcnt lgkmcnt(0)
    s_mov_b32 s4, s72
    s_mov_b32 s5, s73
    s_mov_b32 s6, 268435456
    s_mov_b32 s7, 0x20000
    s_mov_b32 s8, s70
    s_mov_b32 s9, s71
    s_mov_b32 s10, 256
    s_mov_b32 s11, 0x20000
    s_and_b32 s28, s26, 3
    s_lshl_b32 s28, s28, 2
    s_lshr_b32 s29, s26, 2
    s_lshl_b32 s29, s29, 7
    s_add_u32 s28, s28, s29
    v_mov_b32 v4, s28
    v_mov_b32 v5, 1
    v_mov_b32 v3, 0
    s_cmp_eq_u32 s24, 0
    s_cbranch_scc1 L_nocpf
    s_getpc_b64 s[32:33]
L_pc:
    v_add_u32 v6, -64, v0
    v_lshlrev_b32 v6, 4, v6
    v_min_u32 v7, L_code_end-L_pc-16, v6
    global_load_dwordx4 v[128:131], v7, s[32:33]
    v_add_u32 v6, 3072, v6
    v_min_u32 v7, L_code_end-L_pc-16, v6
    global_load_dwordx4 v[132:135], v7, s[32:33]
    v_add_u32 v6, 3072, v6
    v_min_u32 v7, L_code_end-L_pc-16, v6
    global_load_dwordx4 v[136:139], v7, s[32:33]
    v_add_u32 v6, 3072, v6
    v_min_u32 v7, L_code_end-L_pc-16, v6
    global_load_dwordx4 v[140:143], v7, s[32:33]
    v_add_u32 v6, 3072, v6
    v_min_u32 v7, L_code_end-L_pc-16, v6
    global_load_dwordx4 v[144:147], v7, s[32:33]
    v_add_u32 v6, 3072, v6
    v_min_u32 v7, L_code_end-L_pc-16, v6
    global_load_dwordx4 v[148:151], v7, s[32:33]
    v_add_u32 v6, 3072, v6
    v_min_u32 v7, L_code_end-L_pc-16, v6
    global_load_dwordx4 v[152:155], v7, s[32:33]
    v_add_u32 v6, 3072, v6
    v_min_u32 v7, L_code_end-L_pc-16, v6
    global_load_dwordx4 v[156:159], v7, s[32:33]
    v_add_u32 v6, 3072, v6
    v_min_u32 v7, L_code_end-L_pc-16, v6
    global_load_dwordx4 v[160:163], v7, s[32:33]
    v_add_u32 v6, 3072, v6
    v_min_u32 v7, L_code_end-L_pc-16, v6
    global_load_dwordx4 v[164:167], v7, s[32:33]
    v_add_u32 v6, 3072, v6
    v_min_u32 v7, L_code_end-L_pc-16, v6
    global_load_dwordx4 v[168:171], v7, s[32:33]
    v_add_u32 v6, 3072, v6
    v_min_u32 v7, L_code_end-L_pc-16, v6
    global_load_dwordx4 v[172:175], v7, s[32:33]
    v_add_u32 v6, 3072, v6
    v_min_u32 v7, L_code_end-L_pc-16, v6
    global_load_dwordx4 v[176:179], v7, s[32:33]
    v_add_u32 v6, 3072, v6
    v_min_u32 v7, L_code_end-L_pc-16, v6
    global_load_dwordx4 v[180:183], v7, s[32:33]
    v_add_u32 v6, 3072, v6
    v_min_u32 v7, L_code_end-L_pc-16, v6
    global_load_dwordx4 v[184:187], v7, s[32:33]
    v_add_u32 v6, 3072, v6
    v_min_u32 v7, L_code_end-L_pc-16, v6
    global_load_dwordx4 v[188:191], v7, s[32:33]
    v_add_u32 v6, 3072, v6
    v_min_u32 v7, L_code_end-L_pc-16, v6
    global_load_dwordx4 v[128:131], v7, s[32:33]
    v_add_u32 v6, 3072, v6
    v_min_u32 v7, L_code_end-L_pc-16, v6
    global_load_dwordx4 v[132:135], v7, s[32:33]
    v_add_u32 v6, 3072, v6
    v_min_u32 v7, L_code_end-L_pc-16, v6
    global_load_dwordx4 v[136:139], v7, s[32:33]
    v_add_u32 v6, 3072, v6
L_nocpf:
    v_cmp_eq_u32 vcc, 0, v0
    s_and_saveexec_b64 s[28:29], vcc
    s_cbranch_execz L_notick
    buffer_atomic_add v5, v4, s[8:11], 0 offen sc0
    s_waitcnt vmcnt(0)
    ds_write_b32 v3, v5
    s_waitcnt lgkmcnt(0)
L_notick:
    s_mov_b64 exec, s[28:29]
    s_barrier
    ds_read_b32 v5, v3
    s_waitcnt lgkmcnt(0)
    v_readfirstlane_b32 s25, v5
    s_barrier
    s_cmp_ge_u32 s25, 32
    s_cbranch_scc1 L_exit
    s_cmp_lt_u32 s26, 4
    s_cbranch_scc1 L_chainside
    s_sub_u32 s26, s26, 4
    s_cmp_lt_u32 s25, 18
    s_cbranch_scc1 L_proj
    s_cmp_lt_u32 s25, 26
    s_cbranch_scc1 L_pu
    s_cmp_lt_u32 s25, 31
    s_cbranch_scc1 L_ssm
    s_branch L_spare
L_chainside:
    s_cmp_lt_u32 s25, 8
    s_cbranch_scc1 L_qk
    s_cmp_lt_u32 s25, 16
    s_cbranch_scc1 L_vo
    s_sub_u32 s29, s25, 16
    s_lshl_b32 s29, s29, 2
    s_add_u32 s29, s29, s26
    v_mov_b32 v8, -1
    v_mov_b32 v9, -1
    v_mov_b32 v10, -1
    v_mov_b32 v11, -1
    v_lshlrev_b32 v4, 4, v0
    s_lshl_b32 s28, s29, 16
    s_add_u32 s28, s28, 192937984
    buffer_store_dwordx4 v[8:11], v4, s[4:7], s28 offen sc1
    s_add_u32 s28, s28, 4096
    buffer_store_dwordx4 v[8:11], v4, s[4:7], s28 offen sc1
    s_add_u32 s28, s28, 4096
    buffer_store_dwordx4 v[8:11], v4, s[4:7], s28 offen sc1
    s_add_u32 s28, s28, 4096
    buffer_store_dwordx4 v[8:11], v4, s[4:7], s28 offen sc1
    s_add_u32 s28, s28, 4096
    buffer_store_dwordx4 v[8:11], v4, s[4:7], s28 offen sc1
    s_add_u32 s28, s28, 4096
    buffer_store_dwordx4 v[8:11], v4, s[4:7], s28 offen sc1
    s_add_u32 s28, s28, 4096
    buffer_store_dwordx4 v[8:11], v4, s[4:7], s28 offen sc1
    s_add_u32 s28, s28, 4096
    buffer_store_dwordx4 v[8:11], v4, s[4:7], s28 offen sc1
    s_add_u32 s28, s28, 4096
    buffer_store_dwordx4 v[8:11], v4, s[4:7], s28 offen sc1
    s_add_u32 s28, s28, 4096
    buffer_store_dwordx4 v[8:11], v4, s[4:7], s28 offen sc1
    s_add_u32 s28, s28, 4096
    buffer_store_dwordx4 v[8:11], v4, s[4:7], s28 offen sc1
    s_add_u32 s28, s28, 4096
    buffer_store_dwordx4 v[8:11], v4, s[4:7], s28 offen sc1
    s_add_u32 s28, s28, 4096
    buffer_store_dwordx4 v[8:11], v4, s[4:7], s28 offen sc1
    s_add_u32 s28, s28, 4096
    buffer_store_dwordx4 v[8:11], v4, s[4:7], s28 offen sc1
    s_add_u32 s28, s28, 4096
    buffer_store_dwordx4 v[8:11], v4, s[4:7], s28 offen sc1
    s_add_u32 s28, s28, 4096
    buffer_store_dwordx4 v[8:11], v4, s[4:7], s28 offen sc1
    s_add_u32 s28, s28, 4096
    s_lshl_b32 s28, s29, 9
    s_add_u32 s28, s28, 192413696
    v_mov_b32 v5, 0
    v_and_b32 v4, 127, v0
    v_lshlrev_b32 v4, 2, v4
    buffer_store_dword v5, v4, s[4:7], s28 offen sc1
    s_waitcnt vmcnt(0)
    s_barrier
    s_cmp_eq_u32 s24, 0
    s_cbranch_scc0 L_armed
    v_mov_b32 v4, 16
    v_mov_b32 v5, 1
    s_mov_b64 exec, 1
    buffer_atomic_add v5, v4, s[8:11], 0 offen
    s_mov_b64 exec, -1
L_armed:
    s_cmp_lt_u32 s25, 26
    s_cbranch_scc1 L_red
    s_sub_u32 s75, s25, 26
    s_lshl_b32 s75, s75, 2
    s_add_u32 s75, s75, s26
    v_and_b32 v4, 3, v1
    v_lshlrev_b32 v4, 2, v4
    v_bfe_u32 v5, v1, 2, 1
    v_lshl_add_u32 v4, v5, 7, v4
    v_cmp_lt_u32 vcc, 7, v1
    v_mov_b32 v5, 16
    s_nop 0
    v_cndmask_b32 v4, v4, v5, vcc
L_warm_go_s:
    buffer_load_dword v5, v4, s[8:11], 0 offen sc1
    s_waitcnt vmcnt(0)
    v_cmp_gt_u32 vcc, 32, v5
    v_readlane_b32 s28, v5, 8
    s_cbranch_vccnz L_warm_go_s_no
    s_cmp_ge_u32 s28, 64
    s_cbranch_scc1 L_warm_go_s_ok
L_warm_go_s_no:
    s_sleep 4
    s_sub_u32 s27, s27, 1
    s_cbranch_scc1 L_fail
    s_branch L_warm_go_s
L_warm_go_s_ok:
    s_and_b32 s28, s26, 3
    s_mul_i32 s28, s28, 768
    s_add_u32 s28, s28, 192413700
    v_mov_b32 v4, s28
L_warm_go:
    buffer_load_dword v5, v4, s[4:7], 0 offen sc1
    s_waitcnt vmcnt(0)
    v_cmp_eq_u32 vcc, 0, v5
    s_cbranch_vccz L_warm_go_ok
    s_sleep 8
    s_sub_u32 s27, s27, 1
    s_cbranch_scc1 L_fail
    s_branch L_warm_go
L_warm_go_ok:
    s_mov_b32 s12, s36
    s_mov_b32 s13, s37
    s_mov_b32 s14, 2621440
    s_mov_b32 s15, 0x20000
    s_mov_b32 s16, s50
    s_mov_b32 s17, s51
    s_mov_b32 s18, 2621440
    s_mov_b32 s19, 0x20000
    s_add_u32 s29, s75, 2
    v_lshlrev_b32 v4, 4, v0
L_warm:
    s_mul_i32 s28, s29, 40960
    buffer_load_dwordx4 v[16:19], v4, s[12:15], s28 offen
    buffer_load_dwordx4 v[20:23], v4, s[16:19], s28 offen
    s_add_u32 s28, s28, 4096
    buffer_load_dwordx4 v[24:27], v4, s[12:15], s28 offen
    buffer_load_dwordx4 v[28:31], v4, s[16:19], s28 offen
    s_add_u32 s28, s28, 4096
    buffer_load_dwordx4 v[32:35], v4, s[12:15], s28 offen
    buffer_load_dwordx4 v[36:39], v4, s[16:19], s28 offen
    s_add_u32 s28, s28, 4096
    buffer_load_dwordx4 v[40:43], v4, s[12:15], s28 offen
    buffer_load_dwordx4 v[44:47], v4, s[16:19], s28 offen
    s_add_u32 s28, s28, 4096
    buffer_load_dwordx4 v[48:51], v4, s[12:15], s28 offen
    buffer_load_dwordx4 v[52:55], v4, s[16:19], s28 offen
    s_add_u32 s28, s28, 4096
    buffer_load_dwordx4 v[56:59], v4, s[12:15], s28 offen
    buffer_load_dwordx4 v[60:63], v4, s[16:19], s28 offen
    s_add_u32 s28, s28, 4096
    buffer_load_dwordx4 v[64:67], v4, s[12:15], s28 offen
    buffer_load_dwordx4 v[68:71], v4, s[16:19], s28 offen
    s_add_u32 s28, s28, 4096
    buffer_load_dwordx4 v[72:75], v4, s[12:15], s28 offen
    buffer_load_dwordx4 v[76:79], v4, s[16:19], s28 offen
    s_add_u32 s28, s28, 4096
    buffer_load_dwordx4 v[80:83], v4, s[12:15], s28 offen
    buffer_load_dwordx4 v[84:87], v4, s[16:19], s28 offen
    s_add_u32 s28, s28, 4096
    buffer_load_dwordx4 v[88:91], v4, s[12:15], s28 offen
    buffer_load_dwordx4 v[92:95], v4, s[16:19], s28 offen
    s_add_u32 s28, s28, 4096
    s_add_u32 s29, s29, 24
    s_cmp_lt_u32 s29, 64
    s_cbranch_scc1 L_warm
    s_waitcnt vmcnt(0)
L_spare:
    v_and_b32 v4, 3, v1
    v_lshlrev_b32 v4, 2, v4
    v_bfe_u32 v5, v1, 2, 1
    v_lshl_add_u32 v4, v5, 7, v4
    v_cmp_lt_u32 vcc, 7, v1
    v_mov_b32 v5, 16
    s_nop 0
    v_cndmask_b32 v4, v4, v5, vcc
L_spare_w:
    buffer_load_dword v5, v4, s[8:11], 0 offen sc1
    s_waitcnt vmcnt(0)
    v_cmp_gt_u32 vcc, 32, v5
    v_readlane_b32 s28, v5, 8
    s_cbranch_vccnz L_spare_w_no
    s_cmp_ge_u32 s28, 64
    s_cbranch_scc1 L_spare_w_ok
L_spare_w_no:
    s_sleep 4
    s_sub_u32 s27, s27, 1
    s_cbranch_scc1 L_fail
    s_branch L_spare_w
L_spare_w_ok:
    s_endpgm
L_proj:
    s_mul_i32 s75, s26, 6
    s_add_u32 s75, s75, s25
    s_mov_b32 s74, 50331648
    s_add_u32 s83, s75, 48
    s_mov_b32 s12, s44
    s_mov_b32 s13, s45
    s_cmp_lt_u32 s25, 6
    s_cbranch_scc1 L_proj_m
    s_mov_b32 s74, 25165824
    s_sub_u32 s75, s75, 6
    s_add_u32 s83, s75, 24
    s_mov_b32 s12, s42
    s_mov_b32 s13, s43
    s_cmp_lt_u32 s25, 12
    s_cbranch_scc1 L_proj_m
    s_mov_b32 s74, 0
    s_sub_u32 s75, s75, 6
    s_mov_b32 s83, s75
    s_mov_b32 s12, s40
    s_mov_b32 s13, s41
L_proj_m:
    s_mov_b32 s14, 7864320
    s_mov_b32 s15, 0x20000
    s_mov_b32 s16, s36
    s_mov_b32 s17, s37
    s_mov_b32 s18, 2621440
    s_mov_b32 s19, 0x20000
    v_lshrrev_b32 v3, 5, v1
    v_mul_u32_u24 v5, 12288, v3
    s_lshl_b32 s28, s75, 9
    s_mul_i32 s29, s24, 196608
    s_add_u32 s28, s28, s29
    v_add_u32 v5, s28, v5
    v_and_b32 v4, 31, v1
    v_lshlrev_b32 v3, 1, v3
    v_xor_b32 v4, v4, v3
    v_xor_b32 v3, 0, v4
    v_lshl_add_u32 v48, v3, 4, v5
    v_xor_b32 v3, 4, v4
    v_lshl_add_u32 v49, v3, 4, v5
    v_xor_b32 v3, 8, v4
    v_lshl_add_u32 v50, v3, 4, v5
    v_xor_b32 v3, 12, v4
    v_lshl_add_u32 v51, v3, 4, v5
    v_lshrrev_b32 v4, 4, v1
    v_lshlrev_b32 v4, 3, v4
    v_bfe_u32 v5, v1, 2, 2
    v_add_u32 v4, v4, v5
    v_lshlrev_b32 v4, 9, v4
    v_and_b32 v5, 3, v1
    v_lshl_add_u32 v4, v5, 3, v4
    v_bfe_u32 v5, v1, 2, 3
    s_lshl_b32 s28, s24, 2
    v_xor_b32 v5, s28, v5
    s_lshl_b32 s30, s24, 13
    v_xor_b32 v3, 0, v5
    v_lshl_add_u32 v52, v3, 5, v4
    v_add_u32 v56, 0x10000, v52
    v_xor_b32 v3, 1, v5
    v_lshl_add_u32 v53, v3, 5, v4
    v_add_u32 v57, 0x10000, v53
    v_xor_b32 v3, 2, v5
    v_lshl_add_u32 v54, v3, 5, v4
    v_add_u32 v58, 0x10000, v54
    v_xor_b32 v3, 3, v5
    v_lshl_add_u32 v55, v3, 5, v4
    v_add_u32 v59, 0x10000, v55
    s_and_b32 s28, s25, 3
    s_mul_i32 s28, s28, 32768
    v_lshlrev_b32 v6, 4, v0
    buffer_load_dwordx4 v[16:19], v6, s[16:19], s28 offen
    s_add_u32 s28, s28, 4096
    buffer_load_dwordx4 v[20:23], v6, s[16:19], s28 offen
    s_add_u32 s28, s28, 4096
    buffer_load_dwordx4 v[24:27], v6, s[16:19], s28 offen
    s_add_u32 s28, s28, 4096
    buffer_load_dwordx4 v[28:31], v6, s[16:19], s28 offen
    s_add_u32 s28, s28, 4096
    buffer_load_dwordx4 v[32:35], v6, s[16:19], s28 offen
    s_add_u32 s28, s28, 4096
    buffer_load_dwordx4 v[36:39], v6, s[16:19], s28 offen
    s_add_u32 s28, s28, 4096
    buffer_load_dwordx4 v[40:43], v6, s[16:19], s28 offen
    s_add_u32 s28, s28, 4096
    buffer_load_dwordx4 v[44:47], v6, s[16:19], s28 offen
    s_add_u32 s28, s28, 4096
    s_add_u32 m0, s30, 0
    s_mov_b32 s31, 0
    buffer_load_dwordx4 v48, s[12:15], s31 offen lds
    s_add_u32 m0, s30, 1024
    s_mov_b32 s31, 24576
    buffer_load_dwordx4 v49, s[12:15], s31 offen lds
    s_add_u32 m0, s30, 2048
    s_mov_b32 s31, 49152
    buffer_load_dwordx4 v48, s[12:15], s31 offen lds
    s_add_u32 m0, s30, 3072
    s_mov_b32 s31, 73728
    buffer_load_dwordx4 v49, s[12:15], s31 offen lds
    s_add_u32 m0, s30, 4096
    s_mov_b32 s31, 98304
    buffer_load_dwordx4 v50, s[12:15], s31 offen lds
    s_add_u32 m0, s30, 5120
    s_mov_b32 s31, 122880
    buffer_load_dwordx4 v51, s[12:15], s31 offen lds
    s_add_u32 m0, s30, 6144
    s_mov_b32 s31, 147456
    buffer_load_dwordx4 v50, s[12:15], s31 offen lds
    s_add_u32 m0, s30, 7168
    s_mov_b32 s31, 172032
    buffer_load_dwordx4 v51, s[12:15], s31 offen lds
    s_add_u32 m0, s30, 32768
    s_mov_b32 s31, 786432
    buffer_load_dwordx4 v48, s[12:15], s31 offen lds
    s_add_u32 m0, s30, 33792
    s_mov_b32 s31, 811008
    buffer_load_dwordx4 v49, s[12:15], s31 offen lds
    s_add_u32 m0, s30, 34816
    s_mov_b32 s31, 835584
    buffer_load_dwordx4 v48, s[12:15], s31 offen lds
    s_add_u32 m0, s30, 35840
    s_mov_b32 s31, 860160
    buffer_load_dwordx4 v49, s[12:15], s31 offen lds
    s_add_u32 m0, s30, 36864
    s_mov_b32 s31, 884736
    buffer_load_dwordx4 v50, s[12:15], s31 offen lds
    s_add_u32 m0, s30, 37888
    s_mov_b32 s31, 909312
    buffer_load_dwordx4 v51, s[12:15], s31 offen lds
    s_add_u32 m0, s30, 38912
    s_mov_b32 s31, 933888
    buffer_load_dwordx4 v50, s[12:15], s31 offen lds
    s_add_u32 m0, s30, 39936
    s_mov_b32 s31, 958464
    buffer_load_dwordx4 v51, s[12:15], s31 offen lds
    s_add_u32 m0, s30, 65536
    s_mov_b32 s31, 1572864
    buffer_load_dwordx4 v48, s[12:15], s31 offen lds
    s_add_u32 m0, s30, 66560
    s_mov_b32 s31, 1597440
    buffer_load_dwordx4 v49, s[12:15], s31 offen lds
    s_add_u32 m0, s30, 67584
    s_mov_b32 s31, 1622016
    buffer_load_dwordx4 v48, s[12:15], s31 offen lds
    s_add_u32 m0, s30, 68608
    s_mov_b32 s31, 1646592
    buffer_load_dwordx4 v49, s[12:15], s31 offen lds
    s_add_u32 m0, s30, 69632
    s_mov_b32 s31, 1671168
    buffer_load_dwordx4 v50, s[12:15], s31 offen lds
    s_add_u32 m0, s30, 70656
    s_mov_b32 s31, 1695744
    buffer_load_dwordx4 v51, s[12:15], s31 offen lds
    s_add_u32 m0, s30, 71680
    s_mov_b32 s31, 1720320
    buffer_load_dwordx4 v50, s[12:15], s31 offen lds
    s_add_u32 m0, s30, 72704
    s_mov_b32 s31, 1744896
    buffer_load_dwordx4 v51, s[12:15], s31 offen lds
    s_waitcnt vmcnt(16)
    s_barrier
    s_add_u32 m0, s30, 98304
    s_mov_b32 s31, 2359296
    buffer_load_dwordx4 v48, s[12:15], s31 offen lds
    s_add_u32 m0, s30, 99328
    s_mov_b32 s31, 2383872
    buffer_load_dwordx4 v49, s[12:15], s31 offen lds
    s_add_u32 m0, s30, 100352
    s_mov_b32 s31, 2408448
    buffer_load_dwordx4 v48, s[12:15], s31 offen lds
    s_add_u32 m0, s30, 101376
    s_mov_b32 s31, 2433024
    buffer_load_dwordx4 v49, s[12:15], s31 offen lds
    s_add_u32 m0, s30, 102400
    s_mov_b32 s31, 2457600
    buffer_load_dwordx4 v50, s[12:15], s31 offen lds
    s_add_u32 m0, s30, 103424
    s_mov_b32 s31, 2482176
    buffer_load_dwordx4 v51, s[12:15], s31 offen lds
    s_add_u32 m0, s30, 104448
    s_mov_b32 s31, 2506752
    buffer_load_dwordx4 v50, s[12:15], s31 offen lds
    s_add_u32 m0, s30, 105472
    s_mov_b32 s31, 2531328
    buffer_load_dwordx4 v51, s[12:15], s31 offen lds
    ds_read_b64_tr_b16 a[0:1], v52 offset:0
    ds_read_b64_tr_b16 a[2:3], v52 offset:2048
    ds_read_b64_tr_b16 a[80:81], v53 offset:0
    ds_read_b64_tr_b16 a[82:83], v53 offset:2048
    ds_read_b64_tr_b16 a[160:161], v54 offset:0
    ds_read_b64_tr_b16 a[162:163], v54 offset:2048
    ds_read_b64_tr_b16 a[240:241], v55 offset:0
    ds_read_b64_tr_b16 a[242:243], v55 offset:2048
    s_waitcnt lgkmcnt(0)
    ds_read_b64_tr_b16 a[4:5], v52 offset:16384
    ds_read_b64_tr_b16 a[6:7], v52 offset:18432
    ds_read_b64_tr_b16 a[84:85], v53 offset:16384
    ds_read_b64_tr_b16 a[86:87], v53 offset:18432
    ds_read_b64_tr_b16 a[164:165], v54 offset:16384
    ds_read_b64_tr_b16 a[166:167], v54 offset:18432
    ds_read_b64_tr_b16 a[244:245], v55 offset:16384
    ds_read_b64_tr_b16 a[246:247], v55 offset:18432
    s_waitcnt lgkmcnt(0)
    s_waitcnt vmcnt(16)
    s_barrier
    s_add_u32 m0, s30, 0
    s_mov_b32 s31, 3145728
    buffer_load_dwordx4 v48, s[12:15], s31 offen lds
    s_add_u32 m0, s30, 1024
    s_mov_b32 s31, 3170304
    buffer_load_dwordx4 v49, s[12:15], s31 offen lds
    s_add_u32 m0, s30, 2048
    s_mov_b32 s31, 3194880
    buffer_load_dwordx4 v48, s[12:15], s31 offen lds
    s_add_u32 m0, s30, 3072
    s_mov_b32 s31, 3219456
    buffer_load_dwordx4 v49, s[12:15], s31 offen lds
    s_add_u32 m0, s30, 4096
    s_mov_b32 s31, 3244032
    buffer_load_dwordx4 v50, s[12:15], s31 offen lds
    s_add_u32 m0, s30, 5120
    s_mov_b32 s31, 3268608
    buffer_load_dwordx4 v51, s[12:15], s31 offen lds
    s_add_u32 m0, s30, 6144
    s_mov_b32 s31, 3293184
    buffer_load_dwordx4 v50, s[12:15], s31 offen lds
    s_add_u32 m0, s30, 7168
    s_mov_b32 s31, 3317760
    buffer_load_dwordx4 v51, s[12:15], s31 offen lds
    ds_read_b64_tr_b16 a[8:9], v52 offset:32768
    ds_read_b64_tr_b16 a[10:11], v52 offset:34816
    ds_read_b64_tr_b16 a[88:89], v53 offset:32768
    ds_read_b64_tr_b16 a[90:91], v53 offset:34816
    ds_read_b64_tr_b16 a[168:169], v54 offset:32768
    ds_read_b64_tr_b16 a[170:171], v54 offset:34816
    ds_read_b64_tr_b16 a[248:249], v55 offset:32768
    ds_read_b64_tr_b16 a[250:251], v55 offset:34816
    s_waitcnt lgkmcnt(0)
    ds_read_b64_tr_b16 a[12:13], v52 offset:49152
    ds_read_b64_tr_b16 a[14:15], v52 offset:51200
    ds_read_b64_tr_b16 a[92:93], v53 offset:49152
    ds_read_b64_tr_b16 a[94:95], v53 offset:51200
    ds_read_b64_tr_b16 a[172:173], v54 offset:49152
    ds_read_b64_tr_b16 a[174:175], v54 offset:51200
    ds_read_b64_tr_b16 a[252:253], v55 offset:49152
    ds_read_b64_tr_b16 a[254:255], v55 offset:51200
    s_waitcnt lgkmcnt(0)
    s_waitcnt vmcnt(16)
    s_barrier
    s_add_u32 m0, s30, 32768
    s_mov_b32 s31, 3932160
    buffer_load_dwordx4 v48, s[12:15], s31 offen lds
    s_add_u32 m0, s30, 33792
    s_mov_b32 s31, 3956736
    buffer_load_dwordx4 v49, s[12:15], s31 offen lds
    s_add_u32 m0, s30, 34816
    s_mov_b32 s31, 3981312
    buffer_load_dwordx4 v48, s[12:15], s31 offen lds
    s_add_u32 m0, s30, 35840
    s_mov_b32 s31, 4005888
    buffer_load_dwordx4 v49, s[12:15], s31 offen lds
    s_add_u32 m0, s30, 36864
    s_mov_b32 s31, 4030464
    buffer_load_dwordx4 v50, s[12:15], s31 offen lds
    s_add_u32 m0, s30, 37888
    s_mov_b32 s31, 4055040
    buffer_load_dwordx4 v51, s[12:15], s31 offen lds
    s_add_u32 m0, s30, 38912
    s_mov_b32 s31, 4079616
    buffer_load_dwordx4 v50, s[12:15], s31 offen lds
    s_add_u32 m0, s30, 39936
    s_mov_b32 s31, 4104192
    buffer_load_dwordx4 v51, s[12:15], s31 offen lds
    ds_read_b64_tr_b16 a[16:17], v56 offset:0
    ds_read_b64_tr_b16 a[18:19], v56 offset:2048
    ds_read_b64_tr_b16 a[96:97], v57 offset:0
    ds_read_b64_tr_b16 a[98:99], v57 offset:2048
    ds_read_b64_tr_b16 a[176:177], v58 offset:0
    ds_read_b64_tr_b16 a[178:179], v58 offset:2048
    ds_read_b64_tr_b16 v[192:193], v59 offset:0
    ds_read_b64_tr_b16 v[194:195], v59 offset:2048
    s_waitcnt lgkmcnt(0)
    ds_read_b64_tr_b16 a[20:21], v56 offset:16384
    ds_read_b64_tr_b16 a[22:23], v56 offset:18432
    ds_read_b64_tr_b16 a[100:101], v57 offset:16384
    ds_read_b64_tr_b16 a[102:103], v57 offset:18432
    ds_read_b64_tr_b16 a[180:181], v58 offset:16384
    ds_read_b64_tr_b16 a[182:183], v58 offset:18432
    ds_read_b64_tr_b16 v[196:197], v59 offset:16384
    ds_read_b64_tr_b16 v[198:199], v59 offset:18432
    s_waitcnt lgkmcnt(0)
    s_waitcnt vmcnt(16)
    s_barrier
    s_add_u32 m0, s30, 65536
    s_mov_b32 s31, 4718592
    buffer_load_dwordx4 v48, s[12:15], s31 offen lds
    s_add_u32 m0, s30, 66560
    s_mov_b32 s31, 4743168
    buffer_load_dwordx4 v49, s[12:15], s31 offen lds
    s_add_u32 m0, s30, 67584
    s_mov_b32 s31, 4767744
    buffer_load_dwordx4 v48, s[12:15], s31 offen lds
    s_add_u32 m0, s30, 68608
    s_mov_b32 s31, 4792320
    buffer_load_dwordx4 v49, s[12:15], s31 offen lds
    s_add_u32 m0, s30, 69632
    s_mov_b32 s31, 4816896
    buffer_load_dwordx4 v50, s[12:15], s31 offen lds
    s_add_u32 m0, s30, 70656
    s_mov_b32 s31, 4841472
    buffer_load_dwordx4 v51, s[12:15], s31 offen lds
    s_add_u32 m0, s30, 71680
    s_mov_b32 s31, 4866048
    buffer_load_dwordx4 v50, s[12:15], s31 offen lds
    s_add_u32 m0, s30, 72704
    s_mov_b32 s31, 4890624
    buffer_load_dwordx4 v51, s[12:15], s31 offen lds
    ds_read_b64_tr_b16 a[24:25], v56 offset:32768
    ds_read_b64_tr_b16 a[26:27], v56 offset:34816
    ds_read_b64_tr_b16 a[104:105], v57 offset:32768
    ds_read_b64_tr_b16 a[106:107], v57 offset:34816
    ds_read_b64_tr_b16 a[184:185], v58 offset:32768
    ds_read_b64_tr_b16 a[186:187], v58 offset:34816
    ds_read_b64_tr_b16 v[200:201], v59 offset:32768
    ds_read_b64_tr_b16 v[202:203], v59 offset:34816
    s_waitcnt lgkmcnt(0)
    ds_read_b64_tr_b16 a[28:29], v56 offset:49152
    ds_read_b64_tr_b16 a[30:31], v56 offset:51200
    ds_read_b64_tr_b16 a[108:109], v57 offset:49152
    ds_read_b64_tr_b16 a[110:111], v57 offset:51200
    ds_read_b64_tr_b16 a[188:189], v58 offset:49152
    ds_read_b64_tr_b16 a[190:191], v58 offset:51200
    ds_read_b64_tr_b16 v[204:205], v59 offset:49152
    ds_read_b64_tr_b16 v[206:207], v59 offset:51200
    s_waitcnt lgkmcnt(0)
    s_waitcnt vmcnt(16)
    s_barrier
    s_add_u32 m0, s30, 98304
    s_mov_b32 s31, 5505024
    buffer_load_dwordx4 v48, s[12:15], s31 offen lds
    s_add_u32 m0, s30, 99328
    s_mov_b32 s31, 5529600
    buffer_load_dwordx4 v49, s[12:15], s31 offen lds
    s_add_u32 m0, s30, 100352
    s_mov_b32 s31, 5554176
    buffer_load_dwordx4 v48, s[12:15], s31 offen lds
    s_add_u32 m0, s30, 101376
    s_mov_b32 s31, 5578752
    buffer_load_dwordx4 v49, s[12:15], s31 offen lds
    s_add_u32 m0, s30, 102400
    s_mov_b32 s31, 5603328
    buffer_load_dwordx4 v50, s[12:15], s31 offen lds
    s_add_u32 m0, s30, 103424
    s_mov_b32 s31, 5627904
    buffer_load_dwordx4 v51, s[12:15], s31 offen lds
    s_add_u32 m0, s30, 104448
    s_mov_b32 s31, 5652480
    buffer_load_dwordx4 v50, s[12:15], s31 offen lds
    s_add_u32 m0, s30, 105472
    s_mov_b32 s31, 5677056
    buffer_load_dwordx4 v51, s[12:15], s31 offen lds
    ds_read_b64_tr_b16 a[32:33], v52 offset:0
    ds_read_b64_tr_b16 a[34:35], v52 offset:2048
    ds_read_b64_tr_b16 a[112:113], v53 offset:0
    ds_read_b64_tr_b16 a[114:115], v53 offset:2048
    ds_read_b64_tr_b16 a[192:193], v54 offset:0
    ds_read_b64_tr_b16 a[194:195], v54 offset:2048
    ds_read_b64_tr_b16 v[208:209], v55 offset:0
    ds_read_b64_tr_b16 v[210:211], v55 offset:2048
    s_waitcnt lgkmcnt(0)
    ds_read_b64_tr_b16 a[36:37], v52 offset:16384
    ds_read_b64_tr_b16 a[38:39], v52 offset:18432
    ds_read_b64_tr_b16 a[116:117], v53 offset:16384
    ds_read_b64_tr_b16 a[118:119], v53 offset:18432
    ds_read_b64_tr_b16 a[196:197], v54 offset:16384
    ds_read_b64_tr_b16 a[198:199], v54 offset:18432
    ds_read_b64_tr_b16 v[212:213], v55 offset:16384
    ds_read_b64_tr_b16 v[214:215], v55 offset:18432
    s_waitcnt lgkmcnt(0)
    s_waitcnt vmcnt(16)
    s_barrier
    s_add_u32 m0, s30, 0
    s_mov_b32 s31, 6291456
    buffer_load_dwordx4 v48, s[12:15], s31 offen lds
    s_add_u32 m0, s30, 1024
    s_mov_b32 s31, 6316032
    buffer_load_dwordx4 v49, s[12:15], s31 offen lds
    s_add_u32 m0, s30, 2048
    s_mov_b32 s31, 6340608
    buffer_load_dwordx4 v48, s[12:15], s31 offen lds
    s_add_u32 m0, s30, 3072
    s_mov_b32 s31, 6365184
    buffer_load_dwordx4 v49, s[12:15], s31 offen lds
    s_add_u32 m0, s30, 4096
    s_mov_b32 s31, 6389760
    buffer_load_dwordx4 v50, s[12:15], s31 offen lds
    s_add_u32 m0, s30, 5120
    s_mov_b32 s31, 6414336
    buffer_load_dwordx4 v51, s[12:15], s31 offen lds
    s_add_u32 m0, s30, 6144
    s_mov_b32 s31, 6438912
    buffer_load_dwordx4 v50, s[12:15], s31 offen lds
    s_add_u32 m0, s30, 7168
    s_mov_b32 s31, 6463488
    buffer_load_dwordx4 v51, s[12:15], s31 offen lds
    ds_read_b64_tr_b16 a[40:41], v52 offset:32768
    ds_read_b64_tr_b16 a[42:43], v52 offset:34816
    ds_read_b64_tr_b16 a[120:121], v53 offset:32768
    ds_read_b64_tr_b16 a[122:123], v53 offset:34816
    ds_read_b64_tr_b16 a[200:201], v54 offset:32768
    ds_read_b64_tr_b16 a[202:203], v54 offset:34816
    ds_read_b64_tr_b16 v[216:217], v55 offset:32768
    ds_read_b64_tr_b16 v[218:219], v55 offset:34816
    s_waitcnt lgkmcnt(0)
    ds_read_b64_tr_b16 a[44:45], v52 offset:49152
    ds_read_b64_tr_b16 a[46:47], v52 offset:51200
    ds_read_b64_tr_b16 a[124:125], v53 offset:49152
    ds_read_b64_tr_b16 a[126:127], v53 offset:51200
    ds_read_b64_tr_b16 a[204:205], v54 offset:49152
    ds_read_b64_tr_b16 a[206:207], v54 offset:51200
    ds_read_b64_tr_b16 v[220:221], v55 offset:49152
    ds_read_b64_tr_b16 v[222:223], v55 offset:51200
    s_waitcnt lgkmcnt(0)
    s_waitcnt vmcnt(16)
    s_barrier
    s_add_u32 m0, s30, 32768
    s_mov_b32 s31, 7077888
    buffer_load_dwordx4 v48, s[12:15], s31 offen lds
    s_add_u32 m0, s30, 33792
    s_mov_b32 s31, 7102464
    buffer_load_dwordx4 v49, s[12:15], s31 offen lds
    s_add_u32 m0, s30, 34816
    s_mov_b32 s31, 7127040
    buffer_load_dwordx4 v48, s[12:15], s31 offen lds
    s_add_u32 m0, s30, 35840
    s_mov_b32 s31, 7151616
    buffer_load_dwordx4 v49, s[12:15], s31 offen lds
    s_add_u32 m0, s30, 36864
    s_mov_b32 s31, 7176192
    buffer_load_dwordx4 v50, s[12:15], s31 offen lds
    s_add_u32 m0, s30, 37888
    s_mov_b32 s31, 7200768
    buffer_load_dwordx4 v51, s[12:15], s31 offen lds
    s_add_u32 m0, s30, 38912
    s_mov_b32 s31, 7225344
    buffer_load_dwordx4 v50, s[12:15], s31 offen lds
    s_add_u32 m0, s30, 39936
    s_mov_b32 s31, 7249920
    buffer_load_dwordx4 v51, s[12:15], s31 offen lds
    ds_read_b64_tr_b16 a[48:49], v56 offset:0
    ds_read_b64_tr_b16 a[50:51], v56 offset:2048
    ds_read_b64_tr_b16 a[128:129], v57 offset:0
    ds_read_b64_tr_b16 a[130:131], v57 offset:2048
    ds_read_b64_tr_b16 a[208:209], v58 offset:0
    ds_read_b64_tr_b16 a[210:211], v58 offset:2048
    ds_read_b64_tr_b16 v[224:225], v59 offset:0
    ds_read_b64_tr_b16 v[226:227], v59 offset:2048
    s_waitcnt lgkmcnt(0)
    ds_read_b64_tr_b16 a[52:53], v56 offset:16384
    ds_read_b64_tr_b16 a[54:55], v56 offset:18432
    ds_read_b64_tr_b16 a[132:133], v57 offset:16384
    ds_read_b64_tr_b16 a[134:135], v57 offset:18432
    ds_read_b64_tr_b16 a[212:213], v58 offset:16384
    ds_read_b64_tr_b16 a[214:215], v58 offset:18432
    ds_read_b64_tr_b16 v[228:229], v59 offset:16384
    ds_read_b64_tr_b16 v[230:231], v59 offset:18432
    s_waitcnt lgkmcnt(0)
    s_waitcnt vmcnt(16)
    s_barrier
    ds_read_b64_tr_b16 a[56:57], v56 offset:32768
    ds_read_b64_tr_b16 a[58:59], v56 offset:34816
    ds_read_b64_tr_b16 a[136:137], v57 offset:32768
    ds_read_b64_tr_b16 a[138:139], v57 offset:34816
    ds_read_b64_tr_b16 a[216:217], v58 offset:32768
    ds_read_b64_tr_b16 a[218:219], v58 offset:34816
    ds_read_b64_tr_b16 v[232:233], v59 offset:32768
    ds_read_b64_tr_b16 v[234:235], v59 offset:34816
    s_waitcnt lgkmcnt(0)
    ds_read_b64_tr_b16 a[60:61], v56 offset:49152
    ds_read_b64_tr_b16 a[62:63], v56 offset:51200
    ds_read_b64_tr_b16 a[140:141], v57 offset:49152
    ds_read_b64_tr_b16 a[142:143], v57 offset:51200
    ds_read_b64_tr_b16 a[220:221], v58 offset:49152
    ds_read_b64_tr_b16 a[222:223], v58 offset:51200
    ds_read_b64_tr_b16 v[236:237], v59 offset:49152
    ds_read_b64_tr_b16 v[238:239], v59 offset:51200
    s_waitcnt lgkmcnt(0)
    s_waitcnt vmcnt(8)
    s_barrier
    ds_read_b64_tr_b16 a[64:65], v52 offset:0
    ds_read_b64_tr_b16 a[66:67], v52 offset:2048
    ds_read_b64_tr_b16 a[144:145], v53 offset:0
    ds_read_b64_tr_b16 a[146:147], v53 offset:2048
    ds_read_b64_tr_b16 a[224:225], v54 offset:0
    ds_read_b64_tr_b16 a[226:227], v54 offset:2048
    ds_read_b64_tr_b16 v[240:241], v55 offset:0
    ds_read_b64_tr_b16 v[242:243], v55 offset:2048
    s_waitcnt lgkmcnt(0)
    ds_read_b64_tr_b16 a[68:69], v52 offset:16384
    ds_read_b64_tr_b16 a[70:71], v52 offset:18432
    ds_read_b64_tr_b16 a[148:149], v53 offset:16384
    ds_read_b64_tr_b16 a[150:151], v53 offset:18432
    ds_read_b64_tr_b16 a[228:229], v54 offset:16384
    ds_read_b64_tr_b16 a[230:231], v54 offset:18432
    ds_read_b64_tr_b16 v[244:245], v55 offset:16384
    ds_read_b64_tr_b16 v[246:247], v55 offset:18432
    s_waitcnt lgkmcnt(0)
    s_waitcnt vmcnt(0)
    s_barrier
    ds_read_b64_tr_b16 a[72:73], v52 offset:32768
    ds_read_b64_tr_b16 a[74:75], v52 offset:34816
    ds_read_b64_tr_b16 a[152:153], v53 offset:32768
    ds_read_b64_tr_b16 a[154:155], v53 offset:34816
    ds_read_b64_tr_b16 a[232:233], v54 offset:32768
    ds_read_b64_tr_b16 a[234:235], v54 offset:34816
    ds_read_b64_tr_b16 v[248:249], v55 offset:32768
    ds_read_b64_tr_b16 v[250:251], v55 offset:34816
    s_waitcnt lgkmcnt(0)
    ds_read_b64_tr_b16 a[76:77], v52 offset:49152
    ds_read_b64_tr_b16 a[78:79], v52 offset:51200
    ds_read_b64_tr_b16 a[156:157], v53 offset:49152
    ds_read_b64_tr_b16 a[158:159], v53 offset:51200
    ds_read_b64_tr_b16 a[236:237], v54 offset:49152
    ds_read_b64_tr_b16 a[238:239], v54 offset:51200
    ds_read_b64_tr_b16 v[252:253], v55 offset:49152
    ds_read_b64_tr_b16 v[254:255], v55 offset:51200
    s_waitcnt lgkmcnt(0)
    s_barrier
    v_lshrrev_b32 v4, 3, v1
    v_and_b32 v3, 7, v1
    v_xor_b32 v3, v3, v4
    v_lshlrev_b32 v3, 4, v3
    v_mul_u32_u24 v4, 1280, v4
    v_add_u32 v3, v3, v4
    s_mul_i32 s30, s24, 10240
    v_add_u32 v3, s30, v3
    v_and_b32 v4, 7, v1
    v_lshrrev_b32 v5, 4, v1
    v_xor_b32 v5, v5, v4
    v_lshlrev_b32 v5, 4, v5
    v_lshl_add_u32 v5, v4, 7, v5
    v_bfe_u32 v4, v1, 3, 1
    v_mul_u32_u24 v4, 10240, v4
    v_add_u32 v88, v5, v4
    v_xor_b32 v89, 64, v88
    s_lshl_b32 s28, s75, 3
    s_lshl_b32 s29, s24, 1
    s_add_u32 s28, s28, s29
    s_add_u32 s28, s28, 0
    s_mul_i32 s29, s28, 43691
    s_lshr_b32 s29, s29, 18
    s_mul_i32 s31, s29, 6
    s_sub_u32 s28, s28, s31
    s_mul_i32 s29, s29, 12288
    s_lshl_b32 s28, s28, 10
    s_add_u32 s28, s28, s29
    s_add_u32 s28, s28, s74
    v_add_u32 v6, s28, v2
    v_add_u32 v8, 6144, v6
    s_lshl_b32 s28, s75, 3
    s_lshl_b32 s29, s24, 1
    s_add_u32 s28, s28, s29
    s_add_u32 s28, s28, 1
    s_mul_i32 s29, s28, 43691
    s_lshr_b32 s29, s29, 18
    s_mul_i32 s31, s29, 6
    s_sub_u32 s28, s28, s31
    s_mul_i32 s29, s29, 12288
    s_lshl_b32 s28, s28, 10
    s_add_u32 s28, s28, s29
    s_add_u32 s28, s28, s74
    v_add_u32 v7, s28, v2
    v_add_u32 v9, 6144, v7
    s_lshl_b32 s28, s83, 7
    s_add_u32 s28, s28, 192413696
    v_mov_b32 v10, s28
    s_mov_b32 s77, 0
    s_mov_b32 s78, 0
    s_mov_b32 s80, s30
    s_mov_b32 s76, 0
    s_add_u32 m0, s80, 0
    s_nop 0
    buffer_load_dwordx4 v3, s[16:19], s78 offen offset:0 lds
    s_add_u32 m0, s80, 896
    s_nop 0
    buffer_load_dwordx4 v3, s[16:19], s78 offen offset:128 lds
    s_add_u32 m0, s80, 1792
    s_nop 0
    buffer_load_dwordx4 v3, s[16:19], s78 offen offset:256 lds
    s_add_u32 m0, s80, 2688
    s_nop 0
    buffer_load_dwordx4 v3, s[16:19], s78 offen offset:384 lds
    s_add_u32 m0, s80, 3584
    s_nop 0
    buffer_load_dwordx4 v3, s[16:19], s78 offen offset:512 lds
    s_add_u32 m0, s80, 4480
    s_nop 0
    buffer_load_dwordx4 v3, s[16:19], s78 offen offset:640 lds
    s_add_u32 m0, s80, 5376
    s_nop 0
    buffer_load_dwordx4 v3, s[16:19], s78 offen offset:768 lds
    s_add_u32 m0, s80, 6272
    s_nop 0
    buffer_load_dwordx4 v3, s[16:19], s78 offen offset:896 lds
    s_add_u32 m0, s80, 7168
    s_nop 0
    buffer_load_dwordx4 v3, s[16:19], s78 offen offset:1024 lds
    s_add_u32 m0, s80, 8064
    s_nop 0
    buffer_load_dwordx4 v3, s[16:19], s78 offen offset:1152 lds
    s_mov_b32 s78, 40960
    s_add_u32 s80, s30, 40960
    s_add_u32 m0, s80, 0
    s_nop 0
    buffer_load_dwordx4 v3, s[16:19], s78 offen offset:0 lds
    s_add_u32 m0, s80, 896
    s_nop 0
    buffer_load_dwordx4 v3, s[16:19], s78 offen offset:128 lds
    s_add_u32 m0, s80, 1792
    s_nop 0
    buffer_load_dwordx4 v3, s[16:19], s78 offen offset:256 lds
    s_add_u32 m0, s80, 2688
    s_nop 0
    buffer_load_dwordx4 v3, s[16:19], s78 offen offset:384 lds
    s_add_u32 m0, s80, 3584
    s_nop 0
    buffer_load_dwordx4 v3, s[16:19], s78 offen offset:512 lds
    s_add_u32 m0, s80, 4480
    s_nop 0
    buffer_load_dwordx4 v3, s[16:19], s78 offen offset:640 lds
    s_add_u32 m0, s80, 5376
    s_nop 0
    buffer_load_dwordx4 v3, s[16:19], s78 offen offset:768 lds
    s_add_u32 m0, s80, 6272
    s_nop 0
    buffer_load_dwordx4 v3, s[16:19], s78 offen offset:896 lds
    s_add_u32 m0, s80, 7168
    s_nop 0
    buffer_load_dwordx4 v3, s[16:19], s78 offen offset:1024 lds
    s_add_u32 m0, s80, 8064
    s_nop 0
    buffer_load_dwordx4 v3, s[16:19], s78 offen offset:1152 lds
    s_mov_b32 s78, 81920
    s_mov_b32 s79, 81920
    s_add_u32 s80, s30, 81920
    s_mov_b32 s82, 40960
    v_mov_b32 v11, v88
    v_mov_b32 v12, v89
    v_add_u32 v90, 40960, v88
    v_add_u32 v91, 40960, v89
    v_and_b32 v4, 3, v1
    v_lshlrev_b32 v4, 2, v4
    v_bfe_u32 v5, v1, 2, 1
    v_lshl_add_u32 v4, v5, 7, v4
    v_cmp_lt_u32 vcc, 7, v1
    v_mov_b32 v5, 16
    s_nop 0
    v_cndmask_b32 v4, v4, v5, vcc
L_proj_st:
    buffer_load_dword v5, v4, s[8:11], 0 offen sc1
    s_waitcnt vmcnt(0)
    v_cmp_gt_u32 vcc, 32, v5
    v_readlane_b32 s28, v5, 8
    s_cbranch_vccnz L_proj_st_no
    s_cmp_ge_u32 s28, 64
    s_cbranch_scc1 L_proj_st_ok
L_proj_st_no:
    s_sleep 4
    s_sub_u32 s27, s27, 1
    s_cbranch_scc1 L_fail
    s_branch L_proj_st
L_proj_st_ok:
    s_barrier
    ds_read_b128 v[48:51], v11 offset:0
    ds_read_b128 v[52:55], v12 offset:0
    ds_read_b128 v[56:59], v11 offset:1024
    ds_read_b128 v[60:63], v12 offset:1024
    ds_read_b128 v[64:67], v11 offset:2048
    ds_read_b128 v[68:71], v12 offset:2048
    s_cmp_eq_u32 s24, 0
    s_cbranch_scc0 L_proj_go
    v_mov_b32 v13, 1
    s_mov_b64 exec, 1
    buffer_store_dword v13, v10, s[4:7], 0 offen offset:4 sc1
    s_mov_b64 exec, -1
L_proj_go:
    s_mov_b32 s81, 0
    s_mov_b32 s85, 0
L_proj_loop:
    ds_read_b128 v[72:75], v11 offset:3072
    s_waitcnt lgkmcnt(6)
    v_mfma_f32_16x16x32_bf16 v[16:19], a[0:3], v[48:51], 0
    v_mfma_f32_16x16x32_bf16 v[20:23], a[80:83], v[48:51], 0
    v_mfma_f32_16x16x32_bf16 v[24:27], a[160:163], v[48:51], 0
    s_add_u32 m0, s80, 0
    s_nop 0
    buffer_load_dwordx4 v3, s[16:19], s78 offen offset:0 lds
    v_mfma_f32_16x16x32_bf16 v[28:31], a[240:243], v[48:51], 0
    ds_read_b128 v[76:79], v12 offset:3072
    s_waitcnt lgkmcnt(6)
    v_mfma_f32_16x16x32_bf16 v[16:19], a[4:7], v[52:55], v[16:19]
    v_mfma_f32_16x16x32_bf16 v[20:23], a[84:87], v[52:55], v[20:23]
    v_mfma_f32_16x16x32_bf16 v[24:27], a[164:167], v[52:55], v[24:27]
    v_mfma_f32_16x16x32_bf16 v[28:31], a[244:247], v[52:55], v[28:31]
    ds_read_b128 v[48:51], v11 offset:4096
    s_waitcnt lgkmcnt(6)
    v_mfma_f32_16x16x32_bf16 v[16:19], a[8:11], v[56:59], v[16:19]
    s_add_u32 m0, s80, 896
    s_nop 0
    buffer_load_dwordx4 v3, s[16:19], s78 offen offset:128 lds
    v_mfma_f32_16x16x32_bf16 v[20:23], a[88:91], v[56:59], v[20:23]
    v_mfma_f32_16x16x32_bf16 v[24:27], a[168:171], v[56:59], v[24:27]
    v_mfma_f32_16x16x32_bf16 v[28:31], a[248:251], v[56:59], v[28:31]
    ds_read_b128 v[52:55], v12 offset:4096
    s_waitcnt lgkmcnt(6)
    v_mfma_f32_16x16x32_bf16 v[16:19], a[12:15], v[60:63], v[16:19]
    v_mfma_f32_16x16x32_bf16 v[20:23], a[92:95], v[60:63], v[20:23]
    v_mfma_f32_16x16x32_bf16 v[24:27], a[172:175], v[60:63], v[24:27]
    s_add_u32 m0, s80, 1792
    s_nop 0
    buffer_load_dwordx4 v3, s[16:19], s78 offen offset:256 lds
    v_mfma_f32_16x16x32_bf16 v[28:31], a[252:255], v[60:63], v[28:31]
    ds_read_b128 v[56:59], v11 offset:5120
    s_waitcnt lgkmcnt(6)
    v_mfma_f32_16x16x32_bf16 v[16:19], a[16:19], v[64:67], v[16:19]
    v_mfma_f32_16x16x32_bf16 v[20:23], a[96:99], v[64:67], v[20:23]
    v_mfma_f32_16x16x32_bf16 v[24:27], a[176:179], v[64:67], v[24:27]
    v_mfma_f32_16x16x32_bf16 v[28:31], v[192:195], v[64:67], v[28:31]
    ds_read_b128 v[60:63], v12 offset:5120
    s_waitcnt lgkmcnt(6)
    v_mfma_f32_16x16x32_bf16 v[16:19], a[20:23], v[68:71], v[16:19]
    s_add_u32 m0, s80, 2688
    s_nop 0
    buffer_load_dwordx4 v3, s[16:19], s78 offen offset:384 lds
    v_mfma_f32_16x16x32_bf16 v[20:23], a[100:103], v[68:71], v[20:23]
    v_mfma_f32_16x16x32_bf16 v[24:27], a[180:183], v[68:71], v[24:27]
    v_mfma_f32_16x16x32_bf16 v[28:31], v[196:199], v[68:71], v[28:31]
    ds_read_b128 v[64:67], v11 offset:6144
    s_waitcnt lgkmcnt(6)
    v_mfma_f32_16x16x32_bf16 v[16:19], a[24:27], v[72:75], v[16:19]
    v_mfma_f32_16x16x32_bf16 v[20:23], a[104:107], v[72:75], v[20:23]
    v_mfma_f32_16x16x32_bf16 v[24:27], a[184:187], v[72:75], v[24:27]
    s_add_u32 m0, s80, 3584
    s_nop 0
    buffer_load_dwordx4 v3, s[16:19], s78 offen offset:512 lds
    v_mfma_f32_16x16x32_bf16 v[28:31], v[200:203], v[72:75], v[28:31]
    ds_read_b128 v[68:71], v12 offset:6144
    s_waitcnt lgkmcnt(6)
    v_mfma_f32_16x16x32_bf16 v[16:19], a[28:31], v[76:79], v[16:19]
    v_mfma_f32_16x16x32_bf16 v[20:23], a[108:111], v[76:79], v[20:23]
    v_mfma_f32_16x16x32_bf16 v[24:27], a[188:191], v[76:79], v[24:27]
    v_mfma_f32_16x16x32_bf16 v[28:31], v[204:207], v[76:79], v[28:31]
    ds_read_b128 v[72:75], v11 offset:7168
    s_waitcnt lgkmcnt(6)
    v_mfma_f32_16x16x32_bf16 v[16:19], a[32:35], v[48:51], v[16:19]
    s_add_u32 m0, s80, 4480
    s_nop 0
    buffer_load_dwordx4 v3, s[16:19], s78 offen offset:640 lds
    v_mfma_f32_16x16x32_bf16 v[20:23], a[112:115], v[48:51], v[20:23]
    v_mfma_f32_16x16x32_bf16 v[24:27], a[192:195], v[48:51], v[24:27]
    v_mfma_f32_16x16x32_bf16 v[28:31], v[208:211], v[48:51], v[28:31]
    ds_read_b128 v[76:79], v12 offset:7168
    s_waitcnt lgkmcnt(6)
    v_mfma_f32_16x16x32_bf16 v[16:19], a[36:39], v[52:55], v[16:19]
    v_mfma_f32_16x16x32_bf16 v[20:23], a[116:119], v[52:55], v[20:23]
    v_mfma_f32_16x16x32_bf16 v[24:27], a[196:199], v[52:55], v[24:27]
    s_add_u32 m0, s80, 5376
    s_nop 0
    buffer_load_dwordx4 v3, s[16:19], s78 offen offset:768 lds
    v_mfma_f32_16x16x32_bf16 v[28:31], v[212:215], v[52:55], v[28:31]
    ds_read_b128 v[48:51], v11 offset:8192
    s_waitcnt lgkmcnt(6)
    v_mfma_f32_16x16x32_bf16 v[16:19], a[40:43], v[56:59], v[16:19]
    v_mfma_f32_16x16x32_bf16 v[20:23], a[120:123], v[56:59], v[20:23]
    v_mfma_f32_16x16x32_bf16 v[24:27], a[200:203], v[56:59], v[24:27]
    v_mfma_f32_16x16x32_bf16 v[28:31], v[216:219], v[56:59], v[28:31]
    ds_read_b128 v[52:55], v12 offset:8192
    s_waitcnt lgkmcnt(6)
    v_mfma_f32_16x16x32_bf16 v[16:19], a[44:47], v[60:63], v[16:19]
    s_add_u32 m0, s80, 6272
    s_nop 0
    buffer_load_dwordx4 v3, s[16:19], s78 offen offset:896 lds
    v_mfma_f32_16x16x32_bf16 v[20:23], a[124:127], v[60:63], v[20:23]
    v_mfma_f32_16x16x32_bf16 v[24:27], a[204:207], v[60:63], v[24:27]
    v_mfma_f32_16x16x32_bf16 v[28:31], v[220:223], v[60:63], v[28:31]
    ds_read_b128 v[56:59], v11 offset:9216
    s_waitcnt lgkmcnt(6)
    v_mfma_f32_16x16x32_bf16 v[16:19], a[48:51], v[64:67], v[16:19]
    v_mfma_f32_16x16x32_bf16 v[20:23], a[128:131], v[64:67], v[20:23]
    v_mfma_f32_16x16x32_bf16 v[24:27], a[208:211], v[64:67], v[24:27]
    s_add_u32 m0, s80, 7168
    s_nop 0
    buffer_load_dwordx4 v3, s[16:19], s78 offen offset:1024 lds
    v_mfma_f32_16x16x32_bf16 v[28:31], v[224:227], v[64:67], v[28:31]
    ds_read_b128 v[60:63], v12 offset:9216
    s_waitcnt lgkmcnt(6)
    v_mfma_f32_16x16x32_bf16 v[16:19], a[52:55], v[68:71], v[16:19]
    v_mfma_f32_16x16x32_bf16 v[20:23], a[132:135], v[68:71], v[20:23]
    v_mfma_f32_16x16x32_bf16 v[24:27], a[212:215], v[68:71], v[24:27]
    v_mfma_f32_16x16x32_bf16 v[28:31], v[228:231], v[68:71], v[28:31]
    ds_read_b128 v[64:67], v11 offset:20480
    s_waitcnt lgkmcnt(6)
    v_mfma_f32_16x16x32_bf16 v[16:19], a[56:59], v[72:75], v[16:19]
    s_add_u32 m0, s80, 8064
    s_nop 0
    buffer_load_dwordx4 v3, s[16:19], s78 offen offset:1152 lds
    v_mfma_f32_16x16x32_bf16 v[20:23], a[136:139], v[72:75], v[20:23]
    v_mfma_f32_16x16x32_bf16 v[24:27], a[216:219], v[72:75], v[24:27]
    v_mfma_f32_16x16x32_bf16 v[28:31], v[232:235], v[72:75], v[28:31]
    ds_read_b128 v[68:71], v12 offset:20480
    s_waitcnt lgkmcnt(6)
    v_mfma_f32_16x16x32_bf16 v[16:19], a[60:63], v[76:79], v[16:19]
    v_mfma_f32_16x16x32_bf16 v[20:23], a[140:143], v[76:79], v[20:23]
    v_mfma_f32_16x16x32_bf16 v[24:27], a[220:223], v[76:79], v[24:27]
    v_cvt_pk_bf16_f32 v80, v32, v33
    v_mfma_f32_16x16x32_bf16 v[28:31], v[236:239], v[76:79], v[28:31]
    v_cvt_pk_bf16_f32 v81, v34, v35
    ds_read_b128 v[72:75], v11 offset:21504
    s_waitcnt lgkmcnt(6)
    v_mfma_f32_16x16x32_bf16 v[16:19], a[64:67], v[48:51], v[16:19]
    v_cvt_pk_bf16_f32 v82, v36, v37
    v_mfma_f32_16x16x32_bf16 v[20:23], a[144:147], v[48:51], v[20:23]
    v_cvt_pk_bf16_f32 v83, v38, v39
    v_mfma_f32_16x16x32_bf16 v[24:27], a[224:227], v[48:51], v[24:27]
    buffer_store_dwordx4 v[80:83], v8, s[4:7], s81 offen sc1
    v_mfma_f32_16x16x32_bf16 v[28:31], v[240:243], v[48:51], v[28:31]
    v_cvt_pk_bf16_f32 v84, v40, v41
    ds_read_b128 v[76:79], v12 offset:21504
    s_waitcnt lgkmcnt(6)
    v_mfma_f32_16x16x32_bf16 v[16:19], a[68:71], v[52:55], v[16:19]
    v_cvt_pk_bf16_f32 v85, v42, v43
    v_mfma_f32_16x16x32_bf16 v[20:23], a[148:151], v[52:55], v[20:23]
    v_cvt_pk_bf16_f32 v86, v44, v45
    v_mfma_f32_16x16x32_bf16 v[24:27], a[228:231], v[52:55], v[24:27]
    v_cvt_pk_bf16_f32 v87, v46, v47
    v_mfma_f32_16x16x32_bf16 v[28:31], v[244:247], v[52:55], v[28:31]
    buffer_store_dwordx4 v[84:87], v9, s[4:7], s81 offen sc1
    ds_read_b128 v[48:51], v11 offset:22528
    s_waitcnt lgkmcnt(6)
    v_mfma_f32_16x16x32_bf16 v[16:19], a[72:75], v[56:59], v[16:19]
    v_mfma_f32_16x16x32_bf16 v[20:23], a[152:155], v[56:59], v[20:23]
    v_mfma_f32_16x16x32_bf16 v[24:27], a[232:235], v[56:59], v[24:27]
    v_mfma_f32_16x16x32_bf16 v[28:31], v[248:251], v[56:59], v[28:31]
    ds_read_b128 v[52:55], v12 offset:22528
    s_waitcnt lgkmcnt(6)
    v_mfma_f32_16x16x32_bf16 v[16:19], a[76:79], v[60:63], v[16:19]
    v_mfma_f32_16x16x32_bf16 v[20:23], a[156:159], v[60:63], v[20:23]
    v_mfma_f32_16x16x32_bf16 v[24:27], a[236:239], v[60:63], v[24:27]
    v_mfma_f32_16x16x32_bf16 v[28:31], v[252:255], v[60:63], v[28:31]
    ds_read_b128 v[56:59], v11 offset:23552
    s_waitcnt lgkmcnt(6)
    v_mfma_f32_16x16x32_bf16 v[32:35], a[0:3], v[64:67], 0
    v_mfma_f32_16x16x32_bf16 v[36:39], a[80:83], v[64:67], 0
    v_mfma_f32_16x16x32_bf16 v[40:43], a[160:163], v[64:67], 0
    v_mfma_f32_16x16x32_bf16 v[44:47], a[240:243], v[64:67], 0
    ds_read_b128 v[60:63], v12 offset:23552
    s_waitcnt lgkmcnt(6)
    v_mfma_f32_16x16x32_bf16 v[32:35], a[4:7], v[68:71], v[32:35]
    v_mfma_f32_16x16x32_bf16 v[36:39], a[84:87], v[68:71], v[36:39]
    v_mfma_f32_16x16x32_bf16 v[40:43], a[164:167], v[68:71], v[40:43]
    v_mfma_f32_16x16x32_bf16 v[44:47], a[244:247], v[68:71], v[44:47]
    ds_read_b128 v[64:67], v11 offset:24576
    s_waitcnt lgkmcnt(6)
    v_mfma_f32_16x16x32_bf16 v[32:35], a[8:11], v[72:75], v[32:35]
    v_mfma_f32_16x16x32_bf16 v[36:39], a[88:91], v[72:75], v[36:39]
    v_cvt_pk_bf16_f32 v80, v16, v17
    v_mfma_f32_16x16x32_bf16 v[40:43], a[168:171], v[72:75], v[40:43]
    v_cvt_pk_bf16_f32 v81, v18, v19
    v_mfma_f32_16x16x32_bf16 v[44:47], a[248:251], v[72:75], v[44:47]
    v_cvt_pk_bf16_f32 v82, v20, v21
    ds_read_b128 v[68:71], v12 offset:24576
    s_waitcnt lgkmcnt(6)
    v_mfma_f32_16x16x32_bf16 v[32:35], a[12:15], v[76:79], v[32:35]
    v_cvt_pk_bf16_f32 v83, v22, v23
    v_mfma_f32_16x16x32_bf16 v[36:39], a[92:95], v[76:79], v[36:39]
    buffer_store_dwordx4 v[80:83], v6, s[4:7], s76 offen sc1
    v_mfma_f32_16x16x32_bf16 v[40:43], a[172:175], v[76:79], v[40:43]
    v_cvt_pk_bf16_f32 v84, v24, v25
    v_mfma_f32_16x16x32_bf16 v[44:47], a[252:255], v[76:79], v[44:47]
    v_cvt_pk_bf16_f32 v85, v26, v27
    ds_read_b128 v[72:75], v11 offset:25600
    s_waitcnt lgkmcnt(6)
    v_mfma_f32_16x16x32_bf16 v[32:35], a[16:19], v[48:51], v[32:35]
    v_cvt_pk_bf16_f32 v86, v28, v29
    v_mfma_f32_16x16x32_bf16 v[36:39], a[96:99], v[48:51], v[36:39]
    v_cvt_pk_bf16_f32 v87, v30, v31
    v_mfma_f32_16x16x32_bf16 v[40:43], a[176:179], v[48:51], v[40:43]
    buffer_store_dwordx4 v[84:87], v7, s[4:7], s76 offen sc1
    v_mfma_f32_16x16x32_bf16 v[44:47], v[192:195], v[48:51], v[44:47]
    ds_read_b128 v[76:79], v12 offset:25600
    s_waitcnt lgkmcnt(6)
    v_mfma_f32_16x16x32_bf16 v[32:35], a[20:23], v[52:55], v[32:35]
    v_mfma_f32_16x16x32_bf16 v[36:39], a[100:103], v[52:55], v[36:39]
    v_mfma_f32_16x16x32_bf16 v[40:43], a[180:183], v[52:55], v[40:43]
    v_mfma_f32_16x16x32_bf16 v[44:47], v[196:199], v[52:55], v[44:47]
    ds_read_b128 v[48:51], v11 offset:26624
    s_waitcnt lgkmcnt(6)
    v_mfma_f32_16x16x32_bf16 v[32:35], a[24:27], v[56:59], v[32:35]
    v_mfma_f32_16x16x32_bf16 v[36:39], a[104:107], v[56:59], v[36:39]
    v_mfma_f32_16x16x32_bf16 v[40:43], a[184:187], v[56:59], v[40:43]
    v_mfma_f32_16x16x32_bf16 v[44:47], v[200:203], v[56:59], v[44:47]
    ds_read_b128 v[52:55], v12 offset:26624
    s_waitcnt lgkmcnt(6)
    v_mfma_f32_16x16x32_bf16 v[32:35], a[28:31], v[60:63], v[32:35]
    v_mfma_f32_16x16x32_bf16 v[36:39], a[108:111], v[60:63], v[36:39]
    v_mfma_f32_16x16x32_bf16 v[40:43], a[188:191], v[60:63], v[40:43]
    v_mfma_f32_16x16x32_bf16 v[44:47], v[204:207], v[60:63], v[44:47]
    ds_read_b128 v[56:59], v11 offset:27648
    s_waitcnt lgkmcnt(6)
    v_mfma_f32_16x16x32_bf16 v[32:35], a[32:35], v[64:67], v[32:35]
    v_mfma_f32_16x16x32_bf16 v[36:39], a[112:115], v[64:67], v[36:39]
    v_mfma_f32_16x16x32_bf16 v[40:43], a[192:195], v[64:67], v[40:43]
    v_mfma_f32_16x16x32_bf16 v[44:47], v[208:211], v[64:67], v[44:47]
    ds_read_b128 v[60:63], v12 offset:27648
    s_waitcnt lgkmcnt(6)
    v_mfma_f32_16x16x32_bf16 v[32:35], a[36:39], v[68:71], v[32:35]
    v_mfma_f32_16x16x32_bf16 v[36:39], a[116:119], v[68:71], v[36:39]
    v_mfma_f32_16x16x32_bf16 v[40:43], a[196:199], v[68:71], v[40:43]
    v_mfma_f32_16x16x32_bf16 v[44:47], v[212:215], v[68:71], v[44:47]
    ds_read_b128 v[64:67], v11 offset:28672
    s_waitcnt lgkmcnt(6)
    v_mfma_f32_16x16x32_bf16 v[32:35], a[40:43], v[72:75], v[32:35]
    v_mfma_f32_16x16x32_bf16 v[36:39], a[120:123], v[72:75], v[36:39]
    v_mfma_f32_16x16x32_bf16 v[40:43], a[200:203], v[72:75], v[40:43]
    v_mfma_f32_16x16x32_bf16 v[44:47], v[216:219], v[72:75], v[44:47]
    ds_read_b128 v[68:71], v12 offset:28672
    s_waitcnt lgkmcnt(6)
    v_mfma_f32_16x16x32_bf16 v[32:35], a[44:47], v[76:79], v[32:35]
    v_mfma_f32_16x16x32_bf16 v[36:39], a[124:127], v[76:79], v[36:39]
    v_mfma_f32_16x16x32_bf16 v[40:43], a[204:207], v[76:79], v[40:43]
    v_mfma_f32_16x16x32_bf16 v[44:47], v[220:223], v[76:79], v[44:47]
    ds_read_b128 v[72:75], v11 offset:29696
    s_waitcnt lgkmcnt(6)
    v_mfma_f32_16x16x32_bf16 v[32:35], a[48:51], v[48:51], v[32:35]
    v_mfma_f32_16x16x32_bf16 v[36:39], a[128:131], v[48:51], v[36:39]
    v_mfma_f32_16x16x32_bf16 v[40:43], a[208:211], v[48:51], v[40:43]
    v_mfma_f32_16x16x32_bf16 v[44:47], v[224:227], v[48:51], v[44:47]
    ds_read_b128 v[76:79], v12 offset:29696
    s_waitcnt lgkmcnt(6)
    v_mfma_f32_16x16x32_bf16 v[32:35], a[52:55], v[52:55], v[32:35]
    v_mfma_f32_16x16x32_bf16 v[36:39], a[132:135], v[52:55], v[36:39]
    v_mfma_f32_16x16x32_bf16 v[40:43], a[212:215], v[52:55], v[40:43]
    v_mfma_f32_16x16x32_bf16 v[44:47], v[228:231], v[52:55], v[44:47]
    s_sub_u32 s84, s77, 2
    s_cmp_ge_u32 s77, 12
    s_cbranch_scc1 L_proj_len
    s_mov_b32 s84, s77
    s_waitcnt vmcnt(2)
L_proj_len:
    s_waitcnt vmcnt(18)
    s_barrier
    ds_read_b128 v[48:51], v90 offset:0
    s_waitcnt lgkmcnt(6)
    v_mfma_f32_16x16x32_bf16 v[32:35], a[56:59], v[56:59], v[32:35]
    v_mfma_f32_16x16x32_bf16 v[36:39], a[136:139], v[56:59], v[36:39]
    v_mfma_f32_16x16x32_bf16 v[40:43], a[216:219], v[56:59], v[40:43]
    v_mfma_f32_16x16x32_bf16 v[44:47], v[232:235], v[56:59], v[44:47]
    ds_read_b128 v[52:55], v91 offset:0
    s_waitcnt lgkmcnt(6)
    v_mfma_f32_16x16x32_bf16 v[32:35], a[60:63], v[60:63], v[32:35]
    v_mfma_f32_16x16x32_bf16 v[36:39], a[140:143], v[60:63], v[36:39]
    s_max_u32 s85, s85, s84
    s_cmp_eq_u32 s24, 0
    s_cbranch_scc0 L_proj_nopub
    v_mov_b32 v13, s85
    s_mov_b64 exec, 1
    buffer_store_dword v13, v10, s[4:7], 0 offen offset:0 sc1
    s_mov_b64 exec, -1
L_proj_nopub:
    v_mfma_f32_16x16x32_bf16 v[40:43], a[220:223], v[60:63], v[40:43]
    v_mfma_f32_16x16x32_bf16 v[44:47], v[236:239], v[60:63], v[44:47]
    ds_read_b128 v[56:59], v90 offset:1024
    s_waitcnt lgkmcnt(6)
    v_mfma_f32_16x16x32_bf16 v[32:35], a[64:67], v[64:67], v[32:35]
    v_mfma_f32_16x16x32_bf16 v[36:39], a[144:147], v[64:67], v[36:39]
    s_mov_b32 s81, s76
    s_add_u32 s76, s76, 393216
    v_mfma_f32_16x16x32_bf16 v[40:43], a[224:227], v[64:67], v[40:43]
    s_add_u32 s78, s78, 40960
    s_add_u32 s79, s79, 40960
    v_mfma_f32_16x16x32_bf16 v[44:47], v[240:243], v[64:67], v[44:47]
    s_cmp_eq_u32 s79, 163840
    s_cselect_b32 s79, 0, s79
    ds_read_b128 v[60:63], v91 offset:1024
    s_waitcnt lgkmcnt(6)
    v_mfma_f32_16x16x32_bf16 v[32:35], a[68:71], v[68:71], v[32:35]
    v_mfma_f32_16x16x32_bf16 v[36:39], a[148:151], v[68:71], v[36:39]
    s_add_u32 s80, s30, s79
    s_add_u32 s82, s82, 40960
    v_mfma_f32_16x16x32_bf16 v[40:43], a[228:231], v[68:71], v[40:43]
    s_cmp_eq_u32 s82, 163840
    s_cselect_b32 s82, 0, s82
    v_mfma_f32_16x16x32_bf16 v[44:47], v[244:247], v[68:71], v[44:47]
    ds_read_b128 v[64:67], v90 offset:2048
    s_waitcnt lgkmcnt(6)
    v_mfma_f32_16x16x32_bf16 v[32:35], a[72:75], v[72:75], v[32:35]
    v_mfma_f32_16x16x32_bf16 v[36:39], a[152:155], v[72:75], v[36:39]
    v_mfma_f32_16x16x32_bf16 v[40:43], a[232:235], v[72:75], v[40:43]
    v_mfma_f32_16x16x32_bf16 v[44:47], v[248:251], v[72:75], v[44:47]
    ds_read_b128 v[68:71], v91 offset:2048
    s_waitcnt lgkmcnt(6)
    v_mfma_f32_16x16x32_bf16 v[32:35], a[76:79], v[76:79], v[32:35]
    v_mfma_f32_16x16x32_bf16 v[36:39], a[156:159], v[76:79], v[36:39]
    v_mov_b32 v11, v90
    v_mov_b32 v12, v91
    v_mfma_f32_16x16x32_bf16 v[40:43], a[236:239], v[76:79], v[40:43]
    v_add_u32 v90, s82, v88
    v_add_u32 v91, s82, v89
    v_mfma_f32_16x16x32_bf16 v[44:47], v[252:255], v[76:79], v[44:47]
    s_add_u32 s77, s77, 1
    s_sub_u32 s28, s77, 3
    s_cmp_lt_u32 s28, 61
    s_cbranch_scc1 L_proj_loop
    s_nop 7
    v_cvt_pk_bf16_f32 v80, v32, v33
    v_cvt_pk_bf16_f32 v81, v34, v35
    v_cvt_pk_bf16_f32 v82, v36, v37
    v_cvt_pk_bf16_f32 v83, v38, v39
    buffer_store_dwordx4 v[80:83], v8, s[4:7], s81 offen sc1
    v_cvt_pk_bf16_f32 v84, v40, v41
    v_cvt_pk_bf16_f32 v85, v42, v43
    v_cvt_pk_bf16_f32 v86, v44, v45
    v_cvt_pk_bf16_f32 v87, v46, v47
    buffer_store_dwordx4 v[84:87], v9, s[4:7], s81 offen sc1
    s_mov_b32 s85, s77
    s_waitcnt vmcnt(0)
    s_barrier
    s_cmp_eq_u32 s24, 0
    s_cbranch_scc0 L_proj_done
    v_mov_b32 v13, s77
    s_mov_b64 exec, 1
    buffer_store_dword v13, v10, s[4:7], 0 offen offset:0 sc1
    s_mov_b64 exec, -1
L_proj_done:
    s_cmp_lt_u32 s77, 64
    s_cbranch_scc1 L_proj_loop
    s_waitcnt lgkmcnt(0)
    s_branch L_xo
L_pu:
    s_lshl_b32 s75, s26, 3
    s_add_u32 s75, s75, s25
    s_sub_u32 s75, s75, 18
    s_mov_b32 s12, s46
    s_mov_b32 s13, s47
    s_mov_b32 s14, 7864320
    s_mov_b32 s15, 0x20000
    s_mul_i32 s30, s24, 10240
    s_mul_i32 s74, s75, 245760
    s_add_u32 s74, s74, s30
    v_add_u32 v3, 0, v1
    v_mul_u32_u24 v4, 52429, v3
    v_lshrrev_b32 v4, 22, v4
    v_lshlrev_b32 v4, 1, v4
    v_add_u32 v5, v4, v4
    v_add_u32 v5, v5, v5
    v_xor_b32 v3, v3, v4
    v_lshlrev_b32 v16, 4, v3
    v_add_u32 v3, 64, v1
    v_mul_u32_u24 v4, 52429, v3
    v_lshrrev_b32 v4, 22, v4
    v_lshlrev_b32 v4, 1, v4
    v_add_u32 v5, v4, v4
    v_add_u32 v5, v5, v5
    v_xor_b32 v3, v3, v4
    v_lshlrev_b32 v17, 4, v3
    v_add_u32 v3, 128, v1
    v_mul_u32_u24 v4, 52429, v3
    v_lshrrev_b32 v4, 22, v4
    v_lshlrev_b32 v4, 1, v4
    v_add_u32 v5, v4, v4
    v_add_u32 v5, v5, v5
    v_xor_b32 v3, v3, v4
    v_lshlrev_b32 v18, 4, v3
    v_add_u32 v3, 192, v1
    v_mul_u32_u24 v4, 52429, v3
    v_lshrrev_b32 v4, 22, v4
    v_lshlrev_b32 v4, 1, v4
    v_add_u32 v5, v4, v4
    v_add_u32 v5, v5, v5
    v_xor_b32 v3, v3, v4
    v_lshlrev_b32 v19, 4, v3
    v_add_u32 v3, 256, v1
    v_mul_u32_u24 v4, 52429, v3
    v_lshrrev_b32 v4, 22, v4
    v_lshlrev_b32 v4, 1, v4
    v_add_u32 v5, v4, v4
    v_add_u32 v5, v5, v5
    v_xor_b32 v3, v3, v4
    v_lshlrev_b32 v20, 4, v3
    v_add_u32 v3, 320, v1
    v_mul_u32_u24 v4, 52429, v3
    v_lshrrev_b32 v4, 22, v4
    v_lshlrev_b32 v4, 1, v4
    v_add_u32 v5, v4, v4
    v_add_u32 v5, v5, v5
    v_xor_b32 v3, v3, v4
    v_lshlrev_b32 v21, 4, v3
    v_add_u32 v3, 384, v1
    v_mul_u32_u24 v4, 52429, v3
    v_lshrrev_b32 v4, 22, v4
    v_lshlrev_b32 v4, 1, v4
    v_add_u32 v5, v4, v4
    v_add_u32 v5, v5, v5
    v_xor_b32 v3, v3, v4
    v_lshlrev_b32 v22, 4, v3
    v_add_u32 v3, 448, v1
    v_mul_u32_u24 v4, 52429, v3
    v_lshrrev_b32 v4, 22, v4
    v_lshlrev_b32 v4, 1, v4
    v_add_u32 v5, v4, v4
    v_add_u32 v5, v5, v5
    v_xor_b32 v3, v3, v4
    v_lshlrev_b32 v23, 4, v3
    v_add_u32 v3, 512, v1
    v_mul_u32_u24 v4, 52429, v3
    v_lshrrev_b32 v4, 22, v4
    v_lshlrev_b32 v4, 1, v4
    v_add_u32 v5, v4, v4
    v_add_u32 v5, v5, v5
    v_xor_b32 v3, v3, v4
    v_lshlrev_b32 v24, 4, v3
    v_add_u32 v3, 576, v1
    v_mul_u32_u24 v4, 52429, v3
    v_lshrrev_b32 v4, 22, v4
    v_lshlrev_b32 v4, 1, v4
    v_add_u32 v5, v4, v4
    v_add_u32 v5, v5, v5
    v_xor_b32 v3, v3, v4
    v_lshlrev_b32 v25, 4, v3
    v_lshrrev_b32 v4, 4, v1
    v_lshlrev_b32 v4, 2, v4
    v_bfe_u32 v5, v1, 2, 2
    v_add_u32 v4, v4, v5
    v_mul_u32_u24 v4, 1280, v4
    v_and_b32 v5, 3, v1
    v_lshl_add_u32 v4, v5, 3, v4
    v_bfe_u32 v5, v1, 2, 3
    s_mul_i32 s28, s24, 10
    s_add_u32 s29, s28, 0
    v_xor_b32 v3, s29, v5
    v_lshl_add_u32 v26, v3, 5, v4
    s_add_u32 s29, s28, 1
    v_xor_b32 v3, s29, v5
    v_lshl_add_u32 v27, v3, 5, v4
    s_add_u32 s29, s28, 2
    v_xor_b32 v3, s29, v5
    v_lshl_add_u32 v28, v3, 5, v4
    s_add_u32 s29, s28, 3
    v_xor_b32 v3, s29, v5
    v_lshl_add_u32 v29, v3, 5, v4
    s_add_u32 s29, s28, 4
    v_xor_b32 v3, s29, v5
    v_lshl_add_u32 v30, v3, 5, v4
    s_add_u32 s29, s28, 5
    v_xor_b32 v3, s29, v5
    v_lshl_add_u32 v31, v3, 5, v4
    s_add_u32 s29, s28, 6
    v_xor_b32 v3, s29, v5
    v_lshl_add_u32 v32, v3, 5, v4
    s_add_u32 s29, s28, 7
    v_xor_b32 v3, s29, v5
    v_lshl_add_u32 v33, v3, 5, v4
    s_add_u32 s29, s28, 8
    v_xor_b32 v3, s29, v5
    v_lshl_add_u32 v34, v3, 5, v4
    s_add_u32 s29, s28, 9
    v_xor_b32 v3, s29, v5
    v_lshl_add_u32 v35, v3, 5, v4
    s_add_u32 s31, s74, 0
    s_add_u32 m0, s30, 0
    s_nop 0
    buffer_load_dwordx4 v16, s[12:15], s31 offen lds
    s_add_u32 m0, s30, 1024
    s_nop 0
    buffer_load_dwordx4 v17, s[12:15], s31 offen lds
    s_add_u32 m0, s30, 2048
    s_nop 0
    buffer_load_dwordx4 v18, s[12:15], s31 offen lds
    s_add_u32 m0, s30, 3072
    s_nop 0
    buffer_load_dwordx4 v19, s[12:15], s31 offen lds
    s_add_u32 m0, s30, 4096
    s_nop 0
    buffer_load_dwordx4 v20, s[12:15], s31 offen lds
    s_add_u32 m0, s30, 5120
    s_nop 0
    buffer_load_dwordx4 v21, s[12:15], s31 offen lds
    s_add_u32 m0, s30, 6144
    s_nop 0
    buffer_load_dwordx4 v22, s[12:15], s31 offen lds
    s_add_u32 m0, s30, 7168
    s_nop 0
    buffer_load_dwordx4 v23, s[12:15], s31 offen lds
    s_add_u32 m0, s30, 8192
    s_nop 0
    buffer_load_dwordx4 v24, s[12:15], s31 offen lds
    s_add_u32 m0, s30, 9216
    s_nop 0
    buffer_load_dwordx4 v25, s[12:15], s31 offen lds
    s_add_u32 s31, s74, 40960
    s_add_u32 m0, s30, 40960
    s_nop 0
    buffer_load_dwordx4 v16, s[12:15], s31 offen lds
    s_add_u32 m0, s30, 41984
    s_nop 0
    buffer_load_dwordx4 v17, s[12:15], s31 offen lds
    s_add_u32 m0, s30, 43008
    s_nop 0
    buffer_load_dwordx4 v18, s[12:15], s31 offen lds
    s_add_u32 m0, s30, 44032
    s_nop 0
    buffer_load_dwordx4 v19, s[12:15], s31 offen lds
    s_add_u32 m0, s30, 45056
    s_nop 0
    buffer_load_dwordx4 v20, s[12:15], s31 offen lds
    s_add_u32 m0, s30, 46080
    s_nop 0
    buffer_load_dwordx4 v21, s[12:15], s31 offen lds
    s_add_u32 m0, s30, 47104
    s_nop 0
    buffer_load_dwordx4 v22, s[12:15], s31 offen lds
    s_add_u32 m0, s30, 48128
    s_nop 0
    buffer_load_dwordx4 v23, s[12:15], s31 offen lds
    s_add_u32 m0, s30, 49152
    s_nop 0
    buffer_load_dwordx4 v24, s[12:15], s31 offen lds
    s_add_u32 m0, s30, 50176
    s_nop 0
    buffer_load_dwordx4 v25, s[12:15], s31 offen lds
    s_add_u32 s31, s74, 81920
    s_add_u32 m0, s30, 81920
    s_nop 0
    buffer_load_dwordx4 v16, s[12:15], s31 offen lds
    s_add_u32 m0, s30, 82944
    s_nop 0
    buffer_load_dwordx4 v17, s[12:15], s31 offen lds
    s_add_u32 m0, s30, 83968
    s_nop 0
    buffer_load_dwordx4 v18, s[12:15], s31 offen lds
    s_add_u32 m0, s30, 84992
    s_nop 0
    buffer_load_dwordx4 v19, s[12:15], s31 offen lds
    s_add_u32 m0, s30, 86016
    s_nop 0
    buffer_load_dwordx4 v20, s[12:15], s31 offen lds
    s_add_u32 m0, s30, 87040
    s_nop 0
    buffer_load_dwordx4 v21, s[12:15], s31 offen lds
    s_add_u32 m0, s30, 88064
    s_nop 0
    buffer_load_dwordx4 v22, s[12:15], s31 offen lds
    s_add_u32 m0, s30, 89088
    s_nop 0
    buffer_load_dwordx4 v23, s[12:15], s31 offen lds
    s_add_u32 m0, s30, 90112
    s_nop 0
    buffer_load_dwordx4 v24, s[12:15], s31 offen lds
    s_add_u32 m0, s30, 91136
    s_nop 0
    buffer_load_dwordx4 v25, s[12:15], s31 offen lds
    s_waitcnt vmcnt(20)
    s_barrier
    s_add_u32 s31, s74, 122880
    s_add_u32 m0, s30, 122880
    s_nop 0
    buffer_load_dwordx4 v16, s[12:15], s31 offen lds
    s_add_u32 m0, s30, 123904
    s_nop 0
    buffer_load_dwordx4 v17, s[12:15], s31 offen lds
    s_add_u32 m0, s30, 124928
    s_nop 0
    buffer_load_dwordx4 v18, s[12:15], s31 offen lds
    s_add_u32 m0, s30, 125952
    s_nop 0
    buffer_load_dwordx4 v19, s[12:15], s31 offen lds
    s_add_u32 m0, s30, 126976
    s_nop 0
    buffer_load_dwordx4 v20, s[12:15], s31 offen lds
    s_add_u32 m0, s30, 128000
    s_nop 0
    buffer_load_dwordx4 v21, s[12:15], s31 offen lds
    s_add_u32 m0, s30, 129024
    s_nop 0
    buffer_load_dwordx4 v22, s[12:15], s31 offen lds
    s_add_u32 m0, s30, 130048
    s_nop 0
    buffer_load_dwordx4 v23, s[12:15], s31 offen lds
    s_add_u32 m0, s30, 131072
    s_nop 0
    buffer_load_dwordx4 v24, s[12:15], s31 offen lds
    s_add_u32 m0, s30, 132096
    s_nop 0
    buffer_load_dwordx4 v25, s[12:15], s31 offen lds
    v_add_u32 v3, 0, v26
    ds_read_b64_tr_b16 a[0:1], v3 offset:0
    ds_read_b64_tr_b16 a[2:3], v3 offset:20480
    v_add_u32 v4, 0, v27
    ds_read_b64_tr_b16 a[24:25], v4 offset:0
    ds_read_b64_tr_b16 a[26:27], v4 offset:20480
    v_add_u32 v3, 0, v28
    ds_read_b64_tr_b16 a[48:49], v3 offset:0
    ds_read_b64_tr_b16 a[50:51], v3 offset:20480
    v_add_u32 v4, 0, v29
    ds_read_b64_tr_b16 a[72:73], v4 offset:0
    ds_read_b64_tr_b16 a[74:75], v4 offset:20480
    s_waitcnt lgkmcnt(0)
    v_add_u32 v3, 0, v30
    ds_read_b64_tr_b16 a[96:97], v3 offset:0
    ds_read_b64_tr_b16 a[98:99], v3 offset:20480
    v_add_u32 v4, 0, v31
    ds_read_b64_tr_b16 a[120:121], v4 offset:0
    ds_read_b64_tr_b16 a[122:123], v4 offset:20480
    v_add_u32 v3, 0, v32
    ds_read_b64_tr_b16 a[144:145], v3 offset:0
    ds_read_b64_tr_b16 a[146:147], v3 offset:20480
    v_add_u32 v4, 0, v33
    ds_read_b64_tr_b16 a[168:169], v4 offset:0
    ds_read_b64_tr_b16 a[170:171], v4 offset:20480
    s_waitcnt lgkmcnt(0)
    v_add_u32 v3, 0, v34
    ds_read_b64_tr_b16 a[192:193], v3 offset:0
    ds_read_b64_tr_b16 a[194:195], v3 offset:20480
    v_add_u32 v4, 0, v35
    ds_read_b64_tr_b16 a[216:217], v4 offset:0
    ds_read_b64_tr_b16 a[218:219], v4 offset:20480
    s_waitcnt lgkmcnt(0)
    s_waitcnt vmcnt(20)
    s_barrier
    s_add_u32 s31, s74, 163840
    s_add_u32 m0, s30, 0
    s_nop 0
    buffer_load_dwordx4 v16, s[12:15], s31 offen lds
    s_add_u32 m0, s30, 1024
    s_nop 0
    buffer_load_dwordx4 v17, s[12:15], s31 offen lds
    s_add_u32 m0, s30, 2048
    s_nop 0
    buffer_load_dwordx4 v18, s[12:15], s31 offen lds
    s_add_u32 m0, s30, 3072
    s_nop 0
    buffer_load_dwordx4 v19, s[12:15], s31 offen lds
    s_add_u32 m0, s30, 4096
    s_nop 0
    buffer_load_dwordx4 v20, s[12:15], s31 offen lds
    s_add_u32 m0, s30, 5120
    s_nop 0
    buffer_load_dwordx4 v21, s[12:15], s31 offen lds
    s_add_u32 m0, s30, 6144
    s_nop 0
    buffer_load_dwordx4 v22, s[12:15], s31 offen lds
    s_add_u32 m0, s30, 7168
    s_nop 0
    buffer_load_dwordx4 v23, s[12:15], s31 offen lds
    s_add_u32 m0, s30, 8192
    s_nop 0
    buffer_load_dwordx4 v24, s[12:15], s31 offen lds
    s_add_u32 m0, s30, 9216
    s_nop 0
    buffer_load_dwordx4 v25, s[12:15], s31 offen lds
    v_add_u32 v3, 40960, v26
    ds_read_b64_tr_b16 a[4:5], v3 offset:0
    ds_read_b64_tr_b16 a[6:7], v3 offset:20480
    v_add_u32 v4, 40960, v27
    ds_read_b64_tr_b16 a[28:29], v4 offset:0
    ds_read_b64_tr_b16 a[30:31], v4 offset:20480
    v_add_u32 v3, 40960, v28
    ds_read_b64_tr_b16 a[52:53], v3 offset:0
    ds_read_b64_tr_b16 a[54:55], v3 offset:20480
    v_add_u32 v4, 40960, v29
    ds_read_b64_tr_b16 a[76:77], v4 offset:0
    ds_read_b64_tr_b16 a[78:79], v4 offset:20480
    s_waitcnt lgkmcnt(0)
    v_add_u32 v3, 40960, v30
    ds_read_b64_tr_b16 a[100:101], v3 offset:0
    ds_read_b64_tr_b16 a[102:103], v3 offset:20480
    v_add_u32 v4, 40960, v31
    ds_read_b64_tr_b16 a[124:125], v4 offset:0
    ds_read_b64_tr_b16 a[126:127], v4 offset:20480
    v_add_u32 v3, 40960, v32
    ds_read_b64_tr_b16 a[148:149], v3 offset:0
    ds_read_b64_tr_b16 a[150:151], v3 offset:20480
    v_add_u32 v4, 40960, v33
    ds_read_b64_tr_b16 a[172:173], v4 offset:0
    ds_read_b64_tr_b16 a[174:175], v4 offset:20480
    s_waitcnt lgkmcnt(0)
    v_add_u32 v3, 40960, v34
    ds_read_b64_tr_b16 a[196:197], v3 offset:0
    ds_read_b64_tr_b16 a[198:199], v3 offset:20480
    v_add_u32 v4, 40960, v35
    ds_read_b64_tr_b16 a[220:221], v4 offset:0
    ds_read_b64_tr_b16 a[222:223], v4 offset:20480
    s_waitcnt lgkmcnt(0)
    s_waitcnt vmcnt(20)
    s_barrier
    s_add_u32 s31, s74, 204800
    s_add_u32 m0, s30, 40960
    s_nop 0
    buffer_load_dwordx4 v16, s[12:15], s31 offen lds
    s_add_u32 m0, s30, 41984
    s_nop 0
    buffer_load_dwordx4 v17, s[12:15], s31 offen lds
    s_add_u32 m0, s30, 43008
    s_nop 0
    buffer_load_dwordx4 v18, s[12:15], s31 offen lds
    s_add_u32 m0, s30, 44032
    s_nop 0
    buffer_load_dwordx4 v19, s[12:15], s31 offen lds
    s_add_u32 m0, s30, 45056
    s_nop 0
    buffer_load_dwordx4 v20, s[12:15], s31 offen lds
    s_add_u32 m0, s30, 46080
    s_nop 0
    buffer_load_dwordx4 v21, s[12:15], s31 offen lds
    s_add_u32 m0, s30, 47104
    s_nop 0
    buffer_load_dwordx4 v22, s[12:15], s31 offen lds
    s_add_u32 m0, s30, 48128
    s_nop 0
    buffer_load_dwordx4 v23, s[12:15], s31 offen lds
    s_add_u32 m0, s30, 49152
    s_nop 0
    buffer_load_dwordx4 v24, s[12:15], s31 offen lds
    s_add_u32 m0, s30, 50176
    s_nop 0
    buffer_load_dwordx4 v25, s[12:15], s31 offen lds
    v_add_u32 v3, 81920, v26
    ds_read_b64_tr_b16 a[8:9], v3 offset:0
    ds_read_b64_tr_b16 a[10:11], v3 offset:20480
    v_add_u32 v4, 81920, v27
    ds_read_b64_tr_b16 a[32:33], v4 offset:0
    ds_read_b64_tr_b16 a[34:35], v4 offset:20480
    v_add_u32 v3, 81920, v28
    ds_read_b64_tr_b16 a[56:57], v3 offset:0
    ds_read_b64_tr_b16 a[58:59], v3 offset:20480
    v_add_u32 v4, 81920, v29
    ds_read_b64_tr_b16 a[80:81], v4 offset:0
    ds_read_b64_tr_b16 a[82:83], v4 offset:20480
    s_waitcnt lgkmcnt(0)
    v_add_u32 v3, 81920, v30
    ds_read_b64_tr_b16 a[104:105], v3 offset:0
    ds_read_b64_tr_b16 a[106:107], v3 offset:20480
    v_add_u32 v4, 81920, v31
    ds_read_b64_tr_b16 a[128:129], v4 offset:0
    ds_read_b64_tr_b16 a[130:131], v4 offset:20480
    v_add_u32 v3, 81920, v32
    ds_read_b64_tr_b16 a[152:153], v3 offset:0
    ds_read_b64_tr_b16 a[154:155], v3 offset:20480
    v_add_u32 v4, 81920, v33
    ds_read_b64_tr_b16 a[176:177], v4 offset:0
    ds_read_b64_tr_b16 a[178:179], v4 offset:20480
    s_waitcnt lgkmcnt(0)
    v_add_u32 v3, 81920, v34
    ds_read_b64_tr_b16 a[200:201], v3 offset:0
    ds_read_b64_tr_b16 a[202:203], v3 offset:20480
    v_add_u32 v4, 81920, v35
    ds_read_b64_tr_b16 a[224:225], v4 offset:0
    ds_read_b64_tr_b16 a[226:227], v4 offset:20480
    s_waitcnt lgkmcnt(0)
    s_waitcnt vmcnt(20)
    s_barrier
    v_add_u32 v3, 122880, v26
    ds_read_b64_tr_b16 a[12:13], v3 offset:0
    ds_read_b64_tr_b16 a[14:15], v3 offset:20480
    v_add_u32 v4, 122880, v27
    ds_read_b64_tr_b16 a[36:37], v4 offset:0
    ds_read_b64_tr_b16 a[38:39], v4 offset:20480
    v_add_u32 v3, 122880, v28
    ds_read_b64_tr_b16 a[60:61], v3 offset:0
    ds_read_b64_tr_b16 a[62:63], v3 offset:20480
    v_add_u32 v4, 122880, v29
    ds_read_b64_tr_b16 a[84:85], v4 offset:0
    ds_read_b64_tr_b16 a[86:87], v4 offset:20480
    s_waitcnt lgkmcnt(0)
    v_add_u32 v3, 122880, v30
    ds_read_b64_tr_b16 a[108:109], v3 offset:0
    ds_read_b64_tr_b16 a[110:111], v3 offset:20480
    v_add_u32 v4, 122880, v31
    ds_read_b64_tr_b16 a[132:133], v4 offset:0
    ds_read_b64_tr_b16 a[134:135], v4 offset:20480
    v_add_u32 v3, 122880, v32
    ds_read_b64_tr_b16 a[156:157], v3 offset:0
    ds_read_b64_tr_b16 a[158:159], v3 offset:20480
    v_add_u32 v4, 122880, v33
    ds_read_b64_tr_b16 a[180:181], v4 offset:0
    ds_read_b64_tr_b16 a[182:183], v4 offset:20480
    s_waitcnt lgkmcnt(0)
    v_add_u32 v3, 122880, v34
    ds_read_b64_tr_b16 a[204:205], v3 offset:0
    ds_read_b64_tr_b16 a[206:207], v3 offset:20480
    v_add_u32 v4, 122880, v35
    ds_read_b64_tr_b16 a[228:229], v4 offset:0
    ds_read_b64_tr_b16 a[230:231], v4 offset:20480
    s_waitcnt lgkmcnt(0)
    s_waitcnt vmcnt(10)
    s_barrier
    v_add_u32 v3, 0, v26
    ds_read_b64_tr_b16 a[16:17], v3 offset:0
    ds_read_b64_tr_b16 a[18:19], v3 offset:20480
    v_add_u32 v4, 0, v27
    ds_read_b64_tr_b16 a[40:41], v4 offset:0
    ds_read_b64_tr_b16 a[42:43], v4 offset:20480
    v_add_u32 v3, 0, v28
    ds_read_b64_tr_b16 a[64:65], v3 offset:0
    ds_read_b64_tr_b16 a[66:67], v3 offset:20480
    v_add_u32 v4, 0, v29
    ds_read_b64_tr_b16 a[88:89], v4 offset:0
    ds_read_b64_tr_b16 a[90:91], v4 offset:20480
    s_waitcnt lgkmcnt(0)
    v_add_u32 v3, 0, v30
    ds_read_b64_tr_b16 a[112:113], v3 offset:0
    ds_read_b64_tr_b16 a[114:115], v3 offset:20480
    v_add_u32 v4, 0, v31
    ds_read_b64_tr_b16 a[136:137], v4 offset:0
    ds_read_b64_tr_b16 a[138:139], v4 offset:20480
    v_add_u32 v3, 0, v32
    ds_read_b64_tr_b16 a[160:161], v3 offset:0
    ds_read_b64_tr_b16 a[162:163], v3 offset:20480
    v_add_u32 v4, 0, v33
    ds_read_b64_tr_b16 a[184:185], v4 offset:0
    ds_read_b64_tr_b16 a[186:187], v4 offset:20480
    s_waitcnt lgkmcnt(0)
    v_add_u32 v3, 0, v34
    ds_read_b64_tr_b16 a[208:209], v3 offset:0
    ds_read_b64_tr_b16 a[210:211], v3 offset:20480
    v_add_u32 v4, 0, v35
    ds_read_b64_tr_b16 a[232:233], v4 offset:0
    ds_read_b64_tr_b16 a[234:235], v4 offset:20480
    s_waitcnt lgkmcnt(0)
    s_waitcnt vmcnt(0)
    s_barrier
    v_add_u32 v3, 40960, v26
    ds_read_b64_tr_b16 a[20:21], v3 offset:0
    ds_read_b64_tr_b16 a[22:23], v3 offset:20480
    v_add_u32 v4, 40960, v27
    ds_read_b64_tr_b16 a[44:45], v4 offset:0
    ds_read_b64_tr_b16 a[46:47], v4 offset:20480
    v_add_u32 v3, 40960, v28
    ds_read_b64_tr_b16 a[68:69], v3 offset:0
    ds_read_b64_tr_b16 a[70:71], v3 offset:20480
    v_add_u32 v4, 40960, v29
    ds_read_b64_tr_b16 a[92:93], v4 offset:0
    ds_read_b64_tr_b16 a[94:95], v4 offset:20480
    s_waitcnt lgkmcnt(0)
    v_add_u32 v3, 40960, v30
    ds_read_b64_tr_b16 a[116:117], v3 offset:0
    ds_read_b64_tr_b16 a[118:119], v3 offset:20480
    v_add_u32 v4, 40960, v31
    ds_read_b64_tr_b16 a[140:141], v4 offset:0
    ds_read_b64_tr_b16 a[142:143], v4 offset:20480
    v_add_u32 v3, 40960, v32
    ds_read_b64_tr_b16 a[164:165], v3 offset:0
    ds_read_b64_tr_b16 a[166:167], v3 offset:20480
    v_add_u32 v4, 40960, v33
    ds_read_b64_tr_b16 a[188:189], v4 offset:0
    ds_read_b64_tr_b16 a[190:191], v4 offset:20480
    s_waitcnt lgkmcnt(0)
    v_add_u32 v3, 40960, v34
    ds_read_b64_tr_b16 a[212:213], v3 offset:0
    ds_read_b64_tr_b16 a[214:215], v3 offset:20480
    v_add_u32 v4, 40960, v35
    ds_read_b64_tr_b16 a[236:237], v4 offset:0
    ds_read_b64_tr_b16 a[238:239], v4 offset:20480
    s_waitcnt lgkmcnt(0)
    s_mul_i32 s28, s75, 12288
    s_add_u32 s28, s28, 50331648
    v_add_u32 v6, s28, v2
    v_add_u32 v7, 4096, v6
    v_add_u32 v8, 8192, v6
    s_lshl_b32 s28, s75, 10
    s_mul_i32 s29, s24, 327680
    s_add_u32 s28, s28, s29
    v_add_u32 v9, s28, v2
    s_lshl_b32 s28, s75, 7
    s_add_u32 s28, s28, 192422912
    v_mov_b32 v10, s28
    v_and_b32 v4, 3, v1
    v_lshlrev_b32 v4, 2, v4
    v_bfe_u32 v5, v1, 2, 1
    v_lshl_add_u32 v4, v5, 7, v4
    v_cmp_lt_u32 vcc, 7, v1
    v_mov_b32 v5, 16
    s_nop 0
    v_cndmask_b32 v4, v4, v5, vcc
L_pu_st:
    buffer_load_dword v5, v4, s[8:11], 0 offen sc1
    s_waitcnt vmcnt(0)
    v_cmp_gt_u32 vcc, 32, v5
    v_readlane_b32 s28, v5, 8
    s_cbranch_vccnz L_pu_st_no
    s_cmp_ge_u32 s28, 64
    s_cbranch_scc1 L_pu_st_ok
L_pu_st_no:
    s_sleep 4
    s_sub_u32 s27, s27, 1
    s_cbranch_scc1 L_fail
    s_branch L_pu_st
L_pu_st_ok:
    s_mul_i32 s28, s75, 6
    v_and_b32 v11, 1, v1
    v_mul_u32_u24 v11, 5, v11
    v_add_u32 v11, s28, v11
    v_lshrrev_b32 v11, 3, v11
    v_lshlrev_b32 v11, 7, v11
    v_add_u32 v11, 192419840, v11
    s_mov_b32 s77, 0
    s_mov_b32 s76, 0
    s_mov_b32 s78, 75497472
    s_mov_b32 s79, 0
    s_mov_b32 s80, 1
    s_cmp_ge_u32 s79, s80
    s_cbranch_scc1 L_pu_w0_ok
L_pu_w0:
    buffer_load_dword v12, v11, s[4:7], 0 offen sc1
    s_waitcnt vmcnt(0)
    s_nop 1
    v_min_u32_dpp v12, v12, v12 row_shr:1 row_mask:0xf bank_mask:0xf
    s_nop 1
    v_min_u32_dpp v12, v12, v12 row_shr:2 row_mask:0xf bank_mask:0xf
    s_nop 1
    v_min_u32_dpp v12, v12, v12 row_shr:4 row_mask:0xf bank_mask:0xf
    s_nop 1
    v_min_u32_dpp v12, v12, v12 row_shr:8 row_mask:0xf bank_mask:0xf
    s_nop 1
    v_min_u32_dpp v12, v12, v12 row_bcast:15 row_mask:0xa bank_mask:0xf
    s_nop 1
    v_min_u32_dpp v12, v12, v12 row_bcast:31 row_mask:0xc bank_mask:0xf
    s_nop 0
    v_readlane_b32 s79, v12, 63
    s_nop 3
    s_cmp_ge_u32 s79, s80
    s_cbranch_scc1 L_pu_w0_ok
    s_sub_u32 s27, s27, 1
    s_cbranch_scc1 L_fail
    s_branch L_pu_w0
L_pu_w0_ok:
    buffer_load_dwordx4 v[32:35], v6, s[4:7], s76 offen offset:0 sc1
    buffer_load_dwordx4 v[36:39], v6, s[4:7], s76 offen offset:1024 sc1
    buffer_load_dwordx4 v[40:43], v6, s[4:7], s76 offen offset:2048 sc1
    buffer_load_dwordx4 v[44:47], v6, s[4:7], s76 offen offset:3072 sc1
    buffer_load_dwordx4 v[48:51], v7, s[4:7], s76 offen offset:0 sc1
    buffer_load_dwordx4 v[52:55], v7, s[4:7], s76 offen offset:1024 sc1
    buffer_load_dwordx4 v[56:59], v7, s[4:7], s76 offen offset:2048 sc1
    buffer_load_dwordx4 v[60:63], v7, s[4:7], s76 offen offset:3072 sc1
    buffer_load_dwordx4 v[64:67], v8, s[4:7], s76 offen offset:0 sc1
    buffer_load_dwordx4 v[68:71], v8, s[4:7], s76 offen offset:1024 sc1
    buffer_load_dwordx4 v[72:75], v8, s[4:7], s76 offen offset:2048 sc1
    buffer_load_dwordx4 v[76:79], v8, s[4:7], s76 offen offset:3072 sc1
    s_add_u32 s76, s76, 393216
    s_waitcnt vmcnt(0)
L_pu_loop:
    s_add_u32 s80, s77, 2
    s_min_u32 s80, s80, 64
    s_mov_b32 s82, 0
    s_cmp_ge_u32 s79, s80
    s_cbranch_scc0 L_pu_nopf0
    s_mov_b32 s82, 1
    buffer_load_dwordx4 v[80:83], v6, s[4:7], s76 offen offset:0 sc1
    buffer_load_dwordx4 v[84:87], v6, s[4:7], s76 offen offset:1024 sc1
    buffer_load_dwordx4 v[88:91], v6, s[4:7], s76 offen offset:2048 sc1
    buffer_load_dwordx4 v[92:95], v6, s[4:7], s76 offen offset:3072 sc1
    buffer_load_dwordx4 v[96:99], v7, s[4:7], s76 offen offset:0 sc1
    buffer_load_dwordx4 v[100:103], v7, s[4:7], s76 offen offset:1024 sc1
    buffer_load_dwordx4 v[104:107], v7, s[4:7], s76 offen offset:2048 sc1
    buffer_load_dwordx4 v[108:111], v7, s[4:7], s76 offen offset:3072 sc1
    buffer_load_dwordx4 v[112:115], v8, s[4:7], s76 offen offset:0 sc1
    buffer_load_dwordx4 v[116:119], v8, s[4:7], s76 offen offset:1024 sc1
    buffer_load_dwordx4 v[120:123], v8, s[4:7], s76 offen offset:2048 sc1
    buffer_load_dwordx4 v[124:127], v8, s[4:7], s76 offen offset:3072 sc1
    s_add_u32 s76, s76, 393216
L_pu_nopf0:
    buffer_load_dword v12, v11, s[4:7], 0 offen sc1
    v_mfma_f32_16x16x32_bf16 v[128:131], v[32:35], a[0:3], 0
    v_mfma_f32_16x16x32_bf16 v[132:135], v[56:59], a[0:3], 0
    v_mfma_f32_16x16x32_bf16 v[128:131], v[36:39], a[4:7], v[128:131]
    v_mfma_f32_16x16x32_bf16 v[132:135], v[60:63], a[4:7], v[132:135]
    v_mfma_f32_16x16x32_bf16 v[128:131], v[40:43], a[8:11], v[128:131]
    v_mfma_f32_16x16x32_bf16 v[132:135], v[64:67], a[8:11], v[132:135]
    v_mfma_f32_16x16x32_bf16 v[128:131], v[44:47], a[12:15], v[128:131]
    v_mfma_f32_16x16x32_bf16 v[132:135], v[68:71], a[12:15], v[132:135]
    v_mfma_f32_16x16x32_bf16 v[128:131], v[48:51], a[16:19], v[128:131]
    v_mfma_f32_16x16x32_bf16 v[132:135], v[72:75], a[16:19], v[132:135]
    v_mfma_f32_16x16x32_bf16 v[128:131], v[52:55], a[20:23], v[128:131]
    v_mfma_f32_16x16x32_bf16 v[132:135], v[76:79], a[20:23], v[132:135]
    v_mfma_f32_16x16x32_bf16 v[136:139], v[32:35], a[24:27], 0
    v_mfma_f32_16x16x32_bf16 v[140:143], v[56:59], a[24:27], 0
    v_mfma_f32_16x16x32_bf16 v[136:139], v[36:39], a[28:31], v[136:139]
    v_mfma_f32_16x16x32_bf16 v[140:143], v[60:63], a[28:31], v[140:143]
    v_mfma_f32_16x16x32_bf16 v[136:139], v[40:43], a[32:35], v[136:139]
    v_mfma_f32_16x16x32_bf16 v[140:143], v[64:67], a[32:35], v[140:143]
    v_mfma_f32_16x16x32_bf16 v[136:139], v[44:47], a[36:39], v[136:139]
    v_mfma_f32_16x16x32_bf16 v[140:143], v[68:71], a[36:39], v[140:143]
    v_cvt_pk_bf16_f32 v144, v128, v129
    v_cvt_pk_bf16_f32 v145, v130, v131
    v_mfma_f32_16x16x32_bf16 v[136:139], v[48:51], a[40:43], v[136:139]
    v_cvt_pk_bf16_f32 v146, v132, v133
    v_cvt_pk_bf16_f32 v147, v134, v135
    v_mfma_f32_16x16x32_bf16 v[140:143], v[72:75], a[40:43], v[140:143]
    s_add_u32 s81, s78, 0
    buffer_store_dwordx4 v[144:147], v9, s[4:7], s81 offen sc1
    v_mfma_f32_16x16x32_bf16 v[136:139], v[52:55], a[44:47], v[136:139]
    v_mfma_f32_16x16x32_bf16 v[140:143], v[76:79], a[44:47], v[140:143]
    v_mfma_f32_16x16x32_bf16 v[128:131], v[32:35], a[48:51], 0
    v_mfma_f32_16x16x32_bf16 v[132:135], v[56:59], a[48:51], 0
    v_mfma_f32_16x16x32_bf16 v[128:131], v[36:39], a[52:55], v[128:131]
    v_mfma_f32_16x16x32_bf16 v[132:135], v[60:63], a[52:55], v[132:135]
    v_mfma_f32_16x16x32_bf16 v[128:131], v[40:43], a[56:59], v[128:131]
    v_mfma_f32_16x16x32_bf16 v[132:135], v[64:67], a[56:59], v[132:135]
    v_mfma_f32_16x16x32_bf16 v[128:131], v[44:47], a[60:63], v[128:131]
    v_mfma_f32_16x16x32_bf16 v[132:135], v[68:71], a[60:63], v[132:135]
    v_cvt_pk_bf16_f32 v148, v136, v137
    v_cvt_pk_bf16_f32 v149, v138, v139
    v_mfma_f32_16x16x32_bf16 v[128:131], v[48:51], a[64:67], v[128:131]
    v_cvt_pk_bf16_f32 v150, v140, v141
    v_cvt_pk_bf16_f32 v151, v142, v143
    v_mfma_f32_16x16x32_bf16 v[132:135], v[72:75], a[64:67], v[132:135]
    s_add_u32 s81, s78, 32768
    buffer_store_dwordx4 v[148:151], v9, s[4:7], s81 offen sc1
    v_mfma_f32_16x16x32_bf16 v[128:131], v[52:55], a[68:71], v[128:131]
    v_mfma_f32_16x16x32_bf16 v[132:135], v[76:79], a[68:71], v[132:135]
    v_mfma_f32_16x16x32_bf16 v[136:139], v[32:35], a[72:75], 0
    v_mfma_f32_16x16x32_bf16 v[140:143], v[56:59], a[72:75], 0
    v_mfma_f32_16x16x32_bf16 v[136:139], v[36:39], a[76:79], v[136:139]
    v_mfma_f32_16x16x32_bf16 v[140:143], v[60:63], a[76:79], v[140:143]
    v_mfma_f32_16x16x32_bf16 v[136:139], v[40:43], a[80:83], v[136:139]
    v_mfma_f32_16x16x32_bf16 v[140:143], v[64:67], a[80:83], v[140:143]
    v_mfma_f32_16x16x32_bf16 v[136:139], v[44:47], a[84:87], v[136:139]
    v_mfma_f32_16x16x32_bf16 v[140:143], v[68:71], a[84:87], v[140:143]
    v_cvt_pk_bf16_f32 v144, v128, v129
    v_cvt_pk_bf16_f32 v145, v130, v131
    v_mfma_f32_16x16x32_bf16 v[136:139], v[48:51], a[88:91], v[136:139]
    v_cvt_pk_bf16_f32 v146, v132, v133
    v_cvt_pk_bf16_f32 v147, v134, v135
    v_mfma_f32_16x16x32_bf16 v[140:143], v[72:75], a[88:91], v[140:143]
    s_add_u32 s81, s78, 65536
    buffer_store_dwordx4 v[144:147], v9, s[4:7], s81 offen sc1
    v_mfma_f32_16x16x32_bf16 v[136:139], v[52:55], a[92:95], v[136:139]
    v_mfma_f32_16x16x32_bf16 v[140:143], v[76:79], a[92:95], v[140:143]
    v_mfma_f32_16x16x32_bf16 v[128:131], v[32:35], a[96:99], 0
    v_mfma_f32_16x16x32_bf16 v[132:135], v[56:59], a[96:99], 0
    v_mfma_f32_16x16x32_bf16 v[128:131], v[36:39], a[100:103], v[128:131]
    v_mfma_f32_16x16x32_bf16 v[132:135], v[60:63], a[100:103], v[132:135]
    v_mfma_f32_16x16x32_bf16 v[128:131], v[40:43], a[104:107], v[128:131]
    v_mfma_f32_16x16x32_bf16 v[132:135], v[64:67], a[104:107], v[132:135]
    v_mfma_f32_16x16x32_bf16 v[128:131], v[44:47], a[108:111], v[128:131]
    v_mfma_f32_16x16x32_bf16 v[132:135], v[68:71], a[108:111], v[132:135]
    v_cvt_pk_bf16_f32 v148, v136, v137
    v_cvt_pk_bf16_f32 v149, v138, v139
    v_mfma_f32_16x16x32_bf16 v[128:131], v[48:51], a[112:115], v[128:131]
    v_cvt_pk_bf16_f32 v150, v140, v141
    v_cvt_pk_bf16_f32 v151, v142, v143
    v_mfma_f32_16x16x32_bf16 v[132:135], v[72:75], a[112:115], v[132:135]
    s_add_u32 s81, s78, 98304
    buffer_store_dwordx4 v[148:151], v9, s[4:7], s81 offen sc1
    v_mfma_f32_16x16x32_bf16 v[128:131], v[52:55], a[116:119], v[128:131]
    v_mfma_f32_16x16x32_bf16 v[132:135], v[76:79], a[116:119], v[132:135]
    v_mfma_f32_16x16x32_bf16 v[136:139], v[32:35], a[120:123], 0
    v_mfma_f32_16x16x32_bf16 v[140:143], v[56:59], a[120:123], 0
    v_mfma_f32_16x16x32_bf16 v[136:139], v[36:39], a[124:127], v[136:139]
    v_mfma_f32_16x16x32_bf16 v[140:143], v[60:63], a[124:127], v[140:143]
    v_mfma_f32_16x16x32_bf16 v[136:139], v[40:43], a[128:131], v[136:139]
    v_mfma_f32_16x16x32_bf16 v[140:143], v[64:67], a[128:131], v[140:143]
    v_mfma_f32_16x16x32_bf16 v[136:139], v[44:47], a[132:135], v[136:139]
    v_mfma_f32_16x16x32_bf16 v[140:143], v[68:71], a[132:135], v[140:143]
    v_cvt_pk_bf16_f32 v144, v128, v129
    v_cvt_pk_bf16_f32 v145, v130, v131
    v_mfma_f32_16x16x32_bf16 v[136:139], v[48:51], a[136:139], v[136:139]
    v_cvt_pk_bf16_f32 v146, v132, v133
    v_cvt_pk_bf16_f32 v147, v134, v135
    v_mfma_f32_16x16x32_bf16 v[140:143], v[72:75], a[136:139], v[140:143]
    s_add_u32 s81, s78, 131072
    buffer_store_dwordx4 v[144:147], v9, s[4:7], s81 offen sc1
    v_mfma_f32_16x16x32_bf16 v[136:139], v[52:55], a[140:143], v[136:139]
    v_mfma_f32_16x16x32_bf16 v[140:143], v[76:79], a[140:143], v[140:143]
    v_mfma_f32_16x16x32_bf16 v[128:131], v[32:35], a[144:147], 0
    v_mfma_f32_16x16x32_bf16 v[132:135], v[56:59], a[144:147], 0
    v_mfma_f32_16x16x32_bf16 v[128:131], v[36:39], a[148:151], v[128:131]
    v_mfma_f32_16x16x32_bf16 v[132:135], v[60:63], a[148:151], v[132:135]
    v_mfma_f32_16x16x32_bf16 v[128:131], v[40:43], a[152:155], v[128:131]
    v_mfma_f32_16x16x32_bf16 v[132:135], v[64:67], a[152:155], v[132:135]
    v_mfma_f32_16x16x32_bf16 v[128:131], v[44:47], a[156:159], v[128:131]
    v_mfma_f32_16x16x32_bf16 v[132:135], v[68:71], a[156:159], v[132:135]
    v_cvt_pk_bf16_f32 v148, v136, v137
    v_cvt_pk_bf16_f32 v149, v138, v139
    v_mfma_f32_16x16x32_bf16 v[128:131], v[48:51], a[160:163], v[128:131]
    v_cvt_pk_bf16_f32 v150, v140, v141
    v_cvt_pk_bf16_f32 v151, v142, v143
    v_mfma_f32_16x16x32_bf16 v[132:135], v[72:75], a[160:163], v[132:135]
    s_add_u32 s81, s78, 163840
    buffer_store_dwordx4 v[148:151], v9, s[4:7], s81 offen sc1
    v_mfma_f32_16x16x32_bf16 v[128:131], v[52:55], a[164:167], v[128:131]
    v_mfma_f32_16x16x32_bf16 v[132:135], v[76:79], a[164:167], v[132:135]
    v_mfma_f32_16x16x32_bf16 v[136:139], v[32:35], a[168:171], 0
    v_mfma_f32_16x16x32_bf16 v[140:143], v[56:59], a[168:171], 0
    v_mfma_f32_16x16x32_bf16 v[136:139], v[36:39], a[172:175], v[136:139]
    v_mfma_f32_16x16x32_bf16 v[140:143], v[60:63], a[172:175], v[140:143]
    v_mfma_f32_16x16x32_bf16 v[136:139], v[40:43], a[176:179], v[136:139]
    v_mfma_f32_16x16x32_bf16 v[140:143], v[64:67], a[176:179], v[140:143]
    v_mfma_f32_16x16x32_bf16 v[136:139], v[44:47], a[180:183], v[136:139]
    v_mfma_f32_16x16x32_bf16 v[140:143], v[68:71], a[180:183], v[140:143]
    v_cvt_pk_bf16_f32 v144, v128, v129
    v_cvt_pk_bf16_f32 v145, v130, v131
    v_mfma_f32_16x16x32_bf16 v[136:139], v[48:51], a[184:187], v[136:139]
    v_cvt_pk_bf16_f32 v146, v132, v133
    v_cvt_pk_bf16_f32 v147, v134, v135
    v_mfma_f32_16x16x32_bf16 v[140:143], v[72:75], a[184:187], v[140:143]
    s_add_u32 s81, s78, 196608
    buffer_store_dwordx4 v[144:147], v9, s[4:7], s81 offen sc1
    v_mfma_f32_16x16x32_bf16 v[136:139], v[52:55], a[188:191], v[136:139]
    v_mfma_f32_16x16x32_bf16 v[140:143], v[76:79], a[188:191], v[140:143]
    v_mfma_f32_16x16x32_bf16 v[128:131], v[32:35], a[192:195], 0
    v_mfma_f32_16x16x32_bf16 v[132:135], v[56:59], a[192:195], 0
    v_mfma_f32_16x16x32_bf16 v[128:131], v[36:39], a[196:199], v[128:131]
    v_mfma_f32_16x16x32_bf16 v[132:135], v[60:63], a[196:199], v[132:135]
    v_mfma_f32_16x16x32_bf16 v[128:131], v[40:43], a[200:203], v[128:131]
    v_mfma_f32_16x16x32_bf16 v[132:135], v[64:67], a[200:203], v[132:135]
    v_mfma_f32_16x16x32_bf16 v[128:131], v[44:47], a[204:207], v[128:131]
    v_mfma_f32_16x16x32_bf16 v[132:135], v[68:71], a[204:207], v[132:135]
    v_cvt_pk_bf16_f32 v148, v136, v137
    v_cvt_pk_bf16_f32 v149, v138, v139
    v_mfma_f32_16x16x32_bf16 v[128:131], v[48:51], a[208:211], v[128:131]
    v_cvt_pk_bf16_f32 v150, v140, v141
    v_cvt_pk_bf16_f32 v151, v142, v143
    v_mfma_f32_16x16x32_bf16 v[132:135], v[72:75], a[208:211], v[132:135]
    s_add_u32 s81, s78, 229376
    buffer_store_dwordx4 v[148:151], v9, s[4:7], s81 offen sc1
    v_mfma_f32_16x16x32_bf16 v[128:131], v[52:55], a[212:215], v[128:131]
    v_mfma_f32_16x16x32_bf16 v[132:135], v[76:79], a[212:215], v[132:135]
    v_mfma_f32_16x16x32_bf16 v[136:139], v[32:35], a[216:219], 0
    v_mfma_f32_16x16x32_bf16 v[140:143], v[56:59], a[216:219], 0
    v_mfma_f32_16x16x32_bf16 v[136:139], v[36:39], a[220:223], v[136:139]
    v_mfma_f32_16x16x32_bf16 v[140:143], v[60:63], a[220:223], v[140:143]
    v_mfma_f32_16x16x32_bf16 v[136:139], v[40:43], a[224:227], v[136:139]
    v_mfma_f32_16x16x32_bf16 v[140:143], v[64:67], a[224:227], v[140:143]
    v_mfma_f32_16x16x32_bf16 v[136:139], v[44:47], a[228:231], v[136:139]
    v_mfma_f32_16x16x32_bf16 v[140:143], v[68:71], a[228:231], v[140:143]
    v_cvt_pk_bf16_f32 v144, v128, v129
    v_cvt_pk_bf16_f32 v145, v130, v131
    v_mfma_f32_16x16x32_bf16 v[136:139], v[48:51], a[232:235], v[136:139]
    v_cvt_pk_bf16_f32 v146, v132, v133
    v_cvt_pk_bf16_f32 v147, v134, v135
    v_mfma_f32_16x16x32_bf16 v[140:143], v[72:75], a[232:235], v[140:143]
    s_add_u32 s81, s78, 262144
    buffer_store_dwordx4 v[144:147], v9, s[4:7], s81 offen sc1
    v_mfma_f32_16x16x32_bf16 v[136:139], v[52:55], a[236:239], v[136:139]
    v_mfma_f32_16x16x32_bf16 v[140:143], v[76:79], a[236:239], v[140:143]
    s_nop 7
    s_nop 3
    v_cvt_pk_bf16_f32 v148, v136, v137
    v_cvt_pk_bf16_f32 v149, v138, v139
    v_cvt_pk_bf16_f32 v150, v140, v141
    v_cvt_pk_bf16_f32 v151, v142, v143
    s_add_u32 s81, s78, 294912
    buffer_store_dwordx4 v[148:151], v9, s[4:7], s81 offen sc1
    s_add_u32 s78, s78, 1310720
    s_mov_b32 s84, s77
    s_add_u32 s77, s77, 1
    s_cmp_gt_u32 s77, 8
    s_cbranch_scc1 L_pu_len0
    s_mov_b32 s84, s77
    s_waitcnt vmcnt(0)
L_pu_len0:
    s_waitcnt vmcnt(10)
    s_barrier
    s_cmp_eq_u32 s24, 0
    s_cbranch_scc0 L_pu_nopub0
    v_mov_b32 v13, s84
    s_mov_b64 exec, 1
    buffer_store_dword v13, v10, s[4:7], 0 offen offset:0 sc1
    s_mov_b64 exec, -1
L_pu_nopub0:
    v_readlane_b32 s28, v12, 0
    v_readlane_b32 s29, v12, 1
    s_nop 3
    s_min_u32 s28, s28, s29
    s_max_u32 s79, s79, s28
    s_cmp_eq_u32 s82, 1
    s_cbranch_scc1 L_pu_have0
    s_cmp_ge_u32 s79, s80
    s_cbranch_scc1 L_pu_w1_ok
L_pu_w1:
    buffer_load_dword v12, v11, s[4:7], 0 offen sc1
    s_waitcnt vmcnt(0)
    s_nop 1
    v_min_u32_dpp v12, v12, v12 row_shr:1 row_mask:0xf bank_mask:0xf
    s_nop 1
    v_min_u32_dpp v12, v12, v12 row_shr:2 row_mask:0xf bank_mask:0xf
    s_nop 1
    v_min_u32_dpp v12, v12, v12 row_shr:4 row_mask:0xf bank_mask:0xf
    s_nop 1
    v_min_u32_dpp v12, v12, v12 row_shr:8 row_mask:0xf bank_mask:0xf
    s_nop 1
    v_min_u32_dpp v12, v12, v12 row_bcast:15 row_mask:0xa bank_mask:0xf
    s_nop 1
    v_min_u32_dpp v12, v12, v12 row_bcast:31 row_mask:0xc bank_mask:0xf
    s_nop 0
    v_readlane_b32 s79, v12, 63
    s_nop 3
    s_cmp_ge_u32 s79, s80
    s_cbranch_scc1 L_pu_w1_ok
    s_sub_u32 s27, s27, 1
    s_cbranch_scc1 L_fail
    s_branch L_pu_w1
L_pu_w1_ok:
    buffer_load_dwordx4 v[80:83], v6, s[4:7], s76 offen offset:0 sc1
    buffer_load_dwordx4 v[84:87], v6, s[4:7], s76 offen offset:1024 sc1
    buffer_load_dwordx4 v[88:91], v6, s[4:7], s76 offen offset:2048 sc1
    buffer_load_dwordx4 v[92:95], v6, s[4:7], s76 offen offset:3072 sc1
    buffer_load_dwordx4 v[96:99], v7, s[4:7], s76 offen offset:0 sc1
    buffer_load_dwordx4 v[100:103], v7, s[4:7], s76 offen offset:1024 sc1
    buffer_load_dwordx4 v[104:107], v7, s[4:7], s76 offen offset:2048 sc1
    buffer_load_dwordx4 v[108:111], v7, s[4:7], s76 offen offset:3072 sc1
    buffer_load_dwordx4 v[112:115], v8, s[4:7], s76 offen offset:0 sc1
    buffer_load_dwordx4 v[116:119], v8, s[4:7], s76 offen offset:1024 sc1
    buffer_load_dwordx4 v[120:123], v8, s[4:7], s76 offen offset:2048 sc1
    buffer_load_dwordx4 v[124:127], v8, s[4:7], s76 offen offset:3072 sc1
    s_add_u32 s76, s76, 393216
    s_waitcnt vmcnt(0)
L_pu_have0:
    s_add_u32 s80, s77, 2
    s_min_u32 s80, s80, 64
    s_mov_b32 s82, 0
    s_cmp_ge_u32 s79, s80
    s_cbranch_scc0 L_pu_nopf1
    s_mov_b32 s82, 1
    buffer_load_dwordx4 v[32:35], v6, s[4:7], s76 offen offset:0 sc1
    buffer_load_dwordx4 v[36:39], v6, s[4:7], s76 offen offset:1024 sc1
    buffer_load_dwordx4 v[40:43], v6, s[4:7], s76 offen offset:2048 sc1
    buffer_load_dwordx4 v[44:47], v6, s[4:7], s76 offen offset:3072 sc1
    buffer_load_dwordx4 v[48:51], v7, s[4:7], s76 offen offset:0 sc1
    buffer_load_dwordx4 v[52:55], v7, s[4:7], s76 offen offset:1024 sc1
    buffer_load_dwordx4 v[56:59], v7, s[4:7], s76 offen offset:2048 sc1
    buffer_load_dwordx4 v[60:63], v7, s[4:7], s76 offen offset:3072 sc1
    buffer_load_dwordx4 v[64:67], v8, s[4:7], s76 offen offset:0 sc1
    buffer_load_dwordx4 v[68:71], v8, s[4:7], s76 offen offset:1024 sc1
    buffer_load_dwordx4 v[72:75], v8, s[4:7], s76 offen offset:2048 sc1
    buffer_load_dwordx4 v[76:79], v8, s[4:7], s76 offen offset:3072 sc1
    s_add_u32 s76, s76, 393216
L_pu_nopf1:
    buffer_load_dword v12, v11, s[4:7], 0 offen sc1
    v_mfma_f32_16x16x32_bf16 v[128:131], v[80:83], a[0:3], 0
    v_mfma_f32_16x16x32_bf16 v[132:135], v[104:107], a[0:3], 0
    v_mfma_f32_16x16x32_bf16 v[128:131], v[84:87], a[4:7], v[128:131]
    v_mfma_f32_16x16x32_bf16 v[132:135], v[108:111], a[4:7], v[132:135]
    v_mfma_f32_16x16x32_bf16 v[128:131], v[88:91], a[8:11], v[128:131]
    v_mfma_f32_16x16x32_bf16 v[132:135], v[112:115], a[8:11], v[132:135]
    v_mfma_f32_16x16x32_bf16 v[128:131], v[92:95], a[12:15], v[128:131]
    v_mfma_f32_16x16x32_bf16 v[132:135], v[116:119], a[12:15], v[132:135]
    v_mfma_f32_16x16x32_bf16 v[128:131], v[96:99], a[16:19], v[128:131]
    v_mfma_f32_16x16x32_bf16 v[132:135], v[120:123], a[16:19], v[132:135]
    v_mfma_f32_16x16x32_bf16 v[128:131], v[100:103], a[20:23], v[128:131]
    v_mfma_f32_16x16x32_bf16 v[132:135], v[124:127], a[20:23], v[132:135]
    v_mfma_f32_16x16x32_bf16 v[136:139], v[80:83], a[24:27], 0
    v_mfma_f32_16x16x32_bf16 v[140:143], v[104:107], a[24:27], 0
    v_mfma_f32_16x16x32_bf16 v[136:139], v[84:87], a[28:31], v[136:139]
    v_mfma_f32_16x16x32_bf16 v[140:143], v[108:111], a[28:31], v[140:143]
    v_mfma_f32_16x16x32_bf16 v[136:139], v[88:91], a[32:35], v[136:139]
    v_mfma_f32_16x16x32_bf16 v[140:143], v[112:115], a[32:35], v[140:143]
    v_mfma_f32_16x16x32_bf16 v[136:139], v[92:95], a[36:39], v[136:139]
    v_mfma_f32_16x16x32_bf16 v[140:143], v[116:119], a[36:39], v[140:143]
    v_cvt_pk_bf16_f32 v144, v128, v129
    v_cvt_pk_bf16_f32 v145, v130, v131
    v_mfma_f32_16x16x32_bf16 v[136:139], v[96:99], a[40:43], v[136:139]
    v_cvt_pk_bf16_f32 v146, v132, v133
    v_cvt_pk_bf16_f32 v147, v134, v135
    v_mfma_f32_16x16x32_bf16 v[140:143], v[120:123], a[40:43], v[140:143]
    s_add_u32 s81, s78, 0
    buffer_store_dwordx4 v[144:147], v9, s[4:7], s81 offen sc1
    v_mfma_f32_16x16x32_bf16 v[136:139], v[100:103], a[44:47], v[136:139]
    v_mfma_f32_16x16x32_bf16 v[140:143], v[124:127], a[44:47], v[140:143]
    v_mfma_f32_16x16x32_bf16 v[128:131], v[80:83], a[48:51], 0
    v_mfma_f32_16x16x32_bf16 v[132:135], v[104:107], a[48:51], 0
    v_mfma_f32_16x16x32_bf16 v[128:131], v[84:87], a[52:55], v[128:131]
    v_mfma_f32_16x16x32_bf16 v[132:135], v[108:111], a[52:55], v[132:135]
    v_mfma_f32_16x16x32_bf16 v[128:131], v[88:91], a[56:59], v[128:131]
    v_mfma_f32_16x16x32_bf16 v[132:135], v[112:115], a[56:59], v[132:135]
    v_mfma_f32_16x16x32_bf16 v[128:131], v[92:95], a[60:63], v[128:131]
    v_mfma_f32_16x16x32_bf16 v[132:135], v[116:119], a[60:63], v[132:135]
    v_cvt_pk_bf16_f32 v148, v136, v137
    v_cvt_pk_bf16_f32 v149, v138, v139
    v_mfma_f32_16x16x32_bf16 v[128:131], v[96:99], a[64:67], v[128:131]
    v_cvt_pk_bf16_f32 v150, v140, v141
    v_cvt_pk_bf16_f32 v151, v142, v143
    v_mfma_f32_16x16x32_bf16 v[132:135], v[120:123], a[64:67], v[132:135]
    s_add_u32 s81, s78, 32768
    buffer_store_dwordx4 v[148:151], v9, s[4:7], s81 offen sc1
    v_mfma_f32_16x16x32_bf16 v[128:131], v[100:103], a[68:71], v[128:131]
    v_mfma_f32_16x16x32_bf16 v[132:135], v[124:127], a[68:71], v[132:135]
    v_mfma_f32_16x16x32_bf16 v[136:139], v[80:83], a[72:75], 0
    v_mfma_f32_16x16x32_bf16 v[140:143], v[104:107], a[72:75], 0
    v_mfma_f32_16x16x32_bf16 v[136:139], v[84:87], a[76:79], v[136:139]
    v_mfma_f32_16x16x32_bf16 v[140:143], v[108:111], a[76:79], v[140:143]
    v_mfma_f32_16x16x32_bf16 v[136:139], v[88:91], a[80:83], v[136:139]
    v_mfma_f32_16x16x32_bf16 v[140:143], v[112:115], a[80:83], v[140:143]
    v_mfma_f32_16x16x32_bf16 v[136:139], v[92:95], a[84:87], v[136:139]
    v_mfma_f32_16x16x32_bf16 v[140:143], v[116:119], a[84:87], v[140:143]
    v_cvt_pk_bf16_f32 v144, v128, v129
    v_cvt_pk_bf16_f32 v145, v130, v131
    v_mfma_f32_16x16x32_bf16 v[136:139], v[96:99], a[88:91], v[136:139]
    v_cvt_pk_bf16_f32 v146, v132, v133
    v_cvt_pk_bf16_f32 v147, v134, v135
    v_mfma_f32_16x16x32_bf16 v[140:143], v[120:123], a[88:91], v[140:143]
    s_add_u32 s81, s78, 65536
    buffer_store_dwordx4 v[144:147], v9, s[4:7], s81 offen sc1
    v_mfma_f32_16x16x32_bf16 v[136:139], v[100:103], a[92:95], v[136:139]
    v_mfma_f32_16x16x32_bf16 v[140:143], v[124:127], a[92:95], v[140:143]
    v_mfma_f32_16x16x32_bf16 v[128:131], v[80:83], a[96:99], 0
    v_mfma_f32_16x16x32_bf16 v[132:135], v[104:107], a[96:99], 0
    v_mfma_f32_16x16x32_bf16 v[128:131], v[84:87], a[100:103], v[128:131]
    v_mfma_f32_16x16x32_bf16 v[132:135], v[108:111], a[100:103], v[132:135]
    v_mfma_f32_16x16x32_bf16 v[128:131], v[88:91], a[104:107], v[128:131]
    v_mfma_f32_16x16x32_bf16 v[132:135], v[112:115], a[104:107], v[132:135]
    v_mfma_f32_16x16x32_bf16 v[128:131], v[92:95], a[108:111], v[128:131]
    v_mfma_f32_16x16x32_bf16 v[132:135], v[116:119], a[108:111], v[132:135]
    v_cvt_pk_bf16_f32 v148, v136, v137
    v_cvt_pk_bf16_f32 v149, v138, v139
    v_mfma_f32_16x16x32_bf16 v[128:131], v[96:99], a[112:115], v[128:131]
    v_cvt_pk_bf16_f32 v150, v140, v141
    v_cvt_pk_bf16_f32 v151, v142, v143
    v_mfma_f32_16x16x32_bf16 v[132:135], v[120:123], a[112:115], v[132:135]
    s_add_u32 s81, s78, 98304
    buffer_store_dwordx4 v[148:151], v9, s[4:7], s81 offen sc1
    v_mfma_f32_16x16x32_bf16 v[128:131], v[100:103], a[116:119], v[128:131]
    v_mfma_f32_16x16x32_bf16 v[132:135], v[124:127], a[116:119], v[132:135]
    v_mfma_f32_16x16x32_bf16 v[136:139], v[80:83], a[120:123], 0
    v_mfma_f32_16x16x32_bf16 v[140:143], v[104:107], a[120:123], 0
    v_mfma_f32_16x16x32_bf16 v[136:139], v[84:87], a[124:127], v[136:139]
    v_mfma_f32_16x16x32_bf16 v[140:143], v[108:111], a[124:127], v[140:143]
    v_mfma_f32_16x16x32_bf16 v[136:139], v[88:91], a[128:131], v[136:139]
    v_mfma_f32_16x16x32_bf16 v[140:143], v[112:115], a[128:131], v[140:143]
    v_mfma_f32_16x16x32_bf16 v[136:139], v[92:95], a[132:135], v[136:139]
    v_mfma_f32_16x16x32_bf16 v[140:143], v[116:119], a[132:135], v[140:143]
    v_cvt_pk_bf16_f32 v144, v128, v129
    v_cvt_pk_bf16_f32 v145, v130, v131
    v_mfma_f32_16x16x32_bf16 v[136:139], v[96:99], a[136:139], v[136:139]
    v_cvt_pk_bf16_f32 v146, v132, v133
    v_cvt_pk_bf16_f32 v147, v134, v135
    v_mfma_f32_16x16x32_bf16 v[140:143], v[120:123], a[136:139], v[140:143]
    s_add_u32 s81, s78, 131072
    buffer_store_dwordx4 v[144:147], v9, s[4:7], s81 offen sc1
    v_mfma_f32_16x16x32_bf16 v[136:139], v[100:103], a[140:143], v[136:139]
    v_mfma_f32_16x16x32_bf16 v[140:143], v[124:127], a[140:143], v[140:143]
    v_mfma_f32_16x16x32_bf16 v[128:131], v[80:83], a[144:147], 0
    v_mfma_f32_16x16x32_bf16 v[132:135], v[104:107], a[144:147], 0
    v_mfma_f32_16x16x32_bf16 v[128:131], v[84:87], a[148:151], v[128:131]
    v_mfma_f32_16x16x32_bf16 v[132:135], v[108:111], a[148:151], v[132:135]
    v_mfma_f32_16x16x32_bf16 v[128:131], v[88:91], a[152:155], v[128:131]
    v_mfma_f32_16x16x32_bf16 v[132:135], v[112:115], a[152:155], v[132:135]
    v_mfma_f32_16x16x32_bf16 v[128:131], v[92:95], a[156:159], v[128:131]
    v_mfma_f32_16x16x32_bf16 v[132:135], v[116:119], a[156:159], v[132:135]
    v_cvt_pk_bf16_f32 v148, v136, v137
    v_cvt_pk_bf16_f32 v149, v138, v139
    v_mfma_f32_16x16x32_bf16 v[128:131], v[96:99], a[160:163], v[128:131]
    v_cvt_pk_bf16_f32 v150, v140, v141
    v_cvt_pk_bf16_f32 v151, v142, v143
    v_mfma_f32_16x16x32_bf16 v[132:135], v[120:123], a[160:163], v[132:135]
    s_add_u32 s81, s78, 163840
    buffer_store_dwordx4 v[148:151], v9, s[4:7], s81 offen sc1
    v_mfma_f32_16x16x32_bf16 v[128:131], v[100:103], a[164:167], v[128:131]
    v_mfma_f32_16x16x32_bf16 v[132:135], v[124:127], a[164:167], v[132:135]
    v_mfma_f32_16x16x32_bf16 v[136:139], v[80:83], a[168:171], 0
    v_mfma_f32_16x16x32_bf16 v[140:143], v[104:107], a[168:171], 0
    v_mfma_f32_16x16x32_bf16 v[136:139], v[84:87], a[172:175], v[136:139]
    v_mfma_f32_16x16x32_bf16 v[140:143], v[108:111], a[172:175], v[140:143]
    v_mfma_f32_16x16x32_bf16 v[136:139], v[88:91], a[176:179], v[136:139]
    v_mfma_f32_16x16x32_bf16 v[140:143], v[112:115], a[176:179], v[140:143]
    v_mfma_f32_16x16x32_bf16 v[136:139], v[92:95], a[180:183], v[136:139]
    v_mfma_f32_16x16x32_bf16 v[140:143], v[116:119], a[180:183], v[140:143]
    v_cvt_pk_bf16_f32 v144, v128, v129
    v_cvt_pk_bf16_f32 v145, v130, v131
    v_mfma_f32_16x16x32_bf16 v[136:139], v[96:99], a[184:187], v[136:139]
    v_cvt_pk_bf16_f32 v146, v132, v133
    v_cvt_pk_bf16_f32 v147, v134, v135
    v_mfma_f32_16x16x32_bf16 v[140:143], v[120:123], a[184:187], v[140:143]
    s_add_u32 s81, s78, 196608
    buffer_store_dwordx4 v[144:147], v9, s[4:7], s81 offen sc1
    v_mfma_f32_16x16x32_bf16 v[136:139], v[100:103], a[188:191], v[136:139]
    v_mfma_f32_16x16x32_bf16 v[140:143], v[124:127], a[188:191], v[140:143]
    v_mfma_f32_16x16x32_bf16 v[128:131], v[80:83], a[192:195], 0
    v_mfma_f32_16x16x32_bf16 v[132:135], v[104:107], a[192:195], 0
    v_mfma_f32_16x16x32_bf16 v[128:131], v[84:87], a[196:199], v[128:131]
    v_mfma_f32_16x16x32_bf16 v[132:135], v[108:111], a[196:199], v[132:135]
    v_mfma_f32_16x16x32_bf16 v[128:131], v[88:91], a[200:203], v[128:131]
    v_mfma_f32_16x16x32_bf16 v[132:135], v[112:115], a[200:203], v[132:135]
    v_mfma_f32_16x16x32_bf16 v[128:131], v[92:95], a[204:207], v[128:131]
    v_mfma_f32_16x16x32_bf16 v[132:135], v[116:119], a[204:207], v[132:135]
    v_cvt_pk_bf16_f32 v148, v136, v137
    v_cvt_pk_bf16_f32 v149, v138, v139
    v_mfma_f32_16x16x32_bf16 v[128:131], v[96:99], a[208:211], v[128:131]
    v_cvt_pk_bf16_f32 v150, v140, v141
    v_cvt_pk_bf16_f32 v151, v142, v143
    v_mfma_f32_16x16x32_bf16 v[132:135], v[120:123], a[208:211], v[132:135]
    s_add_u32 s81, s78, 229376
    buffer_store_dwordx4 v[148:151], v9, s[4:7], s81 offen sc1
    v_mfma_f32_16x16x32_bf16 v[128:131], v[100:103], a[212:215], v[128:131]
    v_mfma_f32_16x16x32_bf16 v[132:135], v[124:127], a[212:215], v[132:135]
    v_mfma_f32_16x16x32_bf16 v[136:139], v[80:83], a[216:219], 0
    v_mfma_f32_16x16x32_bf16 v[140:143], v[104:107], a[216:219], 0
    v_mfma_f32_16x16x32_bf16 v[136:139], v[84:87], a[220:223], v[136:139]
    v_mfma_f32_16x16x32_bf16 v[140:143], v[108:111], a[220:223], v[140:143]
    v_mfma_f32_16x16x32_bf16 v[136:139], v[88:91], a[224:227], v[136:139]
    v_mfma_f32_16x16x32_bf16 v[140:143], v[112:115], a[224:227], v[140:143]
    v_mfma_f32_16x16x32_bf16 v[136:139], v[92:95], a[228:231], v[136:139]
    v_mfma_f32_16x16x32_bf16 v[140:143], v[116:119], a[228:231], v[140:143]
    v_cvt_pk_bf16_f32 v144, v128, v129
    v_cvt_pk_bf16_f32 v145, v130, v131
    v_mfma_f32_16x16x32_bf16 v[136:139], v[96:99], a[232:235], v[136:139]
    v_cvt_pk_bf16_f32 v146, v132, v133
    v_cvt_pk_bf16_f32 v147, v134, v135
    v_mfma_f32_16x16x32_bf16 v[140:143], v[120:123], a[232:235], v[140:143]
    s_add_u32 s81, s78, 262144
    buffer_store_dwordx4 v[144:147], v9, s[4:7], s81 offen sc1
    v_mfma_f32_16x16x32_bf16 v[136:139], v[100:103], a[236:239], v[136:139]
    v_mfma_f32_16x16x32_bf16 v[140:143], v[124:127], a[236:239], v[140:143]
    s_nop 7
    s_nop 3
    v_cvt_pk_bf16_f32 v148, v136, v137
    v_cvt_pk_bf16_f32 v149, v138, v139
    v_cvt_pk_bf16_f32 v150, v140, v141
    v_cvt_pk_bf16_f32 v151, v142, v143
    s_add_u32 s81, s78, 294912
    buffer_store_dwordx4 v[148:151], v9, s[4:7], s81 offen sc1
    s_add_u32 s78, s78, 1310720
    s_mov_b32 s84, s77
    s_add_u32 s77, s77, 1
    s_cmp_gt_u32 s77, 8
    s_cbranch_scc1 L_pu_len1
    s_mov_b32 s84, s77
    s_waitcnt vmcnt(0)
L_pu_len1:
    s_waitcnt vmcnt(10)
    s_barrier
    s_cmp_eq_u32 s24, 0
    s_cbranch_scc0 L_pu_nopub1
    v_mov_b32 v13, s84
    s_mov_b64 exec, 1
    buffer_store_dword v13, v10, s[4:7], 0 offen offset:0 sc1
    s_mov_b64 exec, -1
L_pu_nopub1:
    v_readlane_b32 s28, v12, 0
    v_readlane_b32 s29, v12, 1
    s_nop 3
    s_min_u32 s28, s28, s29
    s_max_u32 s79, s79, s28
    s_cmp_eq_u32 s82, 1
    s_cbranch_scc1 L_pu_have1
    s_cmp_ge_u32 s79, s80
    s_cbranch_scc1 L_pu_w2_ok
L_pu_w2:
    buffer_load_dword v12, v11, s[4:7], 0 offen sc1
    s_waitcnt vmcnt(0)
    s_nop 1
    v_min_u32_dpp v12, v12, v12 row_shr:1 row_mask:0xf bank_mask:0xf
    s_nop 1
    v_min_u32_dpp v12, v12, v12 row_shr:2 row_mask:0xf bank_mask:0xf
    s_nop 1
    v_min_u32_dpp v12, v12, v12 row_shr:4 row_mask:0xf bank_mask:0xf
    s_nop 1
    v_min_u32_dpp v12, v12, v12 row_shr:8 row_mask:0xf bank_mask:0xf
    s_nop 1
    v_min_u32_dpp v12, v12, v12 row_bcast:15 row_mask:0xa bank_mask:0xf
    s_nop 1
    v_min_u32_dpp v12, v12, v12 row_bcast:31 row_mask:0xc bank_mask:0xf
    s_nop 0
    v_readlane_b32 s79, v12, 63
    s_nop 3
    s_cmp_ge_u32 s79, s80
    s_cbranch_scc1 L_pu_w2_ok
    s_sub_u32 s27, s27, 1
    s_cbranch_scc1 L_fail
    s_branch L_pu_w2
L_pu_w2_ok:
    buffer_load_dwordx4 v[32:35], v6, s[4:7], s76 offen offset:0 sc1
    buffer_load_dwordx4 v[36:39], v6, s[4:7], s76 offen offset:1024 sc1
    buffer_load_dwordx4 v[40:43], v6, s[4:7], s76 offen offset:2048 sc1
    buffer_load_dwordx4 v[44:47], v6, s[4:7], s76 offen offset:3072 sc1
    buffer_load_dwordx4 v[48:51], v7, s[4:7], s76 offen offset:0 sc1
    buffer_load_dwordx4 v[52:55], v7, s[4:7], s76 offen offset:1024 sc1
    buffer_load_dwordx4 v[56:59], v7, s[4:7], s76 offen offset:2048 sc1
    buffer_load_dwordx4 v[60:63], v7, s[4:7], s76 offen offset:3072 sc1
    buffer_load_dwordx4 v[64:67], v8, s[4:7], s76 offen offset:0 sc1
    buffer_load_dwordx4 v[68:71], v8, s[4:7], s76 offen offset:1024 sc1
    buffer_load_dwordx4 v[72:75], v8, s[4:7], s76 offen offset:2048 sc1
    buffer_load_dwordx4 v[76:79], v8, s[4:7], s76 offen offset:3072 sc1
    s_add_u32 s76, s76, 393216
    s_waitcnt vmcnt(0)
L_pu_have1:
    s_cmp_lt_u32 s77, 64
    s_cbranch_scc1 L_pu_loop
    s_waitcnt vmcnt(0)
    s_barrier
    s_cmp_eq_u32 s24, 0
    s_cbranch_scc0 L_pu_end
    v_mov_b32 v13, 64
    s_mov_b64 exec, 1
    buffer_store_dword v13, v10, s[4:7], 0 offen offset:0 sc1
    s_mov_b64 exec, -1
L_pu_end:
    s_waitcnt vmcnt(0)
    s_endpgm
L_xo:
    s_cmp_ge_u32 s83, 40
    s_cbranch_scc1 L_exit
    s_mul_i32 s77, s83, 6554
    s_lshr_b32 s77, s77, 16
    s_mul_i32 s28, s77, 10
    s_sub_u32 s75, s83, s28
    s_branch L_sum
L_qk:
    s_lshl_b32 s75, s26, 3
    s_add_u32 s75, s75, s25
    s_mov_b32 s12, s40
    s_mov_b32 s13, s41
    s_mov_b32 s14, 7864320
    s_mov_b32 s15, 0x20000
    s_mov_b32 s16, s42
    s_mov_b32 s17, s43
    s_mov_b32 s18, 7864320
    s_mov_b32 s19, 0x20000
    v_add_u32 v3, 0, v1
    v_mul_u32_u24 v12, 2731, v3
    v_lshrrev_b32 v12, 16, v12
    v_mul_u32_u24 v13, 24, v12
    v_sub_u32 v13, v3, v13
    v_mul_u32_u24 v12, 12288, v12
    v_lshl_add_u32 v3, v13, 4, v12
    v_add_u32 v4, 64, v1
    v_mul_u32_u24 v12, 2731, v4
    v_lshrrev_b32 v12, 16, v12
    v_mul_u32_u24 v13, 24, v12
    v_sub_u32 v13, v4, v13
    v_mul_u32_u24 v12, 12288, v12
    v_lshl_add_u32 v4, v13, 4, v12
    v_add_u32 v5, 128, v1
    v_mul_u32_u24 v12, 2731, v5
    v_lshrrev_b32 v12, 16, v12
    v_mul_u32_u24 v13, 24, v12
    v_sub_u32 v13, v5, v13
    v_mul_u32_u24 v12, 12288, v12
    v_lshl_add_u32 v5, v13, 4, v12
    s_mul_i32 s28, s75, 384
    s_mul_i32 s29, s24, 196608
    s_add_u32 s28, s28, s29
    v_add_u32 v3, s28, v3
    v_add_u32 v4, s28, v4
    v_add_u32 v5, s28, v5
    v_and_b32 v6, 8, v1
    v_bfe_u32 v12, v1, 2, 1
    v_add_u32 v6, v6, v12
    v_lshrrev_b32 v12, 5, v1
    v_lshl_add_u32 v6, v12, 4, v6
    v_bfe_u32 v12, v1, 4, 1
    v_lshl_add_u32 v6, v12, 2, v6
    v_mul_u32_u24 v6, 384, v6
    v_and_b32 v12, 3, v1
    v_lshl_add_u32 v6, v12, 3, v6
    s_lshl_b32 s28, s24, 5
    s_add_u32 s29, s28, 256
    v_add_u32 v9, s29, v6
    s_lshl_b32 s28, s24, 6
    v_add_u32 v6, s28, v6
    s_mul_i32 s30, s24, 6144
    s_add_u32 m0, s30, 0
    s_mov_b32 s31, 0
    buffer_load_dwordx4 v3, s[16:19], s31 offen lds
    s_add_u32 m0, s30, 1024
    s_mov_b32 s31, 0
    buffer_load_dwordx4 v4, s[16:19], s31 offen lds
    s_add_u32 m0, s30, 2048
    s_mov_b32 s31, 0
    buffer_load_dwordx4 v5, s[16:19], s31 offen lds
    s_add_u32 m0, s30, 3072
    s_mov_b32 s31, 98304
    buffer_load_dwordx4 v3, s[16:19], s31 offen lds
    s_add_u32 m0, s30, 4096
    s_mov_b32 s31, 98304
    buffer_load_dwordx4 v4, s[16:19], s31 offen lds
    s_add_u32 m0, s30, 5120
    s_mov_b32 s31, 98304
    buffer_load_dwordx4 v5, s[16:19], s31 offen lds
    s_add_u32 m0, s30, 24576
    s_mov_b32 s31, 0
    buffer_load_dwordx4 v3, s[12:15], s31 offen lds
    s_add_u32 m0, s30, 25600
    s_mov_b32 s31, 0
    buffer_load_dwordx4 v4, s[12:15], s31 offen lds
    s_add_u32 m0, s30, 26624
    s_mov_b32 s31, 0
    buffer_load_dwordx4 v5, s[12:15], s31 offen lds
    s_add_u32 m0, s30, 27648
    s_mov_b32 s31, 98304
    buffer_load_dwordx4 v3, s[12:15], s31 offen lds
    s_add_u32 m0, s30, 28672
    s_mov_b32 s31, 98304
    buffer_load_dwordx4 v4, s[12:15], s31 offen lds
    s_add_u32 m0, s30, 29696
    s_mov_b32 s31, 98304
    buffer_load_dwordx4 v5, s[12:15], s31 offen lds
    s_add_u32 m0, s30, 49152
    s_mov_b32 s31, 786432
    buffer_load_dwordx4 v3, s[16:19], s31 offen lds
    s_add_u32 m0, s30, 50176
    s_mov_b32 s31, 786432
    buffer_load_dwordx4 v4, s[16:19], s31 offen lds
    s_add_u32 m0, s30, 51200
    s_mov_b32 s31, 786432
    buffer_load_dwordx4 v5, s[16:19], s31 offen lds
    s_add_u32 m0, s30, 52224
    s_mov_b32 s31, 884736
    buffer_load_dwordx4 v3, s[16:19], s31 offen lds
    s_add_u32 m0, s30, 53248
    s_mov_b32 s31, 884736
    buffer_load_dwordx4 v4, s[16:19], s31 offen lds
    s_add_u32 m0, s30, 54272
    s_mov_b32 s31, 884736
    buffer_load_dwordx4 v5, s[16:19], s31 offen lds
    s_add_u32 m0, s30, 73728
    s_mov_b32 s31, 786432
    buffer_load_dwordx4 v3, s[12:15], s31 offen lds
    s_add_u32 m0, s30, 74752
    s_mov_b32 s31, 786432
    buffer_load_dwordx4 v4, s[12:15], s31 offen lds
    s_add_u32 m0, s30, 75776
    s_mov_b32 s31, 786432
    buffer_load_dwordx4 v5, s[12:15], s31 offen lds
    s_add_u32 m0, s30, 76800
    s_mov_b32 s31, 884736
    buffer_load_dwordx4 v3, s[12:15], s31 offen lds
    s_add_u32 m0, s30, 77824
    s_mov_b32 s31, 884736
    buffer_load_dwordx4 v4, s[12:15], s31 offen lds
    s_add_u32 m0, s30, 78848
    s_mov_b32 s31, 884736
    buffer_load_dwordx4 v5, s[12:15], s31 offen lds
    s_add_u32 m0, s30, 98304
    s_mov_b32 s31, 1572864
    buffer_load_dwordx4 v3, s[16:19], s31 offen lds
    s_add_u32 m0, s30, 99328
    s_mov_b32 s31, 1572864
    buffer_load_dwordx4 v4, s[16:19], s31 offen lds
    s_add_u32 m0, s30, 100352
    s_mov_b32 s31, 1572864
    buffer_load_dwordx4 v5, s[16:19], s31 offen lds
    s_add_u32 m0, s30, 101376
    s_mov_b32 s31, 1671168
    buffer_load_dwordx4 v3, s[16:19], s31 offen lds
    s_add_u32 m0, s30, 102400
    s_mov_b32 s31, 1671168
    buffer_load_dwordx4 v4, s[16:19], s31 offen lds
    s_add_u32 m0, s30, 103424
    s_mov_b32 s31, 1671168
    buffer_load_dwordx4 v5, s[16:19], s31 offen lds
    s_waitcnt vmcnt(24)
    s_barrier
    s_add_u32 m0, s30, 122880
    s_mov_b32 s31, 1572864
    buffer_load_dwordx4 v3, s[12:15], s31 offen lds
    s_add_u32 m0, s30, 123904
    s_mov_b32 s31, 1572864
    buffer_load_dwordx4 v4, s[12:15], s31 offen lds
    s_add_u32 m0, s30, 124928
    s_mov_b32 s31, 1572864
    buffer_load_dwordx4 v5, s[12:15], s31 offen lds
    s_add_u32 m0, s30, 125952
    s_mov_b32 s31, 1671168
    buffer_load_dwordx4 v3, s[12:15], s31 offen lds
    s_add_u32 m0, s30, 126976
    s_mov_b32 s31, 1671168
    buffer_load_dwordx4 v4, s[12:15], s31 offen lds
    s_add_u32 m0, s30, 128000
    s_mov_b32 s31, 1671168
    buffer_load_dwordx4 v5, s[12:15], s31 offen lds
    v_add_u32 v7, 0, v6
    v_add_u32 v10, 0, v9
    ds_read_b64_tr_b16 a[240:241], v7 offset:0
    ds_read_b64_tr_b16 a[242:243], v7 offset:768
    ds_read_b64_tr_b16 a[244:245], v7 offset:12288
    ds_read_b64_tr_b16 a[246:247], v7 offset:13056
    ds_read_b64_tr_b16 v[176:177], v7 offset:32
    ds_read_b64_tr_b16 v[178:179], v7 offset:800
    ds_read_b64_tr_b16 v[180:181], v7 offset:12320
    ds_read_b64_tr_b16 v[182:183], v7 offset:13088
    ds_read_b64_tr_b16 v[16:17], v10 offset:0
    ds_read_b64_tr_b16 v[18:19], v10 offset:768
    ds_read_b64_tr_b16 v[20:21], v10 offset:12288
    ds_read_b64_tr_b16 v[22:23], v10 offset:13056
    s_waitcnt lgkmcnt(0)
    s_waitcnt vmcnt(24)
    s_barrier
    s_add_u32 m0, s30, 0
    s_mov_b32 s31, 2359296
    buffer_load_dwordx4 v3, s[16:19], s31 offen lds
    s_add_u32 m0, s30, 1024
    s_mov_b32 s31, 2359296
    buffer_load_dwordx4 v4, s[16:19], s31 offen lds
    s_add_u32 m0, s30, 2048
    s_mov_b32 s31, 2359296
    buffer_load_dwordx4 v5, s[16:19], s31 offen lds
    s_add_u32 m0, s30, 3072
    s_mov_b32 s31, 2457600
    buffer_load_dwordx4 v3, s[16:19], s31 offen lds
    s_add_u32 m0, s30, 4096
    s_mov_b32 s31, 2457600
    buffer_load_dwordx4 v4, s[16:19], s31 offen lds
    s_add_u32 m0, s30, 5120
    s_mov_b32 s31, 2457600
    buffer_load_dwordx4 v5, s[16:19], s31 offen lds
    v_add_u32 v7, 24576, v6
    v_add_u32 v10, 24576, v9
    ds_read_b64_tr_b16 a[0:1], v7 offset:0
    ds_read_b64_tr_b16 a[2:3], v7 offset:768
    ds_read_b64_tr_b16 a[4:5], v7 offset:12288
    ds_read_b64_tr_b16 a[6:7], v7 offset:13056
    ds_read_b64_tr_b16 a[80:81], v7 offset:32
    ds_read_b64_tr_b16 a[82:83], v7 offset:800
    ds_read_b64_tr_b16 a[84:85], v7 offset:12320
    ds_read_b64_tr_b16 a[86:87], v7 offset:13088
    ds_read_b64_tr_b16 a[160:161], v10 offset:0
    ds_read_b64_tr_b16 a[162:163], v10 offset:768
    ds_read_b64_tr_b16 a[164:165], v10 offset:12288
    ds_read_b64_tr_b16 a[166:167], v10 offset:13056
    s_waitcnt lgkmcnt(0)
    s_waitcnt vmcnt(24)
    s_barrier
    s_add_u32 m0, s30, 24576
    s_mov_b32 s31, 2359296
    buffer_load_dwordx4 v3, s[12:15], s31 offen lds
    s_add_u32 m0, s30, 25600
    s_mov_b32 s31, 2359296
    buffer_load_dwordx4 v4, s[12:15], s31 offen lds
    s_add_u32 m0, s30, 26624
    s_mov_b32 s31, 2359296
    buffer_load_dwordx4 v5, s[12:15], s31 offen lds
    s_add_u32 m0, s30, 27648
    s_mov_b32 s31, 2457600
    buffer_load_dwordx4 v3, s[12:15], s31 offen lds
    s_add_u32 m0, s30, 28672
    s_mov_b32 s31, 2457600
    buffer_load_dwordx4 v4, s[12:15], s31 offen lds
    s_add_u32 m0, s30, 29696
    s_mov_b32 s31, 2457600
    buffer_load_dwordx4 v5, s[12:15], s31 offen lds
    v_add_u32 v7, 49152, v6
    v_add_u32 v10, 49152, v9
    ds_read_b64_tr_b16 a[248:249], v7 offset:0
    ds_read_b64_tr_b16 a[250:251], v7 offset:768
    ds_read_b64_tr_b16 a[252:253], v7 offset:12288
    ds_read_b64_tr_b16 a[254:255], v7 offset:13056
    ds_read_b64_tr_b16 v[184:185], v7 offset:32
    ds_read_b64_tr_b16 v[186:187], v7 offset:800
    ds_read_b64_tr_b16 v[188:189], v7 offset:12320
    ds_read_b64_tr_b16 v[190:191], v7 offset:13088
    ds_read_b64_tr_b16 v[24:25], v10 offset:0
    ds_read_b64_tr_b16 v[26:27], v10 offset:768
    ds_read_b64_tr_b16 v[28:29], v10 offset:12288
    ds_read_b64_tr_b16 v[30:31], v10 offset:13056
    s_waitcnt lgkmcnt(0)
    s_waitcnt vmcnt(24)
    s_barrier
    s_add_u32 m0, s30, 49152
    s_mov_b32 s31, 3145728
    buffer_load_dwordx4 v3, s[16:19], s31 offen lds
    s_add_u32 m0, s30, 50176
    s_mov_b32 s31, 3145728
    buffer_load_dwordx4 v4, s[16:19], s31 offen lds
    s_add_u32 m0, s30, 51200
    s_mov_b32 s31, 3145728
    buffer_load_dwordx4 v5, s[16:19], s31 offen lds
    s_add_u32 m0, s30, 52224
    s_mov_b32 s31, 3244032
    buffer_load_dwordx4 v3, s[16:19], s31 offen lds
    s_add_u32 m0, s30, 53248
    s_mov_b32 s31, 3244032
    buffer_load_dwordx4 v4, s[16:19], s31 offen lds
    s_add_u32 m0, s30, 54272
    s_mov_b32 s31, 3244032
    buffer_load_dwordx4 v5, s[16:19], s31 offen lds
    v_add_u32 v7, 73728, v6
    v_add_u32 v10, 73728, v9
    ds_read_b64_tr_b16 a[8:9], v7 offset:0
    ds_read_b64_tr_b16 a[10:11], v7 offset:768
    ds_read_b64_tr_b16 a[12:13], v7 offset:12288
    ds_read_b64_tr_b16 a[14:15], v7 offset:13056
    ds_read_b64_tr_b16 a[88:89], v7 offset:32
    ds_read_b64_tr_b16 a[90:91], v7 offset:800
    ds_read_b64_tr_b16 a[92:93], v7 offset:12320
    ds_read_b64_tr_b16 a[94:95], v7 offset:13088
    ds_read_b64_tr_b16 a[168:169], v10 offset:0
    ds_read_b64_tr_b16 a[170:171], v10 offset:768
    ds_read_b64_tr_b16 a[172:173], v10 offset:12288
    ds_read_b64_tr_b16 a[174:175], v10 offset:13056
    s_waitcnt lgkmcnt(0)
    s_waitcnt vmcnt(24)
    s_barrier
    s_add_u32 m0, s30, 73728
    s_mov_b32 s31, 3145728
    buffer_load_dwordx4 v3, s[12:15], s31 offen lds
    s_add_u32 m0, s30, 74752
    s_mov_b32 s31, 3145728
    buffer_load_dwordx4 v4, s[12:15], s31 offen lds
    s_add_u32 m0, s30, 75776
    s_mov_b32 s31, 3145728
    buffer_load_dwordx4 v5, s[12:15], s31 offen lds
    s_add_u32 m0, s30, 76800
    s_mov_b32 s31, 3244032
    buffer_load_dwordx4 v3, s[12:15], s31 offen lds
    s_add_u32 m0, s30, 77824
    s_mov_b32 s31, 3244032
    buffer_load_dwordx4 v4, s[12:15], s31 offen lds
    s_add_u32 m0, s30, 78848
    s_mov_b32 s31, 3244032
    buffer_load_dwordx4 v5, s[12:15], s31 offen lds
    v_add_u32 v7, 98304, v6
    v_add_u32 v10, 98304, v9
    ds_read_b64_tr_b16 v[112:113], v7 offset:0
    ds_read_b64_tr_b16 v[114:115], v7 offset:768
    ds_read_b64_tr_b16 v[116:117], v7 offset:12288
    ds_read_b64_tr_b16 v[118:119], v7 offset:13056
    ds_read_b64_tr_b16 v[192:193], v7 offset:32
    ds_read_b64_tr_b16 v[194:195], v7 offset:800
    ds_read_b64_tr_b16 v[196:197], v7 offset:12320
    ds_read_b64_tr_b16 v[198:199], v7 offset:13088
    ds_read_b64_tr_b16 v[32:33], v10 offset:0
    ds_read_b64_tr_b16 v[34:35], v10 offset:768
    ds_read_b64_tr_b16 v[36:37], v10 offset:12288
    ds_read_b64_tr_b16 v[38:39], v10 offset:13056
    s_waitcnt lgkmcnt(0)
    s_waitcnt vmcnt(24)
    s_barrier
    s_add_u32 m0, s30, 98304
    s_mov_b32 s31, 3932160
    buffer_load_dwordx4 v3, s[16:19], s31 offen lds
    s_add_u32 m0, s30, 99328
    s_mov_b32 s31, 3932160
    buffer_load_dwordx4 v4, s[16:19], s31 offen lds
    s_add_u32 m0, s30, 100352
    s_mov_b32 s31, 3932160
    buffer_load_dwordx4 v5, s[16:19], s31 offen lds
    s_add_u32 m0, s30, 101376
    s_mov_b32 s31, 4030464
    buffer_load_dwordx4 v3, s[16:19], s31 offen lds
    s_add_u32 m0, s30, 102400
    s_mov_b32 s31, 4030464
    buffer_load_dwordx4 v4, s[16:19], s31 offen lds
    s_add_u32 m0, s30, 103424
    s_mov_b32 s31, 4030464
    buffer_load_dwordx4 v5, s[16:19], s31 offen lds
    v_add_u32 v7, 122880, v6
    v_add_u32 v10, 122880, v9
    ds_read_b64_tr_b16 a[16:17], v7 offset:0
    ds_read_b64_tr_b16 a[18:19], v7 offset:768
    ds_read_b64_tr_b16 a[20:21], v7 offset:12288
    ds_read_b64_tr_b16 a[22:23], v7 offset:13056
    ds_read_b64_tr_b16 a[96:97], v7 offset:32
    ds_read_b64_tr_b16 a[98:99], v7 offset:800
    ds_read_b64_tr_b16 a[100:101], v7 offset:12320
    ds_read_b64_tr_b16 a[102:103], v7 offset:13088
    ds_read_b64_tr_b16 a[176:177], v10 offset:0
    ds_read_b64_tr_b16 a[178:179], v10 offset:768
    ds_read_b64_tr_b16 a[180:181], v10 offset:12288
    ds_read_b64_tr_b16 a[182:183], v10 offset:13056
    s_waitcnt lgkmcnt(0)
    s_waitcnt vmcnt(24)
    s_barrier
    s_add_u32 m0, s30, 122880
    s_mov_b32 s31, 3932160
    buffer_load_dwordx4 v3, s[12:15], s31 offen lds
    s_add_u32 m0, s30, 123904
    s_mov_b32 s31, 3932160
    buffer_load_dwordx4 v4, s[12:15], s31 offen lds
    s_add_u32 m0, s30, 124928
    s_mov_b32 s31, 3932160
    buffer_load_dwordx4 v5, s[12:15], s31 offen lds
    s_add_u32 m0, s30, 125952
    s_mov_b32 s31, 4030464
    buffer_load_dwordx4 v3, s[12:15], s31 offen lds
    s_add_u32 m0, s30, 126976
    s_mov_b32 s31, 4030464
    buffer_load_dwordx4 v4, s[12:15], s31 offen lds
    s_add_u32 m0, s30, 128000
    s_mov_b32 s31, 4030464
    buffer_load_dwordx4 v5, s[12:15], s31 offen lds
    v_add_u32 v7, 0, v6
    v_add_u32 v10, 0, v9
    ds_read_b64_tr_b16 v[120:121], v7 offset:0
    ds_read_b64_tr_b16 v[122:123], v7 offset:768
    ds_read_b64_tr_b16 v[124:125], v7 offset:12288
    ds_read_b64_tr_b16 v[126:127], v7 offset:13056
    ds_read_b64_tr_b16 v[200:201], v7 offset:32
    ds_read_b64_tr_b16 v[202:203], v7 offset:800
    ds_read_b64_tr_b16 v[204:205], v7 offset:12320
    ds_read_b64_tr_b16 v[206:207], v7 offset:13088
    ds_read_b64_tr_b16 v[40:41], v10 offset:0
    ds_read_b64_tr_b16 v[42:43], v10 offset:768
    ds_read_b64_tr_b16 v[44:45], v10 offset:12288
    ds_read_b64_tr_b16 v[46:47], v10 offset:13056
    s_waitcnt lgkmcnt(0)
    s_waitcnt vmcnt(24)
    s_barrier
    s_add_u32 m0, s30, 0
    s_mov_b32 s31, 4718592
    buffer_load_dwordx4 v3, s[16:19], s31 offen lds
    s_add_u32 m0, s30, 1024
    s_mov_b32 s31, 4718592
    buffer_load_dwordx4 v4, s[16:19], s31 offen lds
    s_add_u32 m0, s30, 2048
    s_mov_b32 s31, 4718592
    buffer_load_dwordx4 v5, s[16:19], s31 offen lds
    s_add_u32 m0, s30, 3072
    s_mov_b32 s31, 4816896
    buffer_load_dwordx4 v3, s[16:19], s31 offen lds
    s_add_u32 m0, s30, 4096
    s_mov_b32 s31, 4816896
    buffer_load_dwordx4 v4, s[16:19], s31 offen lds
    s_add_u32 m0, s30, 5120
    s_mov_b32 s31, 4816896
    buffer_load_dwordx4 v5, s[16:19], s31 offen lds
    v_add_u32 v7, 24576, v6
    v_add_u32 v10, 24576, v9
    ds_read_b64_tr_b16 a[24:25], v7 offset:0
    ds_read_b64_tr_b16 a[26:27], v7 offset:768
    ds_read_b64_tr_b16 a[28:29], v7 offset:12288
    ds_read_b64_tr_b16 a[30:31], v7 offset:13056
    ds_read_b64_tr_b16 a[104:105], v7 offset:32
    ds_read_b64_tr_b16 a[106:107], v7 offset:800
    ds_read_b64_tr_b16 a[108:109], v7 offset:12320
    ds_read_b64_tr_b16 a[110:111], v7 offset:13088
    ds_read_b64_tr_b16 a[184:185], v10 offset:0
    ds_read_b64_tr_b16 a[186:187], v10 offset:768
    ds_read_b64_tr_b16 a[188:189], v10 offset:12288
    ds_read_b64_tr_b16 a[190:191], v10 offset:13056
    s_waitcnt lgkmcnt(0)
    s_waitcnt vmcnt(24)
    s_barrier
    s_add_u32 m0, s30, 24576
    s_mov_b32 s31, 4718592
    buffer_load_dwordx4 v3, s[12:15], s31 offen lds
    s_add_u32 m0, s30, 25600
    s_mov_b32 s31, 4718592
    buffer_load_dwordx4 v4, s[12:15], s31 offen lds
    s_add_u32 m0, s30, 26624
    s_mov_b32 s31, 4718592
    buffer_load_dwordx4 v5, s[12:15], s31 offen lds
    s_add_u32 m0, s30, 27648
    s_mov_b32 s31, 4816896
    buffer_load_dwordx4 v3, s[12:15], s31 offen lds
    s_add_u32 m0, s30, 28672
    s_mov_b32 s31, 4816896
    buffer_load_dwordx4 v4, s[12:15], s31 offen lds
    s_add_u32 m0, s30, 29696
    s_mov_b32 s31, 4816896
    buffer_load_dwordx4 v5, s[12:15], s31 offen lds
    v_add_u32 v7, 49152, v6
    v_add_u32 v10, 49152, v9
    ds_read_b64_tr_b16 v[128:129], v7 offset:0
    ds_read_b64_tr_b16 v[130:131], v7 offset:768
    ds_read_b64_tr_b16 v[132:133], v7 offset:12288
    ds_read_b64_tr_b16 v[134:135], v7 offset:13056
    ds_read_b64_tr_b16 v[208:209], v7 offset:32
    ds_read_b64_tr_b16 v[210:211], v7 offset:800
    ds_read_b64_tr_b16 v[212:213], v7 offset:12320
    ds_read_b64_tr_b16 v[214:215], v7 offset:13088
    ds_read_b64_tr_b16 v[48:49], v10 offset:0
    ds_read_b64_tr_b16 v[50:51], v10 offset:768
    ds_read_b64_tr_b16 v[52:53], v10 offset:12288
    ds_read_b64_tr_b16 v[54:55], v10 offset:13056
    s_waitcnt lgkmcnt(0)
    s_waitcnt vmcnt(24)
    s_barrier
    s_add_u32 m0, s30, 49152
    s_mov_b32 s31, 5505024
    buffer_load_dwordx4 v3, s[16:19], s31 offen lds
    s_add_u32 m0, s30, 50176
    s_mov_b32 s31, 5505024
    buffer_load_dwordx4 v4, s[16:19], s31 offen lds
    s_add_u32 m0, s30, 51200
    s_mov_b32 s31, 5505024
    buffer_load_dwordx4 v5, s[16:19], s31 offen lds
    s_add_u32 m0, s30, 52224
    s_mov_b32 s31, 5603328
    buffer_load_dwordx4 v3, s[16:19], s31 offen lds
    s_add_u32 m0, s30, 53248
    s_mov_b32 s31, 5603328
    buffer_load_dwordx4 v4, s[16:19], s31 offen lds
    s_add_u32 m0, s30, 54272
    s_mov_b32 s31, 5603328
    buffer_load_dwordx4 v5, s[16:19], s31 offen lds
    v_add_u32 v7, 73728, v6
    v_add_u32 v10, 73728, v9
    ds_read_b64_tr_b16 a[32:33], v7 offset:0
    ds_read_b64_tr_b16 a[34:35], v7 offset:768
    ds_read_b64_tr_b16 a[36:37], v7 offset:12288
    ds_read_b64_tr_b16 a[38:39], v7 offset:13056
    ds_read_b64_tr_b16 a[112:113], v7 offset:32
    ds_read_b64_tr_b16 a[114:115], v7 offset:800
    ds_read_b64_tr_b16 a[116:117], v7 offset:12320
    ds_read_b64_tr_b16 a[118:119], v7 offset:13088
    ds_read_b64_tr_b16 a[192:193], v10 offset:0
    ds_read_b64_tr_b16 a[194:195], v10 offset:768
    ds_read_b64_tr_b16 a[196:197], v10 offset:12288
    ds_read_b64_tr_b16 a[198:199], v10 offset:13056
    s_waitcnt lgkmcnt(0)
    s_waitcnt vmcnt(24)
    s_barrier
    s_add_u32 m0, s30, 73728
    s_mov_b32 s31, 5505024
    buffer_load_dwordx4 v3, s[12:15], s31 offen lds
    s_add_u32 m0, s30, 74752
    s_mov_b32 s31, 5505024
    buffer_load_dwordx4 v4, s[12:15], s31 offen lds
    s_add_u32 m0, s30, 75776
    s_mov_b32 s31, 5505024
    buffer_load_dwordx4 v5, s[12:15], s31 offen lds
    s_add_u32 m0, s30, 76800
    s_mov_b32 s31, 5603328
    buffer_load_dwordx4 v3, s[12:15], s31 offen lds
    s_add_u32 m0, s30, 77824
    s_mov_b32 s31, 5603328
    buffer_load_dwordx4 v4, s[12:15], s31 offen lds
    s_add_u32 m0, s30, 78848
    s_mov_b32 s31, 5603328
    buffer_load_dwordx4 v5, s[12:15], s31 offen lds
    v_add_u32 v7, 98304, v6
    v_add_u32 v10, 98304, v9
    ds_read_b64_tr_b16 v[136:137], v7 offset:0
    ds_read_b64_tr_b16 v[138:139], v7 offset:768
    ds_read_b64_tr_b16 v[140:141], v7 offset:12288
    ds_read_b64_tr_b16 v[142:143], v7 offset:13056
    ds_read_b64_tr_b16 v[216:217], v7 offset:32
    ds_read_b64_tr_b16 v[218:219], v7 offset:800
    ds_read_b64_tr_b16 v[220:221], v7 offset:12320
    ds_read_b64_tr_b16 v[222:223], v7 offset:13088
    ds_read_b64_tr_b16 v[56:57], v10 offset:0
    ds_read_b64_tr_b16 v[58:59], v10 offset:768
    ds_read_b64_tr_b16 v[60:61], v10 offset:12288
    ds_read_b64_tr_b16 v[62:63], v10 offset:13056
    s_waitcnt lgkmcnt(0)
    s_waitcnt vmcnt(24)
    s_barrier
    s_add_u32 m0, s30, 98304
    s_mov_b32 s31, 6291456
    buffer_load_dwordx4 v3, s[16:19], s31 offen lds
    s_add_u32 m0, s30, 99328
    s_mov_b32 s31, 6291456
    buffer_load_dwordx4 v4, s[16:19], s31 offen lds
    s_add_u32 m0, s30, 100352
    s_mov_b32 s31, 6291456
    buffer_load_dwordx4 v5, s[16:19], s31 offen lds
    s_add_u32 m0, s30, 101376
    s_mov_b32 s31, 6389760
    buffer_load_dwordx4 v3, s[16:19], s31 offen lds
    s_add_u32 m0, s30, 102400
    s_mov_b32 s31, 6389760
    buffer_load_dwordx4 v4, s[16:19], s31 offen lds
    s_add_u32 m0, s30, 103424
    s_mov_b32 s31, 6389760
    buffer_load_dwordx4 v5, s[16:19], s31 offen lds
    v_add_u32 v7, 122880, v6
    v_add_u32 v10, 122880, v9
    ds_read_b64_tr_b16 a[40:41], v7 offset:0
    ds_read_b64_tr_b16 a[42:43], v7 offset:768
    ds_read_b64_tr_b16 a[44:45], v7 offset:12288
    ds_read_b64_tr_b16 a[46:47], v7 offset:13056
    ds_read_b64_tr_b16 a[120:121], v7 offset:32
    ds_read_b64_tr_b16 a[122:123], v7 offset:800
    ds_read_b64_tr_b16 a[124:125], v7 offset:12320
    ds_read_b64_tr_b16 a[126:127], v7 offset:13088
    ds_read_b64_tr_b16 a[200:201], v10 offset:0
    ds_read_b64_tr_b16 a[202:203], v10 offset:768
    ds_read_b64_tr_b16 a[204:205], v10 offset:12288
    ds_read_b64_tr_b16 a[206:207], v10 offset:13056
    s_waitcnt lgkmcnt(0)
    s_waitcnt vmcnt(24)
    s_barrier
    s_add_u32 m0, s30, 122880
    s_mov_b32 s31, 6291456
    buffer_load_dwordx4 v3, s[12:15], s31 offen lds
    s_add_u32 m0, s30, 123904
    s_mov_b32 s31, 6291456
    buffer_load_dwordx4 v4, s[12:15], s31 offen lds
    s_add_u32 m0, s30, 124928
    s_mov_b32 s31, 6291456
    buffer_load_dwordx4 v5, s[12:15], s31 offen lds
    s_add_u32 m0, s30, 125952
    s_mov_b32 s31, 6389760
    buffer_load_dwordx4 v3, s[12:15], s31 offen lds
    s_add_u32 m0, s30, 126976
    s_mov_b32 s31, 6389760
    buffer_load_dwordx4 v4, s[12:15], s31 offen lds
    s_add_u32 m0, s30, 128000
    s_mov_b32 s31, 6389760
    buffer_load_dwordx4 v5, s[12:15], s31 offen lds
    v_add_u32 v7, 0, v6
    v_add_u32 v10, 0, v9
    ds_read_b64_tr_b16 v[144:145], v7 offset:0
    ds_read_b64_tr_b16 v[146:147], v7 offset:768
    ds_read_b64_tr_b16 v[148:149], v7 offset:12288
    ds_read_b64_tr_b16 v[150:151], v7 offset:13056
    ds_read_b64_tr_b16 v[224:225], v7 offset:32
    ds_read_b64_tr_b16 v[226:227], v7 offset:800
    ds_read_b64_tr_b16 v[228:229], v7 offset:12320
    ds_read_b64_tr_b16 v[230:231], v7 offset:13088
    ds_read_b64_tr_b16 v[64:65], v10 offset:0
    ds_read_b64_tr_b16 v[66:67], v10 offset:768
    ds_read_b64_tr_b16 v[68:69], v10 offset:12288
    ds_read_b64_tr_b16 v[70:71], v10 offset:13056
    s_waitcnt lgkmcnt(0)
    s_waitcnt vmcnt(24)
    s_barrier
    s_add_u32 m0, s30, 0
    s_mov_b32 s31, 7077888
    buffer_load_dwordx4 v3, s[16:19], s31 offen lds
    s_add_u32 m0, s30, 1024
    s_mov_b32 s31, 7077888
    buffer_load_dwordx4 v4, s[16:19], s31 offen lds
    s_add_u32 m0, s30, 2048
    s_mov_b32 s31, 7077888
    buffer_load_dwordx4 v5, s[16:19], s31 offen lds
    s_add_u32 m0, s30, 3072
    s_mov_b32 s31, 7176192
    buffer_load_dwordx4 v3, s[16:19], s31 offen lds
    s_add_u32 m0, s30, 4096
    s_mov_b32 s31, 7176192
    buffer_load_dwordx4 v4, s[16:19], s31 offen lds
    s_add_u32 m0, s30, 5120
    s_mov_b32 s31, 7176192
    buffer_load_dwordx4 v5, s[16:19], s31 offen lds
    v_add_u32 v7, 24576, v6
    v_add_u32 v10, 24576, v9
    ds_read_b64_tr_b16 a[48:49], v7 offset:0
    ds_read_b64_tr_b16 a[50:51], v7 offset:768
    ds_read_b64_tr_b16 a[52:53], v7 offset:12288
    ds_read_b64_tr_b16 a[54:55], v7 offset:13056
    ds_read_b64_tr_b16 a[128:129], v7 offset:32
    ds_read_b64_tr_b16 a[130:131], v7 offset:800
    ds_read_b64_tr_b16 a[132:133], v7 offset:12320
    ds_read_b64_tr_b16 a[134:135], v7 offset:13088
    ds_read_b64_tr_b16 a[208:209], v10 offset:0
    ds_read_b64_tr_b16 a[210:211], v10 offset:768
    ds_read_b64_tr_b16 a[212:213], v10 offset:12288
    ds_read_b64_tr_b16 a[214:215], v10 offset:13056
    s_waitcnt lgkmcnt(0)
    s_waitcnt vmcnt(24)
    s_barrier
    s_add_u32 m0, s30, 24576
    s_mov_b32 s31, 7077888
    buffer_load_dwordx4 v3, s[12:15], s31 offen lds
    s_add_u32 m0, s30, 25600
    s_mov_b32 s31, 7077888
    buffer_load_dwordx4 v4, s[12:15], s31 offen lds
    s_add_u32 m0, s30, 26624
    s_mov_b32 s31, 7077888
    buffer_load_dwordx4 v5, s[12:15], s31 offen lds
    s_add_u32 m0, s30, 27648
    s_mov_b32 s31, 7176192
    buffer_load_dwordx4 v3, s[12:15], s31 offen lds
    s_add_u32 m0, s30, 28672
    s_mov_b32 s31, 7176192
    buffer_load_dwordx4 v4, s[12:15], s31 offen lds
    s_add_u32 m0, s30, 29696
    s_mov_b32 s31, 7176192
    buffer_load_dwordx4 v5, s[12:15], s31 offen lds
    v_add_u32 v7, 49152, v6
    v_add_u32 v10, 49152, v9
    ds_read_b64_tr_b16 v[152:153], v7 offset:0
    ds_read_b64_tr_b16 v[154:155], v7 offset:768
    ds_read_b64_tr_b16 v[156:157], v7 offset:12288
    ds_read_b64_tr_b16 v[158:159], v7 offset:13056
    ds_read_b64_tr_b16 v[232:233], v7 offset:32
    ds_read_b64_tr_b16 v[234:235], v7 offset:800
    ds_read_b64_tr_b16 v[236:237], v7 offset:12320
    ds_read_b64_tr_b16 v[238:239], v7 offset:13088
    ds_read_b64_tr_b16 v[72:73], v10 offset:0
    ds_read_b64_tr_b16 v[74:75], v10 offset:768
    ds_read_b64_tr_b16 v[76:77], v10 offset:12288
    ds_read_b64_tr_b16 v[78:79], v10 offset:13056
    s_waitcnt lgkmcnt(0)
    s_waitcnt vmcnt(24)
    s_barrier
    v_add_u32 v7, 73728, v6
    v_add_u32 v10, 73728, v9
    ds_read_b64_tr_b16 a[56:57], v7 offset:0
    ds_read_b64_tr_b16 a[58:59], v7 offset:768
    ds_read_b64_tr_b16 a[60:61], v7 offset:12288
    ds_read_b64_tr_b16 a[62:63], v7 offset:13056
    ds_read_b64_tr_b16 a[136:137], v7 offset:32
    ds_read_b64_tr_b16 a[138:139], v7 offset:800
    ds_read_b64_tr_b16 a[140:141], v7 offset:12320
    ds_read_b64_tr_b16 a[142:143], v7 offset:13088
    ds_read_b64_tr_b16 a[216:217], v10 offset:0
    ds_read_b64_tr_b16 a[218:219], v10 offset:768
    ds_read_b64_tr_b16 a[220:221], v10 offset:12288
    ds_read_b64_tr_b16 a[222:223], v10 offset:13056
    s_waitcnt lgkmcnt(0)
    s_waitcnt vmcnt(18)
    s_barrier
    v_add_u32 v7, 98304, v6
    v_add_u32 v10, 98304, v9
    ds_read_b64_tr_b16 v[160:161], v7 offset:0
    ds_read_b64_tr_b16 v[162:163], v7 offset:768
    ds_read_b64_tr_b16 v[164:165], v7 offset:12288
    ds_read_b64_tr_b16 v[166:167], v7 offset:13056
    ds_read_b64_tr_b16 v[240:241], v7 offset:32
    ds_read_b64_tr_b16 v[242:243], v7 offset:800
    ds_read_b64_tr_b16 v[244:245], v7 offset:12320
    ds_read_b64_tr_b16 v[246:247], v7 offset:13088
    ds_read_b64_tr_b16 v[80:81], v10 offset:0
    ds_read_b64_tr_b16 v[82:83], v10 offset:768
    ds_read_b64_tr_b16 v[84:85], v10 offset:12288
    ds_read_b64_tr_b16 v[86:87], v10 offset:13056
    s_waitcnt lgkmcnt(0)
    s_waitcnt vmcnt(12)
    s_barrier
    v_add_u32 v7, 122880, v6
    v_add_u32 v10, 122880, v9
    ds_read_b64_tr_b16 a[64:65], v7 offset:0
    ds_read_b64_tr_b16 a[66:67], v7 offset:768
    ds_read_b64_tr_b16 a[68:69], v7 offset:12288
    ds_read_b64_tr_b16 a[70:71], v7 offset:13056
    ds_read_b64_tr_b16 a[144:145], v7 offset:32
    ds_read_b64_tr_b16 a[146:147], v7 offset:800
    ds_read_b64_tr_b16 a[148:149], v7 offset:12320
    ds_read_b64_tr_b16 a[150:151], v7 offset:13088
    ds_read_b64_tr_b16 a[224:225], v10 offset:0
    ds_read_b64_tr_b16 a[226:227], v10 offset:768
    ds_read_b64_tr_b16 a[228:229], v10 offset:12288
    ds_read_b64_tr_b16 a[230:231], v10 offset:13056
    s_waitcnt lgkmcnt(0)
    s_waitcnt vmcnt(6)
    s_barrier
    v_add_u32 v7, 0, v6
    v_add_u32 v10, 0, v9
    ds_read_b64_tr_b16 v[168:169], v7 offset:0
    ds_read_b64_tr_b16 v[170:171], v7 offset:768
    ds_read_b64_tr_b16 v[172:173], v7 offset:12288
    ds_read_b64_tr_b16 v[174:175], v7 offset:13056
    ds_read_b64_tr_b16 v[248:249], v7 offset:32
    ds_read_b64_tr_b16 v[250:251], v7 offset:800
    ds_read_b64_tr_b16 v[252:253], v7 offset:12320
    ds_read_b64_tr_b16 v[254:255], v7 offset:13088
    ds_read_b64_tr_b16 v[88:89], v10 offset:0
    ds_read_b64_tr_b16 v[90:91], v10 offset:768
    ds_read_b64_tr_b16 v[92:93], v10 offset:12288
    ds_read_b64_tr_b16 v[94:95], v10 offset:13056
    s_waitcnt lgkmcnt(0)
    s_waitcnt vmcnt(0)
    s_barrier
    v_add_u32 v7, 24576, v6
    v_add_u32 v10, 24576, v9
    ds_read_b64_tr_b16 a[72:73], v7 offset:0
    ds_read_b64_tr_b16 a[74:75], v7 offset:768
    ds_read_b64_tr_b16 a[76:77], v7 offset:12288
    ds_read_b64_tr_b16 a[78:79], v7 offset:13056
    ds_read_b64_tr_b16 a[152:153], v7 offset:32
    ds_read_b64_tr_b16 a[154:155], v7 offset:800
    ds_read_b64_tr_b16 a[156:157], v7 offset:12320
    ds_read_b64_tr_b16 a[158:159], v7 offset:13088
    ds_read_b64_tr_b16 a[232:233], v10 offset:0
    ds_read_b64_tr_b16 a[234:235], v10 offset:768
    ds_read_b64_tr_b16 a[236:237], v10 offset:12288
    ds_read_b64_tr_b16 a[238:239], v10 offset:13056
    s_waitcnt lgkmcnt(0)
    s_barrier
    s_mul_i32 s28, s24, 20480
    v_add_u32 v11, s28, v2
    ds_write_b128 v11, v[16:19] offset:0
    ds_write_b128 v11, v[20:23] offset:1024
    ds_write_b128 v11, v[24:27] offset:2048
    ds_write_b128 v11, v[28:31] offset:3072
    ds_write_b128 v11, v[32:35] offset:4096
    ds_write_b128 v11, v[36:39] offset:5120
    ds_write_b128 v11, v[40:43] offset:6144
    ds_write_b128 v11, v[44:47] offset:7168
    s_waitcnt lgkmcnt(0)
    ds_write_b128 v11, v[48:51] offset:8192
    ds_write_b128 v11, v[52:55] offset:9216
    ds_write_b128 v11, v[56:59] offset:10240
    ds_write_b128 v11, v[60:63] offset:11264
    ds_write_b128 v11, v[64:67] offset:12288
    ds_write_b128 v11, v[68:71] offset:13312
    ds_write_b128 v11, v[72:75] offset:14336
    ds_write_b128 v11, v[76:79] offset:15360
    s_waitcnt lgkmcnt(0)
    ds_write_b128 v11, v[80:83] offset:16384
    ds_write_b128 v11, v[84:87] offset:17408
    ds_write_b128 v11, v[88:91] offset:18432
    ds_write_b128 v11, v[92:95] offset:19456
    s_waitcnt lgkmcnt(0)
    v_add_u32 v3, 4096, v2
    v_add_u32 v4, 8192, v2
    v_and_b32 v8, 15, v1
    v_lshlrev_b32 v8, 3, v8
    v_lshrrev_b32 v12, 5, v1
    v_lshlrev_b32 v12, 6, v12
    v_xor_b32 v8, v8, v12
    v_lshrrev_b32 v12, 4, v1
    v_lshl_add_u32 v8, v12, 7, v8
    v_add_u32 v8, 81920, v8
    v_lshrrev_b32 v9, 2, v1
    v_lshlrev_b32 v9, 3, v9
    v_bfe_u32 v12, v1, 1, 1
    v_lshlrev_b32 v12, 6, v12
    v_xor_b32 v9, v9, v12
    v_and_b32 v12, 3, v1
    v_lshl_add_u32 v9, v12, 7, v9
    v_add_u32 v9, 81920, v9
    v_mov_b32 v10, 0x4444
    v_mov_b32 v12, 0xeeee
    v_and_b32 v13, 8, v1
    v_cmp_ne_u32 vcc, 0, v13
    s_nop 1
    v_cndmask_b32 v10, v10, v12, vcc
    s_mul_i32 s28, s24, 1536
    v_add_u32 v8, s28, v8
    v_add_u32 v6, s28, v9
    v_and_b32 v12, 7, v1
    v_lshrrev_b32 v13, 3, v1
    v_xor_b32 v7, v12, v13
    v_lshlrev_b32 v7, 4, v7
    v_lshl_add_u32 v0, v12, 7, v7
    v_lshl_add_u32 v7, v13, 7, v7
    s_lshl_b32 s28, s24, 10
    s_add_u32 s28, s28, 143360
    v_add_u32 v0, s28, v0
    v_add_u32 v7, 143360, v7
    v_and_b32 v12, 3, v1
    v_lshlrev_b32 v12, 2, v12
    v_bfe_u32 v13, v1, 2, 1
    v_lshl_add_u32 v12, v13, 7, v12
    v_cmp_lt_u32 vcc, 7, v1
    v_mov_b32 v13, 16
    s_nop 0
    v_cndmask_b32 v12, v12, v13, vcc
L_qk_st:
    buffer_load_dword v13, v12, s[8:11], 0 offen sc1
    s_waitcnt vmcnt(0)
    v_cmp_gt_u32 vcc, 32, v13
    v_readlane_b32 s28, v13, 8
    s_cbranch_vccnz L_qk_st_no
    s_cmp_ge_u32 s28, 64
    s_cbranch_scc1 L_qk_st_ok
L_qk_st_no:
    s_sleep 4
    s_sub_u32 s27, s27, 1
    s_cbranch_scc1 L_fail
    s_branch L_qk_st
L_qk_st_ok:
    s_lshl_b32 s74, s26, 19
    s_add_u32 s74, s74, 192937984
    s_mov_b32 s77, 0
    s_mov_b32 s78, 0
    s_mul_i32 s79, s75, 12288
    v_lshrrev_b32 v12, 4, v1
    v_and_b32 v13, 1, v12
    v_lshlrev_b32 v13, 1, v13
    v_lshrrev_b32 v15, 1, v12
    v_add_u32 v13, v13, v15
    v_lshlrev_b32 v13, 2, v13
    s_cmp_eq_u32 s24, 0
    s_cbranch_scc0 L_qk_c1
    v_lshrrev_b32 v15, 3, v1
    v_lshlrev_b32 v15, 4, v15
    v_bfe_u32 v12, v1, 1, 2
    v_lshl_add_u32 v14, v12, 7, v15
    v_and_b32 v13, 1, v1
    v_lshl_add_u32 v14, v13, 3, v14
    v_and_b32 v13, 1, v12
    v_lshl_add_u32 v15, v13, 3, v15
    v_lshrrev_b32 v13, 1, v12
    v_lshl_add_u32 v15, v13, 2, v15
    s_lshr_b32 s28, s25, 1
    s_mul_i32 s28, s28, 1280
    s_and_b32 s29, s25, 1
    s_lshl_b32 s31, s29, 9
    s_add_u32 s31, s31, s28
    s_add_u32 s31, s31, 12288
    v_add_u32 v14, s31, v14
    s_lshl_b32 s31, s29, 7
    s_add_u32 s31, s31, s28
    s_add_u32 s31, s31, 13312
    v_add_u32 v15, s31, v15
    s_branch L_qk_c3
L_qk_c1:
    s_cmp_eq_u32 s24, 3
    s_cbranch_scc1 L_qk_c2
    s_sub_u32 s28, s24, 1
    s_mul_i32 s29, s28, 10240
    s_add_u32 s29, s29, 20480
    s_lshl_b32 s31, s25, 10
    s_add_u32 s31, s31, s29
    v_add_u32 v14, s31, v2
    v_and_b32 v15, 15, v1
    v_lshl_add_u32 v15, v15, 4, v13
    s_lshl_b32 s31, s25, 8
    s_add_u32 s31, s31, s29
    s_add_u32 s31, s31, 8192
    v_add_u32 v15, s31, v15
    v_and_b32 v13, 15, v1
    s_lshl_b32 s28, s28, 4
    v_add_u32 v13, s28, v13
    v_lshlrev_b32 v12, 2, v12
    v_sub_u32 v13, v13, v12
    v_cmp_gt_i32 s[48:49], 0, v13
    v_cmp_gt_i32 s[50:51], 1, v13
    v_cmp_gt_i32 s[52:53], 2, v13
    v_cmp_gt_i32 s[54:55], 3, v13
    v_cmp_gt_i32 s[56:57], 16, v13
    v_cmp_gt_i32 s[58:59], 17, v13
    v_cmp_gt_i32 s[60:61], 18, v13
    v_cmp_gt_i32 s[62:63], 19, v13
    s_branch L_qk_c3
L_qk_c2:
    s_mul_i32 s28, s75, 6
    v_and_b32 v14, 1, v1
    v_mul_u32_u24 v14, 5, v14
    v_add_u32 v14, s28, v14
    v_lshrrev_b32 v14, 3, v14
    v_lshlrev_b32 v14, 7, v14
    v_add_u32 v15, 192413696, v14
    v_add_u32 v14, 192416768, v14
L_qk_c3:
    s_mov_b32 s80, 1037384597
    s_mov_b32 s81, 0xf149f2ca
    s_mov_b32 s82, 0x55555555
    s_mov_b32 s83, 0x55555555
    s_mov_b32 s64, 1
    s_mov_b32 s66, 0
    s_mov_b32 s65, 0
    s_mov_b32 s67, 0
    s_mov_b32 s68, 0
    s_mov_b32 s69, 0
    s_cmp_eq_u32 s24, 3
    s_cbranch_scc0 L_qk_pf0_skip
    s_cmp_ge_u32 s64, 65
    s_cbranch_scc1 L_qk_pf0_skip
    s_cmp_ge_u32 s67, s64
    s_cbranch_scc1 L_qk_pf0_qk
    buffer_load_dword v13, v15, s[4:7], 0 offen sc1
    s_waitcnt vmcnt(0)
    v_readlane_b32 s28, v13, 0
    v_readlane_b32 s29, v13, 1
    s_nop 3
    s_min_u32 s67, s28, s29
L_qk_pf0_qk:
    s_cmp_ge_u32 s78, s64
    s_cbranch_scc1 L_qk_pf0_w_ok
L_qk_pf0_w:
    buffer_load_dword v12, v14, s[4:7], 0 offen sc1
    s_waitcnt vmcnt(0)
    s_nop 1
    v_min_u32_dpp v12, v12, v12 row_shr:1 row_mask:0xf bank_mask:0xf
    s_nop 1
    v_min_u32_dpp v12, v12, v12 row_shr:2 row_mask:0xf bank_mask:0xf
    s_nop 1
    v_min_u32_dpp v12, v12, v12 row_shr:4 row_mask:0xf bank_mask:0xf
    s_nop 1
    v_min_u32_dpp v12, v12, v12 row_shr:8 row_mask:0xf bank_mask:0xf
    s_nop 1
    v_min_u32_dpp v12, v12, v12 row_bcast:15 row_mask:0xa bank_mask:0xf
    s_nop 1
    v_min_u32_dpp v12, v12, v12 row_bcast:31 row_mask:0xc bank_mask:0xf
    s_nop 0
    v_readlane_b32 s78, v12, 63
    s_nop 3
    s_cmp_ge_u32 s78, s64
    s_cbranch_scc1 L_qk_pf0_w_ok
    s_sub_u32 s27, s27, 1
    s_cbranch_scc1 L_fail
    s_branch L_qk_pf0_w
L_qk_pf0_w_ok:
    s_add_u32 m0, s66, 94208
    s_add_u32 s28, s79, 25165824
    buffer_load_dwordx4 v2, s[4:7], s28 offen offset:0 sc1 lds
    buffer_load_dwordx4 v2, s[4:7], s28 offen offset:1024 sc1 lds
    buffer_load_dwordx4 v2, s[4:7], s28 offen offset:2048 sc1 lds
    buffer_load_dwordx4 v2, s[4:7], s28 offen offset:3072 sc1 lds
    s_add_u32 m0, s66, 98304
    s_add_u32 s28, s79, 25169920
    buffer_load_dwordx4 v2, s[4:7], s28 offen offset:0 sc1 lds
    buffer_load_dwordx4 v2, s[4:7], s28 offen offset:1024 sc1 lds
    buffer_load_dwordx4 v2, s[4:7], s28 offen offset:2048 sc1 lds
    buffer_load_dwordx4 v2, s[4:7], s28 offen offset:3072 sc1 lds
    s_add_u32 m0, s66, 102400
    s_add_u32 s28, s79, 25174016
    buffer_load_dwordx4 v2, s[4:7], s28 offen offset:0 sc1 lds
    buffer_load_dwordx4 v2, s[4:7], s28 offen offset:1024 sc1 lds
    buffer_load_dwordx4 v2, s[4:7], s28 offen offset:2048 sc1 lds
    buffer_load_dwordx4 v2, s[4:7], s28 offen offset:3072 sc1 lds
    s_mov_b32 s68, 1
    s_cmp_ge_u32 s67, s64
    s_cbranch_scc0 L_qk_pf0_noq
    s_mov_b32 s68, 0
    s_add_u32 m0, s66, 106496
    s_add_u32 s28, s79, 0
    buffer_load_dwordx4 v2, s[4:7], s28 offen offset:0 sc1 lds
    buffer_load_dwordx4 v2, s[4:7], s28 offen offset:1024 sc1 lds
    buffer_load_dwordx4 v2, s[4:7], s28 offen offset:2048 sc1 lds
    buffer_load_dwordx4 v2, s[4:7], s28 offen offset:3072 sc1 lds
    s_add_u32 m0, s66, 110592
    s_add_u32 s28, s79, 4096
    buffer_load_dwordx4 v2, s[4:7], s28 offen offset:0 sc1 lds
    buffer_load_dwordx4 v2, s[4:7], s28 offen offset:1024 sc1 lds
    buffer_load_dwordx4 v2, s[4:7], s28 offen offset:2048 sc1 lds
    buffer_load_dwordx4 v2, s[4:7], s28 offen offset:3072 sc1 lds
    s_add_u32 m0, s66, 114688
    s_add_u32 s28, s79, 8192
    buffer_load_dwordx4 v2, s[4:7], s28 offen offset:0 sc1 lds
    buffer_load_dwordx4 v2, s[4:7], s28 offen offset:1024 sc1 lds
    buffer_load_dwordx4 v2, s[4:7], s28 offen offset:2048 sc1 lds
    buffer_load_dwordx4 v2, s[4:7], s28 offen offset:3072 sc1 lds
L_qk_pf0_noq:
    s_mov_b32 s69, s79
    s_add_u32 s79, s79, 393216
L_qk_pf0_skip:
    s_and_b32 s28, s77, 3
    s_lshl_b32 s28, s28, 17
    s_add_u32 s76, s74, s28
    s_mov_b32 s95, 0
L_qk_loop:
    ds_read_b128 v[80:83], v11 offset:0
    ds_read_b128 v[84:87], v11 offset:1024
    ds_read_b128 v[88:91], v11 offset:2048
    ds_read_b128 v[92:95], v11 offset:3072
    ds_read_b128 v[96:99], v11 offset:4096
    ds_read_b128 v[100:103], v11 offset:5120
    ds_read_b128 v[104:107], v11 offset:6144
    ds_read_b128 v[108:111], v11 offset:7168
    s_lshl_b32 s28, s24, 10
    s_add_u32 s28, s28, s65
    s_add_u32 s28, s28, 94208
    v_add_u32 v12, s28, v2
    s_lshr_b32 s28, s24, 1
    s_lshl_b32 s28, s28, 10
    s_and_b32 s29, s24, 1
    s_lshl_b32 s29, s29, 3
    s_add_u32 s28, s28, s29
    s_add_u32 s28, s28, s65
    s_add_u32 s28, s28, 98304
    v_add_u32 v13, s28, v2
    s_xor_b32 s66, s65, 24576
    s_waitcnt vmcnt(0) lgkmcnt(0)
    s_barrier
    v_mov_b32 v56, 0
    v_mov_b32 v57, 0
    v_mov_b32 v58, 0
    v_mov_b32 v59, 0
    v_mov_b32 v60, 0
    v_mov_b32 v61, 0
    v_mov_b32 v62, 0
    v_mov_b32 v63, 0
    v_mov_b32 v64, 0
    v_mov_b32 v65, 0
    v_mov_b32 v66, 0
    v_mov_b32 v67, 0
    v_mov_b32 v68, 0
    v_mov_b32 v69, 0
    v_mov_b32 v70, 0
    v_mov_b32 v71, 0
    v_mov_b32 v72, 0
    v_mov_b32 v73, 0
    v_mov_b32 v74, 0
    v_mov_b32 v75, 0
    v_mov_b32 v76, 0
    v_mov_b32 v77, 0
    v_mov_b32 v78, 0
    v_mov_b32 v79, 0
    s_branch L_qk_poll
L_qk_poll_r:
    s_sub_u32 s27, s27, 1
    s_cbranch_scc1 L_fail
L_qk_poll:
    buffer_load_dwordx4 v[16:19], v2, s[4:7], s76 offen offset:0 sc1
    buffer_load_dwordx4 v[20:23], v2, s[4:7], s76 offen offset:1024 sc1
    buffer_load_dwordx4 v[24:27], v2, s[4:7], s76 offen offset:2048 sc1
    s_waitcnt vmcnt(0)
    v_max3_u32 v44, v16, v17, v18
    v_max3_u32 v45, v19, v20, v21
    v_max3_u32 v46, v22, v23, v24
    v_max3_u32 v47, v25, v26, v27
    v_max3_u32 v48, v44, v45, v46
    v_max_u32 v49, v48, v47
    v_cmp_eq_u32 vcc, -1, v49
    s_cbranch_vccnz L_qk_poll_r
L_qk_e0:
    buffer_load_dwordx4 v[28:31], v2, s[4:7], s76 offen offset:3072 sc1
    v_smfmac_f32_16x16x64_bf16 v[56:59], v[16:19], a[0:7], v10
    v_smfmac_f32_16x16x64_bf16 v[60:63], v[16:19], a[80:87], v10
    v_smfmac_f32_16x16x64_bf16 v[64:67], v[16:19], a[160:167], v10
    buffer_load_dwordx4 v[32:35], v3, s[4:7], s76 offen offset:0 sc1
    v_smfmac_f32_16x16x64_bf16 v[68:71], v[16:19], a[240:247], v10
    v_smfmac_f32_16x16x64_bf16 v[72:75], v[16:19], v[176:183], v10
    v_smfmac_f32_16x16x64_bf16 v[76:79], v[16:19], v[80:87], v10
    buffer_load_dwordx4 v[36:39], v3, s[4:7], s76 offen offset:1024 sc1
    v_smfmac_f32_16x16x64_bf16 v[56:59], v[20:23], a[8:15], v10
    v_smfmac_f32_16x16x64_bf16 v[60:63], v[20:23], a[88:95], v10
    v_smfmac_f32_16x16x64_bf16 v[64:67], v[20:23], a[168:175], v10
    buffer_load_dwordx4 v[40:43], v3, s[4:7], s76 offen offset:2048 sc1
    v_smfmac_f32_16x16x64_bf16 v[68:71], v[20:23], a[248:255], v10
    v_smfmac_f32_16x16x64_bf16 v[72:75], v[20:23], v[184:191], v10
    v_smfmac_f32_16x16x64_bf16 v[76:79], v[20:23], v[88:95], v10
    buffer_load_dwordx4 v[44:47], v3, s[4:7], s76 offen offset:3072 sc1
    v_smfmac_f32_16x16x64_bf16 v[56:59], v[24:27], a[16:23], v10
    v_smfmac_f32_16x16x64_bf16 v[60:63], v[24:27], a[96:103], v10
    s_waitcnt vmcnt(4)
    v_max3_u32 v5, v28, v29, v30
    v_smfmac_f32_16x16x64_bf16 v[64:67], v[24:27], a[176:183], v10
    buffer_load_dwordx4 v[48:51], v4, s[4:7], s76 offen offset:0 sc1
    v_max_u32 v5, v5, v31
    v_smfmac_f32_16x16x64_bf16 v[68:71], v[24:27], v[112:119], v10
    v_cmp_eq_u32 vcc, -1, v5
    v_smfmac_f32_16x16x64_bf16 v[72:75], v[24:27], v[192:199], v10
    v_smfmac_f32_16x16x64_bf16 v[76:79], v[24:27], v[96:103], v10
    buffer_load_dwordx4 v[52:55], v4, s[4:7], s76 offen offset:1024 sc1
    s_cbranch_vccnz L_qk_rtv0_3
L_qk_bkv0_3:
L_qk_g3:
    v_smfmac_f32_16x16x64_bf16 v[56:59], v[28:31], a[24:31], v10
    ds_read_b128 v[80:83], v11 offset:8192
    ds_read_b128 v[84:87], v11 offset:9216
    v_smfmac_f32_16x16x64_bf16 v[60:63], v[28:31], a[104:111], v10
    s_waitcnt vmcnt(5)
    v_max3_u32 v5, v32, v33, v34
    v_smfmac_f32_16x16x64_bf16 v[64:67], v[28:31], a[184:191], v10
    v_max_u32 v5, v5, v35
    v_smfmac_f32_16x16x64_bf16 v[68:71], v[28:31], v[120:127], v10
    v_cmp_eq_u32 vcc, -1, v5
    v_smfmac_f32_16x16x64_bf16 v[72:75], v[28:31], v[200:207], v10
    v_smfmac_f32_16x16x64_bf16 v[76:79], v[28:31], v[104:111], v10
    s_cbranch_vccnz L_qk_rt4
L_qk_bk4:
    v_smfmac_f32_16x16x64_bf16 v[56:59], v[32:35], a[32:39], v10
    ds_read_b128 v[88:91], v11 offset:10240
    ds_read_b128 v[92:95], v11 offset:11264
    v_smfmac_f32_16x16x64_bf16 v[60:63], v[32:35], a[112:119], v10
    s_waitcnt vmcnt(4)
    v_max3_u32 v5, v36, v37, v38
    v_smfmac_f32_16x16x64_bf16 v[64:67], v[32:35], a[192:199], v10
    v_max_u32 v5, v5, v39
    v_smfmac_f32_16x16x64_bf16 v[68:71], v[32:35], v[128:135], v10
    v_cmp_eq_u32 vcc, -1, v5
    v_smfmac_f32_16x16x64_bf16 v[72:75], v[32:35], v[208:215], v10
    s_waitcnt lgkmcnt(2)
    v_smfmac_f32_16x16x64_bf16 v[76:79], v[32:35], v[80:87], v10
    s_cbranch_vccnz L_qk_rt5
L_qk_bk5:
    v_smfmac_f32_16x16x64_bf16 v[56:59], v[36:39], a[40:47], v10
    ds_read_b128 v[80:83], v11 offset:12288
    ds_read_b128 v[84:87], v11 offset:13312
    v_smfmac_f32_16x16x64_bf16 v[60:63], v[36:39], a[120:127], v10
    s_waitcnt vmcnt(3)
    v_max3_u32 v5, v40, v41, v42
    v_smfmac_f32_16x16x64_bf16 v[64:67], v[36:39], a[200:207], v10
    v_max_u32 v5, v5, v43
    v_smfmac_f32_16x16x64_bf16 v[68:71], v[36:39], v[136:143], v10
    v_cmp_eq_u32 vcc, -1, v5
    v_smfmac_f32_16x16x64_bf16 v[72:75], v[36:39], v[216:223], v10
    s_waitcnt lgkmcnt(2)
    v_smfmac_f32_16x16x64_bf16 v[76:79], v[36:39], v[88:95], v10
    s_cbranch_vccnz L_qk_rt6
L_qk_bk6:
    v_smfmac_f32_16x16x64_bf16 v[56:59], v[40:43], a[48:55], v10
    ds_read_b128 v[88:91], v11 offset:14336
    ds_read_b128 v[92:95], v11 offset:15360
    v_smfmac_f32_16x16x64_bf16 v[60:63], v[40:43], a[128:135], v10
    s_waitcnt vmcnt(2)
    ds_read_b128 v[28:31], v12
    v_max3_u32 v5, v44, v45, v46
    v_smfmac_f32_16x16x64_bf16 v[64:67], v[40:43], a[208:215], v10
    ds_read_b128 v[32:35], v12 offset:6144
    v_max_u32 v5, v5, v47
    v_smfmac_f32_16x16x64_bf16 v[68:71], v[40:43], v[144:151], v10
    v_cmp_eq_u32 vcc, -1, v5
    v_smfmac_f32_16x16x64_bf16 v[72:75], v[40:43], v[224:231], v10
    s_waitcnt lgkmcnt(4)
    v_smfmac_f32_16x16x64_bf16 v[76:79], v[40:43], v[80:87], v10
    s_cbranch_vccnz L_qk_rt7
L_qk_bk7:
    v_smfmac_f32_16x16x64_bf16 v[56:59], v[44:47], a[56:63], v10
    s_waitcnt vmcnt(0)
    ds_read_b128 v[80:83], v11 offset:16384
    v_max3_u32 v5, v48, v49, v50
    v_smfmac_f32_16x16x64_bf16 v[60:63], v[44:47], a[136:143], v10
    ds_read_b128 v[84:87], v11 offset:17408
    ds_read_b64 v[36:37], v13
    v_max3_u32 v5, v5, v51, v52
    v_smfmac_f32_16x16x64_bf16 v[64:67], v[44:47], a[216:223], v10
    ds_read_b64 v[38:39], v13 offset:6144
    v_max3_u32 v5, v5, v53, v54
    v_max_u32 v5, v5, v55
    v_smfmac_f32_16x16x64_bf16 v[68:71], v[44:47], v[152:159], v10
    v_cmp_eq_u32 vcc, -1, v5
    v_smfmac_f32_16x16x64_bf16 v[72:75], v[44:47], v[232:239], v10
    s_waitcnt lgkmcnt(6)
    v_smfmac_f32_16x16x64_bf16 v[76:79], v[44:47], v[88:95], v10
    s_cbranch_vccnz L_qk_rt89
L_qk_bk89:
    v_smfmac_f32_16x16x64_bf16 v[56:59], v[48:51], a[64:71], v10
    ds_read_b128 v[88:91], v11 offset:18432
    ds_read_b128 v[92:95], v11 offset:19456
    v_mov_b32 v22, 0
    v_smfmac_f32_16x16x64_bf16 v[56:59], v[52:55], a[72:79], v10
    s_nop 1
    v_mov_b32 v23, 0
    v_smfmac_f32_16x16x64_bf16 v[60:63], v[48:51], a[144:151], v10
    s_nop 1
    v_mov_b32 v22, 0
    v_smfmac_f32_16x16x64_bf16 v[60:63], v[52:55], a[152:159], v10
    s_nop 1
    v_cvt_pk_bf16_f32 v56, v56, v57
    v_smfmac_f32_16x16x64_bf16 v[64:67], v[48:51], a[224:231], v10
    s_waitcnt lgkmcnt(4)
    s_nop 0
    v_cvt_pk_bf16_f32 v57, v58, v59
    v_smfmac_f32_16x16x64_bf16 v[64:67], v[52:55], a[232:239], v10
    ds_write_b64 v8, v[56:57] offset:0
    s_nop 0
    v_cvt_pk_bf16_f32 v60, v60, v61
    v_smfmac_f32_16x16x64_bf16 v[76:79], v[48:51], v[80:87], v10
    s_waitcnt lgkmcnt(1)
    s_nop 0
    v_cvt_pk_bf16_f32 v61, v62, v63
    v_smfmac_f32_16x16x64_bf16 v[76:79], v[52:55], v[88:95], v10
    ds_write_b64 v8, v[60:61] offset:512
    s_nop 0
    v_cvt_pk_bf16_f32 v64, v64, v65
    v_smfmac_f32_16x16x64_bf16 v[68:71], v[48:51], v[160:167], v10
    ds_read_b64_tr_b16 v[16:17], v6
    ds_read_b64_tr_b16 v[18:19], v6 offset:512
    v_cvt_pk_bf16_f32 v65, v66, v67
    v_smfmac_f32_16x16x64_bf16 v[68:71], v[52:55], v[168:175], v10
    ds_write_b64 v8, v[64:65] offset:1024
    ds_read_b64_tr_b16 v[20:21], v6 offset:1024
    v_cvt_pk_bf16_f32 v76, v76, v77
    v_smfmac_f32_16x16x64_bf16 v[72:75], v[48:51], v[240:247], v10
    s_nop 1
    v_cvt_pk_bf16_f32 v77, v78, v79
    v_smfmac_f32_16x16x64_bf16 v[72:75], v[52:55], v[248:255], v10
    ds_write_b64 v8, v[76:77] offset:7168
    ds_read_b64_tr_b16 v[42:43], v6 offset:7168
    v_cvt_pk_bf16_f32 v68, v68, v69
    v_cvt_pk_bf16_f32 v69, v70, v71
    ds_write_b64 v8, v[68:69] offset:6144
    ds_read_b64_tr_b16 v[24:25], v6 offset:6144
    s_nop 1
    v_cvt_pk_bf16_f32 v72, v72, v73
    v_cvt_pk_bf16_f32 v73, v74, v75
    ds_write_b64 v8, v[72:73] offset:6656
    ds_read_b64_tr_b16 v[26:27], v6 offset:6656
    s_waitcnt lgkmcnt(6)
    v_mfma_f32_16x16x32_bf16 v[80:83], v[28:31], v[16:19], 0
    v_mfma_f32_16x16x32_bf16 v[84:87], v[32:35], v[16:19], 0
    v_mfma_f32_16x16x32_bf16 v[80:83], v[36:39], v[20:23], v[80:83]
    v_mfma_f32_16x16x32_bf16 v[84:87], v[38:41], v[20:23], v[84:87]
    s_waitcnt lgkmcnt(4)
    v_mfma_f32_16x16x32_bf16 v[88:91], v[42:45], v[20:23], 0
    s_waitcnt lgkmcnt(0)
    v_mfma_f32_16x16x32_bf16 v[88:91], v[24:27], v[16:19], v[88:91]
    s_nop 2
    v_add_f32_dpp v92, v80, v80 row_ror:8 row_mask:0xf bank_mask:0x3
    v_add_f32_dpp v93, v81, v81 row_ror:8 row_mask:0xf bank_mask:0x3
    v_add_f32_dpp v94, v82, v82 row_ror:8 row_mask:0xf bank_mask:0x3
    v_add_f32_dpp v95, v83, v83 row_ror:8 row_mask:0xf bank_mask:0x3
    v_add_f32_dpp v92, v84, v84 row_ror:8 row_mask:0xf bank_mask:0xc
    v_add_f32_dpp v93, v85, v85 row_ror:8 row_mask:0xf bank_mask:0xc
    v_add_f32_dpp v94, v86, v86 row_ror:8 row_mask:0xf bank_mask:0xc
    v_add_f32_dpp v95, v87, v87 row_ror:8 row_mask:0xf bank_mask:0xc
    ds_write_b128 v0, v[92:95]
    v_permlane32_swap_b32 v88, v89
    v_permlane32_swap_b32 v90, v91
    v_add_f32 v88, v88, v89
    v_add_f32 v89, v90, v91
    s_nop 0
    v_add_f32_dpp v96, v88, v88 row_ror:8 row_mask:0xf bank_mask:0x3
    v_add_f32_dpp v96, v89, v89 row_ror:8 row_mask:0xf bank_mask:0xc
    ds_write_b32 v0, v96 offset:4096
    s_cmp_eq_u32 s24, 0
    s_waitcnt lgkmcnt(0)
    s_barrier
    s_cbranch_scc0 L_qk_x
    ds_read_b128 v[16:19], v7 offset:0
    ds_read_b32 v32, v7 offset:4096
    ds_read_b128 v[20:23], v7 offset:1024
    ds_read_b32 v33, v7 offset:5120
    ds_read_b128 v[24:27], v7 offset:2048
    ds_read_b32 v34, v7 offset:6144
    ds_read_b128 v[28:31], v7 offset:3072
    ds_read_b32 v35, v7 offset:7168
    s_waitcnt lgkmcnt(4)
    v_pk_add_f32 v[16:17], v[16:17], v[20:21]
    v_pk_add_f32 v[18:19], v[18:19], v[22:23]
    v_add_f32 v32, v32, v33
    s_waitcnt lgkmcnt(0)
    v_pk_add_f32 v[24:25], v[24:25], v[28:29]
    v_pk_add_f32 v[26:27], v[26:27], v[30:31]
    v_add_f32 v34, v34, v35
    v_pk_add_f32 v[92:93], v[16:17], v[24:25]
    v_pk_add_f32 v[94:95], v[18:19], v[26:27]
    v_add_f32 v96, v32, v34
    v_max3_f32 v97, v92, v93, v94
    v_max3_f32 v97, v97, v95, v96
    s_nop 1
    v_max_f32_dpp v97, v97, v97 quad_perm:[1,0,3,2] row_mask:0xf bank_mask:0xf
    s_nop 1
    v_max_f32_dpp v97, v97, v97 quad_perm:[2,3,0,1] row_mask:0xf bank_mask:0xf
    s_nop 1
    v_max_f32_dpp v97, v97, v97 row_half_mirror row_mask:0xf bank_mask:0xf
    v_mul_f32 v97, s80, v97
    v_fma_f32 v92, v92, s80, -v97
    v_fma_f32 v93, v93, s80, -v97
    v_fma_f32 v94, v94, s80, -v97
    v_fma_f32 v95, v95, s80, -v97
    v_fma_f32 v96, v96, s80, -v97
    v_exp_f32 v92, v92
    v_exp_f32 v93, v93
    v_exp_f32 v94, v94
    v_exp_f32 v95, v95
    v_exp_f32 v96, v96
    v_add_f32 v97, v92, v93
    v_add_f32 v98, v94, v95
    v_add_f32 v97, v97, v96
    v_add_f32 v97, v97, v98
    s_nop 1
    v_add_f32_dpp v97, v97, v97 quad_perm:[1,0,3,2] row_mask:0xf bank_mask:0xf
    s_nop 1
    v_add_f32_dpp v97, v97, v97 quad_perm:[2,3,0,1] row_mask:0xf bank_mask:0xf
    s_nop 1
    v_add_f32_dpp v97, v97, v97 row_half_mirror row_mask:0xf bank_mask:0xf
    v_rcp_f32 v97, v97
    s_nop 0
    v_mul_f32 v96, v96, v97
    v_mul_f32 v92, v92, v97
    v_mul_f32 v93, v93, v97
    v_mul_f32 v94, v94, v97
    v_mul_f32 v95, v95, v97
    v_mov_b32_dpp v98, v96 quad_perm:[1,0,3,2] row_mask:0xf bank_mask:0xf
    v_cvt_pk_bf16_f32 v100, v92, v93
    v_cvt_pk_bf16_f32 v101, v94, v95
    v_cvt_pk_bf16_f32 v102, v96, v98
    v_min_u32 v100, -2, v100
    v_min_u32 v101, -2, v101
    v_min_u32 v102, -2, v102
    buffer_store_dwordx2 v[100:101], v14, s[4:7], s76 offen
    s_mov_b64 exec, s[82:83]
    buffer_store_dword v102, v15, s[4:7], s76 offen
    s_mov_b64 exec, -1
    s_barrier
    s_add_u32 s28, s77, 3
    s_and_b32 s28, s28, 3
    s_lshl_b32 s28, s28, 17
    s_add_u32 s28, s28, s74
    v_mov_b32 v104, -1
    v_mov_b32 v105, -1
    buffer_store_dwordx2 v[104:105], v14, s[4:7], s28 offen
    buffer_store_dword v104, v15, s[4:7], s28 offen
    s_branch L_qk_next
L_qk_x:
    s_cmp_eq_u32 s24, 3
    s_cbranch_scc1 L_qk_w3
    s_barrier
    s_mul_i32 s28, s24, 6144
    s_add_u32 s28, s28, 100352
    s_add_u32 s28, s28, s65
    v_add_u32 v13, s28, v2
    s_add_u32 s28, s65, 94208
    v_add_u32 v12, s28, v2
    ds_read_b128 v[16:19], v12 offset:0
    ds_read_b128 v[20:23], v12 offset:1024
    ds_read_b128 v[24:27], v12 offset:2048
    ds_read_b128 v[28:31], v12 offset:3072
    ds_read_b128 v[32:35], v12 offset:4096
    ds_read_b128 v[36:39], v12 offset:5120
    ds_read_b128 v[40:43], v12 offset:6144
    ds_read_b128 v[44:47], v12 offset:7168
    ds_read_b128 v[48:51], v12 offset:8192
    ds_read_b128 v[96:99], v12 offset:9216
    ds_read_b128 v[100:103], v12 offset:10240
    ds_read_b128 v[104:107], v12 offset:11264
    s_waitcnt lgkmcnt(6)
    ds_read_b128 v[56:59], v13 offset:0
    ds_read_b64_tr_b16 v[68:69], v9 offset:6144
    ds_read_b64_tr_b16 v[70:71], v9 offset:6656
    ds_read_b128 v[60:63], v13 offset:1024
    ds_read_b64_tr_b16 v[72:73], v9 offset:7680
    ds_read_b64_tr_b16 v[74:75], v9 offset:8192
    ds_read_b128 v[64:67], v13 offset:2048
    ds_read_b64_tr_b16 v[76:77], v9 offset:9216
    ds_read_b64_tr_b16 v[78:79], v9 offset:9728
    s_waitcnt lgkmcnt(6)
    v_mfma_f32_16x16x32_bf16 v[88:91], v[68:71], v[56:59], 0
    v_mfma_f32_16x16x32_bf16 v[80:83], v[16:19], v[56:59], 0
    v_mfma_f32_16x16x32_bf16 v[84:87], v[40:43], v[56:59], 0
    ds_read_b128 v[56:59], v13 offset:3072
    ds_read_b64_tr_b16 v[68:69], v9 offset:10752
    ds_read_b64_tr_b16 v[70:71], v9 offset:11264
    s_waitcnt lgkmcnt(6)
    v_mfma_f32_16x16x32_bf16 v[88:91], v[72:75], v[60:63], v[88:91]
    v_mfma_f32_16x16x32_bf16 v[80:83], v[20:23], v[60:63], v[80:83]
    v_mfma_f32_16x16x32_bf16 v[84:87], v[44:47], v[60:63], v[84:87]
    ds_read_b128 v[60:63], v13 offset:4096
    ds_read_b64_tr_b16 v[72:73], v9 offset:7168
    ds_read_b64_tr_b16 v[74:75], v9 offset:8704
    s_waitcnt lgkmcnt(6)
    v_mfma_f32_16x16x32_bf16 v[88:91], v[76:79], v[64:67], v[88:91]
    v_mfma_f32_16x16x32_bf16 v[80:83], v[24:27], v[64:67], v[80:83]
    v_mfma_f32_16x16x32_bf16 v[84:87], v[48:51], v[64:67], v[84:87]
    ds_read_b128 v[64:67], v13 offset:5120
    ds_read_b64_tr_b16 v[76:77], v9 offset:10240
    ds_read_b64_tr_b16 v[78:79], v9 offset:11776
    s_waitcnt lgkmcnt(6)
    v_mfma_f32_16x16x32_bf16 v[88:91], v[68:71], v[56:59], v[88:91]
    v_mfma_f32_16x16x32_bf16 v[80:83], v[28:31], v[56:59], v[80:83]
    v_mfma_f32_16x16x32_bf16 v[84:87], v[96:99], v[56:59], v[84:87]
    s_waitcnt lgkmcnt(3)
    v_mfma_f32_16x16x32_bf16 v[88:91], v[72:75], v[60:63], v[88:91]
    v_mfma_f32_16x16x32_bf16 v[80:83], v[32:35], v[60:63], v[80:83]
    v_mfma_f32_16x16x32_bf16 v[84:87], v[100:103], v[60:63], v[84:87]
    s_waitcnt lgkmcnt(0)
    v_mfma_f32_16x16x32_bf16 v[88:91], v[76:79], v[64:67], v[88:91]
    v_mfma_f32_16x16x32_bf16 v[80:83], v[36:39], v[64:67], v[80:83]
    v_mfma_f32_16x16x32_bf16 v[84:87], v[104:107], v[64:67], v[84:87]
    s_nop 5
    v_permlane32_swap_b32 v88, v89
    v_permlane32_swap_b32 v90, v91
    v_add_f32 v88, v88, v89
    v_add_f32 v89, v90, v91
    v_mov_b32 v97, s81
    v_cndmask_b32 v80, v80, v97, s[48:49]
    v_cndmask_b32 v81, v81, v97, s[50:51]
    v_cndmask_b32 v82, v82, v97, s[52:53]
    v_cndmask_b32 v83, v83, v97, s[54:55]
    v_cndmask_b32 v84, v84, v97, s[56:57]
    v_cndmask_b32 v85, v85, v97, s[58:59]
    v_cndmask_b32 v86, v86, v97, s[60:61]
    v_cndmask_b32 v87, v87, v97, s[62:63]
    v_max3_f32 v97, v80, v81, v82
    v_max3_f32 v97, v97, v83, v84
    v_max3_f32 v97, v97, v85, v86
    v_max3_f32 v97, v97, v87, v88
    v_max_f32 v97, v97, v89
    v_mov_b32 v98, v97
    s_nop 1
    v_permlane16_swap_b32 v97, v98
    v_max_f32 v97, v97, v98
    v_mov_b32 v98, v97
    s_nop 1
    v_permlane32_swap_b32 v97, v98
    v_max_f32 v97, v97, v98
    v_mul_f32 v97, s80, v97
    v_fma_f32 v80, v80, s80, -v97
    v_fma_f32 v81, v81, s80, -v97
    v_fma_f32 v82, v82, s80, -v97
    v_fma_f32 v83, v83, s80, -v97
    v_fma_f32 v84, v84, s80, -v97
    v_fma_f32 v85, v85, s80, -v97
    v_fma_f32 v86, v86, s80, -v97
    v_fma_f32 v87, v87, s80, -v97
    v_fma_f32 v88, v88, s80, -v97
    v_fma_f32 v89, v89, s80, -v97
    v_exp_f32 v80, v80
    v_exp_f32 v81, v81
    v_exp_f32 v82, v82
    v_exp_f32 v83, v83
    v_exp_f32 v84, v84
    v_exp_f32 v85, v85
    v_exp_f32 v86, v86
    v_exp_f32 v87, v87
    v_exp_f32 v88, v88
    v_exp_f32 v89, v89
    s_nop 0
    v_add_f32 v97, v80, v81
    v_add_f32 v97, v97, v82
    v_add_f32 v97, v97, v83
    v_add_f32 v97, v97, v84
    v_add_f32 v97, v97, v85
    v_add_f32 v97, v97, v86
    v_add_f32 v97, v97, v87
    v_add_f32 v97, v97, v88
    v_add_f32 v97, v97, v89
    v_mov_b32 v98, v97
    s_nop 1
    v_permlane16_swap_b32 v97, v98
    v_add_f32 v97, v97, v98
    v_mov_b32 v98, v97
    s_nop 1
    v_permlane32_swap_b32 v97, v98
    v_add_f32 v97, v97, v98
    v_rcp_f32 v97, v97
    s_nop 0
    v_mul_f32 v80, v80, v97
    v_mul_f32 v81, v81, v97
    v_mul_f32 v82, v82, v97
    v_mul_f32 v83, v83, v97
    v_mul_f32 v84, v84, v97
    v_mul_f32 v85, v85, v97
    v_mul_f32 v86, v86, v97
    v_mul_f32 v87, v87, v97
    v_mul_f32 v88, v88, v97
    v_mul_f32 v89, v89, v97
    v_cvt_pk_bf16_f32 v100, v80, v81
    v_cvt_pk_bf16_f32 v101, v82, v83
    v_cvt_pk_bf16_f32 v102, v84, v85
    v_cvt_pk_bf16_f32 v103, v86, v87
    v_cvt_pk_bf16_f32 v104, v88, v89
    buffer_store_dwordx4 v[100:103], v14, s[4:7], s76 offen
    buffer_store_dword v104, v15, s[4:7], s76 offen
    s_branch L_qk_next
L_qk_w3:
    s_cmp_eq_u32 s68, 0
    s_cbranch_scc1 L_qk_w3b
    s_add_u32 s64, s77, 1
    s_cmp_ge_u32 s67, s64
    s_cbranch_scc1 L_qk_qw_ok
L_qk_qw:
    buffer_load_dword v12, v15, s[4:7], 0 offen sc1
    s_waitcnt vmcnt(0)
    s_nop 1
    v_min_u32_dpp v12, v12, v12 row_shr:1 row_mask:0xf bank_mask:0xf
    s_nop 1
    v_min_u32_dpp v12, v12, v12 row_shr:2 row_mask:0xf bank_mask:0xf
    s_nop 1
    v_min_u32_dpp v12, v12, v12 row_shr:4 row_mask:0xf bank_mask:0xf
    s_nop 1
    v_min_u32_dpp v12, v12, v12 row_shr:8 row_mask:0xf bank_mask:0xf
    s_nop 1
    v_min_u32_dpp v12, v12, v12 row_bcast:15 row_mask:0xa bank_mask:0xf
    s_nop 1
    v_min_u32_dpp v12, v12, v12 row_bcast:31 row_mask:0xc bank_mask:0xf
    s_nop 0
    v_readlane_b32 s67, v12, 63
    s_nop 3
    s_cmp_ge_u32 s67, s64
    s_cbranch_scc1 L_qk_qw_ok
    s_sub_u32 s27, s27, 1
    s_cbranch_scc1 L_fail
    s_branch L_qk_qw
L_qk_qw_ok:
    s_add_u32 m0, s65, 106496
    s_add_u32 s28, s69, 0
    buffer_load_dwordx4 v2, s[4:7], s28 offen offset:0 sc1 lds
    buffer_load_dwordx4 v2, s[4:7], s28 offen offset:1024 sc1 lds
    buffer_load_dwordx4 v2, s[4:7], s28 offen offset:2048 sc1 lds
    buffer_load_dwordx4 v2, s[4:7], s28 offen offset:3072 sc1 lds
    s_add_u32 m0, s65, 110592
    s_add_u32 s28, s69, 4096
    buffer_load_dwordx4 v2, s[4:7], s28 offen offset:0 sc1 lds
    buffer_load_dwordx4 v2, s[4:7], s28 offen offset:1024 sc1 lds
    buffer_load_dwordx4 v2, s[4:7], s28 offen offset:2048 sc1 lds
    buffer_load_dwordx4 v2, s[4:7], s28 offen offset:3072 sc1 lds
    s_add_u32 m0, s65, 114688
    s_add_u32 s28, s69, 8192
    buffer_load_dwordx4 v2, s[4:7], s28 offen offset:0 sc1 lds
    buffer_load_dwordx4 v2, s[4:7], s28 offen offset:1024 sc1 lds
    buffer_load_dwordx4 v2, s[4:7], s28 offen offset:2048 sc1 lds
    buffer_load_dwordx4 v2, s[4:7], s28 offen offset:3072 sc1 lds
    s_waitcnt vmcnt(0)
L_qk_w3b:
    s_barrier
    s_add_u32 s64, s77, 2
    s_cmp_eq_u32 s24, 3
    s_cbranch_scc0 L_qk_pf_skip
    s_cmp_ge_u32 s64, 65
    s_cbranch_scc1 L_qk_pf_skip
    s_cmp_ge_u32 s67, s64
    s_cbranch_scc1 L_qk_pf_qk
    buffer_load_dword v13, v15, s[4:7], 0 offen sc1
    s_waitcnt vmcnt(0)
    v_readlane_b32 s28, v13, 0
    v_readlane_b32 s29, v13, 1
    s_nop 3
    s_min_u32 s67, s28, s29
L_qk_pf_qk:
    s_cmp_ge_u32 s78, s64
    s_cbranch_scc1 L_qk_pf_w_ok
L_qk_pf_w:
    buffer_load_dword v12, v14, s[4:7], 0 offen sc1
    s_waitcnt vmcnt(0)
    s_nop 1
    v_min_u32_dpp v12, v12, v12 row_shr:1 row_mask:0xf bank_mask:0xf
    s_nop 1
    v_min_u32_dpp v12, v12, v12 row_shr:2 row_mask:0xf bank_mask:0xf
    s_nop 1
    v_min_u32_dpp v12, v12, v12 row_shr:4 row_mask:0xf bank_mask:0xf
    s_nop 1
    v_min_u32_dpp v12, v12, v12 row_shr:8 row_mask:0xf bank_mask:0xf
    s_nop 1
    v_min_u32_dpp v12, v12, v12 row_bcast:15 row_mask:0xa bank_mask:0xf
    s_nop 1
    v_min_u32_dpp v12, v12, v12 row_bcast:31 row_mask:0xc bank_mask:0xf
    s_nop 0
    v_readlane_b32 s78, v12, 63
    s_nop 3
    s_cmp_ge_u32 s78, s64
    s_cbranch_scc1 L_qk_pf_w_ok
    s_sub_u32 s27, s27, 1
    s_cbranch_scc1 L_fail
    s_branch L_qk_pf_w
L_qk_pf_w_ok:
    s_add_u32 m0, s66, 94208
    s_add_u32 s28, s79, 25165824
    buffer_load_dwordx4 v2, s[4:7], s28 offen offset:0 sc1 lds
    buffer_load_dwordx4 v2, s[4:7], s28 offen offset:1024 sc1 lds
    buffer_load_dwordx4 v2, s[4:7], s28 offen offset:2048 sc1 lds
    buffer_load_dwordx4 v2, s[4:7], s28 offen offset:3072 sc1 lds
    s_add_u32 m0, s66, 98304
    s_add_u32 s28, s79, 25169920
    buffer_load_dwordx4 v2, s[4:7], s28 offen offset:0 sc1 lds
    buffer_load_dwordx4 v2, s[4:7], s28 offen offset:1024 sc1 lds
    buffer_load_dwordx4 v2, s[4:7], s28 offen offset:2048 sc1 lds
    buffer_load_dwordx4 v2, s[4:7], s28 offen offset:3072 sc1 lds
    s_add_u32 m0, s66, 102400
    s_add_u32 s28, s79, 25174016
    buffer_load_dwordx4 v2, s[4:7], s28 offen offset:0 sc1 lds
    buffer_load_dwordx4 v2, s[4:7], s28 offen offset:1024 sc1 lds
    buffer_load_dwordx4 v2, s[4:7], s28 offen offset:2048 sc1 lds
    buffer_load_dwordx4 v2, s[4:7], s28 offen offset:3072 sc1 lds
    s_mov_b32 s68, 1
    s_cmp_ge_u32 s67, s64
    s_cbranch_scc0 L_qk_pf_noq
    s_mov_b32 s68, 0
    s_add_u32 m0, s66, 106496
    s_add_u32 s28, s79, 0
    buffer_load_dwordx4 v2, s[4:7], s28 offen offset:0 sc1 lds
    buffer_load_dwordx4 v2, s[4:7], s28 offen offset:1024 sc1 lds
    buffer_load_dwordx4 v2, s[4:7], s28 offen offset:2048 sc1 lds
    buffer_load_dwordx4 v2, s[4:7], s28 offen offset:3072 sc1 lds
    s_add_u32 m0, s66, 110592
    s_add_u32 s28, s79, 4096
    buffer_load_dwordx4 v2, s[4:7], s28 offen offset:0 sc1 lds
    buffer_load_dwordx4 v2, s[4:7], s28 offen offset:1024 sc1 lds
    buffer_load_dwordx4 v2, s[4:7], s28 offen offset:2048 sc1 lds
    buffer_load_dwordx4 v2, s[4:7], s28 offen offset:3072 sc1 lds
    s_add_u32 m0, s66, 114688
    s_add_u32 s28, s79, 8192
    buffer_load_dwordx4 v2, s[4:7], s28 offen offset:0 sc1 lds
    buffer_load_dwordx4 v2, s[4:7], s28 offen offset:1024 sc1 lds
    buffer_load_dwordx4 v2, s[4:7], s28 offen offset:2048 sc1 lds
    buffer_load_dwordx4 v2, s[4:7], s28 offen offset:3072 sc1 lds
L_qk_pf_noq:
    s_mov_b32 s69, s79
    s_add_u32 s79, s79, 393216
L_qk_pf_skip:
L_qk_next:
    s_mov_b32 s65, s66
    s_add_u32 s77, s77, 1
    s_and_b32 s28, s77, 3
    s_lshl_b32 s28, s28, 17
    s_add_u32 s76, s74, s28
    s_cmp_lt_u32 s77, 64
    s_cbranch_scc1 L_qk_loop
    s_waitcnt vmcnt(0)
    s_barrier
    s_cmp_eq_u32 s24, 0
    s_cbranch_scc0 L_qk_end
    v_mov_b32 v100, 0
    v_mov_b32 v101, 0
    buffer_store_dwordx2 v[100:101], v14, s[4:7], s76 offen
    buffer_store_dword v100, v15, s[4:7], s76 offen
L_qk_end:
    s_waitcnt vmcnt(0)
    s_endpgm
L_qk_rtv0_3:
    s_add_u32 s95, s95, 1
    s_sub_u32 s27, s27, 1
    s_cbranch_scc1 L_fail
    buffer_load_dwordx4 v[28:31], v2, s[4:7], s76 offen offset:3072 sc1
    s_waitcnt vmcnt(0)
    v_max3_u32 v5, v28, v29, v30
    v_max_u32 v5, v5, v31
    v_cmp_eq_u32 vcc, -1, v5
    s_cbranch_vccnz L_qk_rtv0_3
    s_branch L_qk_bkv0_3
L_qk_rt4:
    s_add_u32 s95, s95, 1
    s_sub_u32 s27, s27, 1
    s_cbranch_scc1 L_fail
    buffer_load_dwordx4 v[32:35], v3, s[4:7], s76 offen offset:0 sc1
    s_waitcnt vmcnt(0)
    v_max3_u32 v5, v32, v33, v34
    v_max_u32 v5, v5, v35
    v_cmp_eq_u32 vcc, -1, v5
    s_cbranch_vccnz L_qk_rt4
    s_branch L_qk_bk4
L_qk_rt5:
    s_add_u32 s95, s95, 1
    s_sub_u32 s27, s27, 1
    s_cbranch_scc1 L_fail
    buffer_load_dwordx4 v[36:39], v3, s[4:7], s76 offen offset:1024 sc1
    s_waitcnt vmcnt(0)
    v_max3_u32 v5, v36, v37, v38
    v_max_u32 v5, v5, v39
    v_cmp_eq_u32 vcc, -1, v5
    s_cbranch_vccnz L_qk_rt5
    s_branch L_qk_bk5
L_qk_rt6:
    s_add_u32 s95, s95, 1
    s_sub_u32 s27, s27, 1
    s_cbranch_scc1 L_fail
    buffer_load_dwordx4 v[40:43], v3, s[4:7], s76 offen offset:2048 sc1
    s_waitcnt vmcnt(0)
    v_max3_u32 v5, v40, v41, v42
    v_max_u32 v5, v5, v43
    v_cmp_eq_u32 vcc, -1, v5
    s_cbranch_vccnz L_qk_rt6
    s_branch L_qk_bk6
L_qk_rt7:
    s_add_u32 s95, s95, 1
    s_sub_u32 s27, s27, 1
    s_cbranch_scc1 L_fail
    buffer_load_dwordx4 v[44:47], v3, s[4:7], s76 offen offset:3072 sc1
    s_waitcnt vmcnt(0)
    v_max3_u32 v5, v44, v45, v46
    v_max_u32 v5, v5, v47
    v_cmp_eq_u32 vcc, -1, v5
    s_cbranch_vccnz L_qk_rt7
    s_branch L_qk_bk7
L_qk_rt89:
    s_sub_u32 s27, s27, 1
    s_cbranch_scc1 L_fail
    buffer_load_dwordx4 v[48:51], v4, s[4:7], s76 offen offset:0 sc1
    buffer_load_dwordx4 v[52:55], v4, s[4:7], s76 offen offset:1024 sc1
    s_waitcnt vmcnt(0)
    v_max3_u32 v5, v48, v49, v50
    v_max3_u32 v5, v5, v51, v52
    v_max3_u32 v5, v5, v53, v54
    v_max_u32 v5, v5, v55
    v_cmp_eq_u32 vcc, -1, v5
    s_cbranch_vccnz L_qk_rt89
    s_branch L_qk_bk89
L_vo:
    s_sub_u32 s25, s25, 8
    s_lshl_b32 s75, s26, 3
    s_add_u32 s75, s75, s25
    s_mov_b32 s12, s44
    s_mov_b32 s13, s45
    s_mov_b32 s14, 7864320
    s_mov_b32 s15, 0x20000
    s_mov_b32 s16, s46
    s_mov_b32 s17, s47
    s_mov_b32 s18, 7864320
    s_mov_b32 s19, 0x20000
    v_add_u32 v3, 0, v1
    v_mul_u32_u24 v12, 2731, v3
    v_lshrrev_b32 v12, 16, v12
    v_mul_u32_u24 v13, 24, v12
    v_sub_u32 v13, v3, v13
    v_mul_u32_u24 v12, 12288, v12
    v_lshl_add_u32 v3, v13, 4, v12
    v_add_u32 v4, 64, v1
    v_mul_u32_u24 v12, 2731, v4
    v_lshrrev_b32 v12, 16, v12
    v_mul_u32_u24 v13, 24, v12
    v_sub_u32 v13, v4, v13
    v_mul_u32_u24 v12, 12288, v12
    v_lshl_add_u32 v4, v13, 4, v12
    v_add_u32 v5, 128, v1
    v_mul_u32_u24 v12, 2731, v5
    v_lshrrev_b32 v12, 16, v12
    v_mul_u32_u24 v13, 24, v12
    v_sub_u32 v13, v5, v13
    v_mul_u32_u24 v12, 12288, v12
    v_lshl_add_u32 v5, v13, 4, v12
    s_mul_i32 s28, s75, 384
    s_mul_i32 s29, s24, 196608
    s_add_u32 s28, s28, s29
    v_add_u32 v3, s28, v3
    v_add_u32 v4, s28, v4
    v_add_u32 v5, s28, v5
    v_and_b32 v6, 8, v1
    v_bfe_u32 v12, v1, 2, 1
    v_add_u32 v6, v6, v12
    v_lshrrev_b32 v12, 5, v1
    v_lshl_add_u32 v6, v12, 4, v6
    v_bfe_u32 v12, v1, 4, 1
    v_lshl_add_u32 v6, v12, 2, v6
    v_mul_u32_u24 v6, 384, v6
    v_and_b32 v12, 3, v1
    v_lshl_add_u32 v6, v12, 3, v6
    s_lshl_b32 s28, s24, 5
    s_add_u32 s29, s28, 256
    v_add_u32 v9, s29, v6
    s_lshl_b32 s28, s24, 6
    v_add_u32 v6, s28, v6
    s_mul_i32 s30, s24, 6144
    v_and_b32 v8, 16, v1
    v_lshrrev_b32 v12, 5, v1
    v_lshl_add_u32 v8, v12, 2, v8
    v_bfe_u32 v12, v1, 2, 1
    v_add_u32 v8, v8, v12
    v_mul_u32_u24 v8, 1280, v8
    v_bfe_u32 v12, v1, 3, 1
    v_lshl_add_u32 v8, v12, 5, v8
    v_and_b32 v12, 3, v1
    v_lshl_add_u32 v8, v12, 3, v8
    s_mul_i32 s28, s24, 320
    v_add_u32 v8, s28, v8
    s_mul_i32 s32, s24, 10240
    s_mul_i32 s33, s75, 245760
    s_add_u32 s33, s33, s32
    s_add_u32 m0, s30, 0
    s_mov_b32 s31, 0
    buffer_load_dwordx4 v3, s[12:15], s31 offen lds
    s_add_u32 m0, s30, 1024
    s_mov_b32 s31, 0
    buffer_load_dwordx4 v4, s[12:15], s31 offen lds
    s_add_u32 m0, s30, 2048
    s_mov_b32 s31, 0
    buffer_load_dwordx4 v5, s[12:15], s31 offen lds
    s_add_u32 m0, s30, 3072
    s_mov_b32 s31, 98304
    buffer_load_dwordx4 v3, s[12:15], s31 offen lds
    s_add_u32 m0, s30, 4096
    s_mov_b32 s31, 98304
    buffer_load_dwordx4 v4, s[12:15], s31 offen lds
    s_add_u32 m0, s30, 5120
    s_mov_b32 s31, 98304
    buffer_load_dwordx4 v5, s[12:15], s31 offen lds
    s_add_u32 m0, s30, 40960
    s_mov_b32 s31, 786432
    buffer_load_dwordx4 v3, s[12:15], s31 offen lds
    s_add_u32 m0, s30, 41984
    s_mov_b32 s31, 786432
    buffer_load_dwordx4 v4, s[12:15], s31 offen lds
    s_add_u32 m0, s30, 43008
    s_mov_b32 s31, 786432
    buffer_load_dwordx4 v5, s[12:15], s31 offen lds
    s_add_u32 m0, s30, 44032
    s_mov_b32 s31, 884736
    buffer_load_dwordx4 v3, s[12:15], s31 offen lds
    s_add_u32 m0, s30, 45056
    s_mov_b32 s31, 884736
    buffer_load_dwordx4 v4, s[12:15], s31 offen lds
    s_add_u32 m0, s30, 46080
    s_mov_b32 s31, 884736
    buffer_load_dwordx4 v5, s[12:15], s31 offen lds
    s_add_u32 m0, s30, 81920
    s_mov_b32 s31, 1572864
    buffer_load_dwordx4 v3, s[12:15], s31 offen lds
    s_add_u32 m0, s30, 82944
    s_mov_b32 s31, 1572864
    buffer_load_dwordx4 v4, s[12:15], s31 offen lds
    s_add_u32 m0, s30, 83968
    s_mov_b32 s31, 1572864
    buffer_load_dwordx4 v5, s[12:15], s31 offen lds
    s_add_u32 m0, s30, 84992
    s_mov_b32 s31, 1671168
    buffer_load_dwordx4 v3, s[12:15], s31 offen lds
    s_add_u32 m0, s30, 86016
    s_mov_b32 s31, 1671168
    buffer_load_dwordx4 v4, s[12:15], s31 offen lds
    s_add_u32 m0, s30, 87040
    s_mov_b32 s31, 1671168
    buffer_load_dwordx4 v5, s[12:15], s31 offen lds
    s_waitcnt vmcnt(12)
    s_barrier
    s_add_u32 m0, s30, 122880
    s_mov_b32 s31, 2359296
    buffer_load_dwordx4 v3, s[12:15], s31 offen lds
    s_add_u32 m0, s30, 123904
    s_mov_b32 s31, 2359296
    buffer_load_dwordx4 v4, s[12:15], s31 offen lds
    s_add_u32 m0, s30, 124928
    s_mov_b32 s31, 2359296
    buffer_load_dwordx4 v5, s[12:15], s31 offen lds
    s_add_u32 m0, s30, 125952
    s_mov_b32 s31, 2457600
    buffer_load_dwordx4 v3, s[12:15], s31 offen lds
    s_add_u32 m0, s30, 126976
    s_mov_b32 s31, 2457600
    buffer_load_dwordx4 v4, s[12:15], s31 offen lds
    s_add_u32 m0, s30, 128000
    s_mov_b32 s31, 2457600
    buffer_load_dwordx4 v5, s[12:15], s31 offen lds
    v_add_u32 v7, 0, v6
    v_add_u32 v10, 0, v9
    ds_read_b64_tr_b16 a[0:1], v7 offset:0
    ds_read_b64_tr_b16 a[2:3], v7 offset:768
    ds_read_b64_tr_b16 a[4:5], v7 offset:12288
    ds_read_b64_tr_b16 a[6:7], v7 offset:13056
    ds_read_b64_tr_b16 a[80:81], v7 offset:32
    ds_read_b64_tr_b16 a[82:83], v7 offset:800
    ds_read_b64_tr_b16 a[84:85], v7 offset:12320
    ds_read_b64_tr_b16 a[86:87], v7 offset:13088
    ds_read_b64_tr_b16 a[160:161], v10 offset:0
    ds_read_b64_tr_b16 a[162:163], v10 offset:768
    ds_read_b64_tr_b16 a[164:165], v10 offset:12288
    ds_read_b64_tr_b16 a[166:167], v10 offset:13056
    s_waitcnt lgkmcnt(0)
    s_waitcnt vmcnt(12)
    s_barrier
    s_add_u32 m0, s30, 0
    s_mov_b32 s31, 3145728
    buffer_load_dwordx4 v3, s[12:15], s31 offen lds
    s_add_u32 m0, s30, 1024
    s_mov_b32 s31, 3145728
    buffer_load_dwordx4 v4, s[12:15], s31 offen lds
    s_add_u32 m0, s30, 2048
    s_mov_b32 s31, 3145728
    buffer_load_dwordx4 v5, s[12:15], s31 offen lds
    s_add_u32 m0, s30, 3072
    s_mov_b32 s31, 3244032
    buffer_load_dwordx4 v3, s[12:15], s31 offen lds
    s_add_u32 m0, s30, 4096
    s_mov_b32 s31, 3244032
    buffer_load_dwordx4 v4, s[12:15], s31 offen lds
    s_add_u32 m0, s30, 5120
    s_mov_b32 s31, 3244032
    buffer_load_dwordx4 v5, s[12:15], s31 offen lds
    v_add_u32 v7, 40960, v6
    v_add_u32 v10, 40960, v9
    ds_read_b64_tr_b16 a[8:9], v7 offset:0
    ds_read_b64_tr_b16 a[10:11], v7 offset:768
    ds_read_b64_tr_b16 a[12:13], v7 offset:12288
    ds_read_b64_tr_b16 a[14:15], v7 offset:13056
    ds_read_b64_tr_b16 a[88:89], v7 offset:32
    ds_read_b64_tr_b16 a[90:91], v7 offset:800
    ds_read_b64_tr_b16 a[92:93], v7 offset:12320
    ds_read_b64_tr_b16 a[94:95], v7 offset:13088
    ds_read_b64_tr_b16 a[168:169], v10 offset:0
    ds_read_b64_tr_b16 a[170:171], v10 offset:768
    ds_read_b64_tr_b16 a[172:173], v10 offset:12288
    ds_read_b64_tr_b16 a[174:175], v10 offset:13056
    s_waitcnt lgkmcnt(0)
    s_waitcnt vmcnt(12)
    s_barrier
    s_add_u32 m0, s30, 40960
    s_mov_b32 s31, 3932160
    buffer_load_dwordx4 v3, s[12:15], s31 offen lds
    s_add_u32 m0, s30, 41984
    s_mov_b32 s31, 3932160
    buffer_load_dwordx4 v4, s[12:15], s31 offen lds
    s_add_u32 m0, s30, 43008
    s_mov_b32 s31, 3932160
    buffer_load_dwordx4 v5, s[12:15], s31 offen lds
    s_add_u32 m0, s30, 44032
    s_mov_b32 s31, 4030464
    buffer_load_dwordx4 v3, s[12:15], s31 offen lds
    s_add_u32 m0, s30, 45056
    s_mov_b32 s31, 4030464
    buffer_load_dwordx4 v4, s[12:15], s31 offen lds
    s_add_u32 m0, s30, 46080
    s_mov_b32 s31, 4030464
    buffer_load_dwordx4 v5, s[12:15], s31 offen lds
    v_add_u32 v7, 81920, v6
    v_add_u32 v10, 81920, v9
    ds_read_b64_tr_b16 a[16:17], v7 offset:0
    ds_read_b64_tr_b16 a[18:19], v7 offset:768
    ds_read_b64_tr_b16 a[20:21], v7 offset:12288
    ds_read_b64_tr_b16 a[22:23], v7 offset:13056
    ds_read_b64_tr_b16 a[96:97], v7 offset:32
    ds_read_b64_tr_b16 a[98:99], v7 offset:800
    ds_read_b64_tr_b16 a[100:101], v7 offset:12320
    ds_read_b64_tr_b16 a[102:103], v7 offset:13088
    ds_read_b64_tr_b16 a[176:177], v10 offset:0
    ds_read_b64_tr_b16 a[178:179], v10 offset:768
    ds_read_b64_tr_b16 a[180:181], v10 offset:12288
    ds_read_b64_tr_b16 a[182:183], v10 offset:13056
    s_waitcnt lgkmcnt(0)
    s_waitcnt vmcnt(12)
    s_barrier
    s_add_u32 m0, s30, 81920
    s_mov_b32 s31, 4718592
    buffer_load_dwordx4 v3, s[12:15], s31 offen lds
    s_add_u32 m0, s30, 82944
    s_mov_b32 s31, 4718592
    buffer_load_dwordx4 v4, s[12:15], s31 offen lds
    s_add_u32 m0, s30, 83968
    s_mov_b32 s31, 4718592
    buffer_load_dwordx4 v5, s[12:15], s31 offen lds
    s_add_u32 m0, s30, 84992
    s_mov_b32 s31, 4816896
    buffer_load_dwordx4 v3, s[12:15], s31 offen lds
    s_add_u32 m0, s30, 86016
    s_mov_b32 s31, 4816896
    buffer_load_dwordx4 v4, s[12:15], s31 offen lds
    s_add_u32 m0, s30, 87040
    s_mov_b32 s31, 4816896
    buffer_load_dwordx4 v5, s[12:15], s31 offen lds
    v_add_u32 v7, 122880, v6
    v_add_u32 v10, 122880, v9
    ds_read_b64_tr_b16 a[24:25], v7 offset:0
    ds_read_b64_tr_b16 a[26:27], v7 offset:768
    ds_read_b64_tr_b16 a[28:29], v7 offset:12288
    ds_read_b64_tr_b16 a[30:31], v7 offset:13056
    ds_read_b64_tr_b16 a[104:105], v7 offset:32
    ds_read_b64_tr_b16 a[106:107], v7 offset:800
    ds_read_b64_tr_b16 a[108:109], v7 offset:12320
    ds_read_b64_tr_b16 a[110:111], v7 offset:13088
    ds_read_b64_tr_b16 a[184:185], v10 offset:0
    ds_read_b64_tr_b16 a[186:187], v10 offset:768
    ds_read_b64_tr_b16 a[188:189], v10 offset:12288
    ds_read_b64_tr_b16 a[190:191], v10 offset:13056
    s_waitcnt lgkmcnt(0)
    s_waitcnt vmcnt(12)
    s_barrier
    s_add_u32 m0, s30, 122880
    s_mov_b32 s31, 5505024
    buffer_load_dwordx4 v3, s[12:15], s31 offen lds
    s_add_u32 m0, s30, 123904
    s_mov_b32 s31, 5505024
    buffer_load_dwordx4 v4, s[12:15], s31 offen lds
    s_add_u32 m0, s30, 124928
    s_mov_b32 s31, 5505024
    buffer_load_dwordx4 v5, s[12:15], s31 offen lds
    s_add_u32 m0, s30, 125952
    s_mov_b32 s31, 5603328
    buffer_load_dwordx4 v3, s[12:15], s31 offen lds
    s_add_u32 m0, s30, 126976
    s_mov_b32 s31, 5603328
    buffer_load_dwordx4 v4, s[12:15], s31 offen lds
    s_add_u32 m0, s30, 128000
    s_mov_b32 s31, 5603328
    buffer_load_dwordx4 v5, s[12:15], s31 offen lds
    v_add_u32 v7, 0, v6
    v_add_u32 v10, 0, v9
    ds_read_b64_tr_b16 a[32:33], v7 offset:0
    ds_read_b64_tr_b16 a[34:35], v7 offset:768
    ds_read_b64_tr_b16 a[36:37], v7 offset:12288
    ds_read_b64_tr_b16 a[38:39], v7 offset:13056
    ds_read_b64_tr_b16 a[112:113], v7 offset:32
    ds_read_b64_tr_b16 a[114:115], v7 offset:800
    ds_read_b64_tr_b16 a[116:117], v7 offset:12320
    ds_read_b64_tr_b16 a[118:119], v7 offset:13088
    ds_read_b64_tr_b16 a[192:193], v10 offset:0
    ds_read_b64_tr_b16 a[194:195], v10 offset:768
    ds_read_b64_tr_b16 a[196:197], v10 offset:12288
    ds_read_b64_tr_b16 a[198:199], v10 offset:13056
    s_waitcnt lgkmcnt(0)
    s_waitcnt vmcnt(12)
    s_barrier
    s_add_u32 m0, s30, 0
    s_mov_b32 s31, 6291456
    buffer_load_dwordx4 v3, s[12:15], s31 offen lds
    s_add_u32 m0, s30, 1024
    s_mov_b32 s31, 6291456
    buffer_load_dwordx4 v4, s[12:15], s31 offen lds
    s_add_u32 m0, s30, 2048
    s_mov_b32 s31, 6291456
    buffer_load_dwordx4 v5, s[12:15], s31 offen lds
    s_add_u32 m0, s30, 3072
    s_mov_b32 s31, 6389760
    buffer_load_dwordx4 v3, s[12:15], s31 offen lds
    s_add_u32 m0, s30, 4096
    s_mov_b32 s31, 6389760
    buffer_load_dwordx4 v4, s[12:15], s31 offen lds
    s_add_u32 m0, s30, 5120
    s_mov_b32 s31, 6389760
    buffer_load_dwordx4 v5, s[12:15], s31 offen lds
    v_add_u32 v7, 40960, v6
    v_add_u32 v10, 40960, v9
    ds_read_b64_tr_b16 a[40:41], v7 offset:0
    ds_read_b64_tr_b16 a[42:43], v7 offset:768
    ds_read_b64_tr_b16 a[44:45], v7 offset:12288
    ds_read_b64_tr_b16 a[46:47], v7 offset:13056
    ds_read_b64_tr_b16 a[120:121], v7 offset:32
    ds_read_b64_tr_b16 a[122:123], v7 offset:800
    ds_read_b64_tr_b16 a[124:125], v7 offset:12320
    ds_read_b64_tr_b16 a[126:127], v7 offset:13088
    ds_read_b64_tr_b16 a[200:201], v10 offset:0
    ds_read_b64_tr_b16 a[202:203], v10 offset:768
    ds_read_b64_tr_b16 a[204:205], v10 offset:12288
    ds_read_b64_tr_b16 a[206:207], v10 offset:13056
    s_waitcnt lgkmcnt(0)
    s_waitcnt vmcnt(12)
    s_barrier
    s_add_u32 m0, s30, 40960
    s_mov_b32 s31, 7077888
    buffer_load_dwordx4 v3, s[12:15], s31 offen lds
    s_add_u32 m0, s30, 41984
    s_mov_b32 s31, 7077888
    buffer_load_dwordx4 v4, s[12:15], s31 offen lds
    s_add_u32 m0, s30, 43008
    s_mov_b32 s31, 7077888
    buffer_load_dwordx4 v5, s[12:15], s31 offen lds
    s_add_u32 m0, s30, 44032
    s_mov_b32 s31, 7176192
    buffer_load_dwordx4 v3, s[12:15], s31 offen lds
    s_add_u32 m0, s30, 45056
    s_mov_b32 s31, 7176192
    buffer_load_dwordx4 v4, s[12:15], s31 offen lds
    s_add_u32 m0, s30, 46080
    s_mov_b32 s31, 7176192
    buffer_load_dwordx4 v5, s[12:15], s31 offen lds
    v_add_u32 v7, 81920, v6
    v_add_u32 v10, 81920, v9
    ds_read_b64_tr_b16 a[48:49], v7 offset:0
    ds_read_b64_tr_b16 a[50:51], v7 offset:768
    ds_read_b64_tr_b16 a[52:53], v7 offset:12288
    ds_read_b64_tr_b16 a[54:55], v7 offset:13056
    ds_read_b64_tr_b16 a[128:129], v7 offset:32
    ds_read_b64_tr_b16 a[130:131], v7 offset:800
    ds_read_b64_tr_b16 a[132:133], v7 offset:12320
    ds_read_b64_tr_b16 a[134:135], v7 offset:13088
    ds_read_b64_tr_b16 a[208:209], v10 offset:0
    ds_read_b64_tr_b16 a[210:211], v10 offset:768
    ds_read_b64_tr_b16 a[212:213], v10 offset:12288
    ds_read_b64_tr_b16 a[214:215], v10 offset:13056
    s_waitcnt lgkmcnt(0)
    s_waitcnt vmcnt(12)
    s_barrier
    s_add_u32 m0, s32, 81920
    s_add_u32 s31, s33, 0
    buffer_load_dwordx4 v2, s[16:19], s31 offen offset:0 lds
    buffer_load_dwordx4 v2, s[16:19], s31 offen offset:1024 lds
    buffer_load_dwordx4 v2, s[16:19], s31 offen offset:2048 lds
    buffer_load_dwordx4 v2, s[16:19], s31 offen offset:3072 lds
    s_add_u32 m0, s32, 86016
    s_add_u32 s31, s33, 4096
    buffer_load_dwordx4 v2, s[16:19], s31 offen offset:0 lds
    buffer_load_dwordx4 v2, s[16:19], s31 offen offset:1024 lds
    buffer_load_dwordx4 v2, s[16:19], s31 offen offset:2048 lds
    buffer_load_dwordx4 v2, s[16:19], s31 offen offset:3072 lds
    s_add_u32 m0, s32, 90112
    s_add_u32 s31, s33, 8192
    buffer_load_dwordx4 v2, s[16:19], s31 offen offset:0 lds
    buffer_load_dwordx4 v2, s[16:19], s31 offen offset:1024 lds
    v_add_u32 v7, 122880, v6
    v_add_u32 v10, 122880, v9
    ds_read_b64_tr_b16 a[56:57], v7 offset:0
    ds_read_b64_tr_b16 a[58:59], v7 offset:768
    ds_read_b64_tr_b16 a[60:61], v7 offset:12288
    ds_read_b64_tr_b16 a[62:63], v7 offset:13056
    ds_read_b64_tr_b16 a[136:137], v7 offset:32
    ds_read_b64_tr_b16 a[138:139], v7 offset:800
    ds_read_b64_tr_b16 a[140:141], v7 offset:12320
    ds_read_b64_tr_b16 a[142:143], v7 offset:13088
    ds_read_b64_tr_b16 a[216:217], v10 offset:0
    ds_read_b64_tr_b16 a[218:219], v10 offset:768
    ds_read_b64_tr_b16 a[220:221], v10 offset:12288
    ds_read_b64_tr_b16 a[222:223], v10 offset:13056
    s_waitcnt lgkmcnt(0)
    s_waitcnt vmcnt(16)
    s_barrier
    s_add_u32 m0, s32, 122880
    s_add_u32 s31, s33, 40960
    buffer_load_dwordx4 v2, s[16:19], s31 offen offset:0 lds
    buffer_load_dwordx4 v2, s[16:19], s31 offen offset:1024 lds
    buffer_load_dwordx4 v2, s[16:19], s31 offen offset:2048 lds
    buffer_load_dwordx4 v2, s[16:19], s31 offen offset:3072 lds
    s_add_u32 m0, s32, 126976
    s_add_u32 s31, s33, 45056
    buffer_load_dwordx4 v2, s[16:19], s31 offen offset:0 lds
    buffer_load_dwordx4 v2, s[16:19], s31 offen offset:1024 lds
    buffer_load_dwordx4 v2, s[16:19], s31 offen offset:2048 lds
    buffer_load_dwordx4 v2, s[16:19], s31 offen offset:3072 lds
    s_add_u32 m0, s32, 131072
    s_add_u32 s31, s33, 49152
    buffer_load_dwordx4 v2, s[16:19], s31 offen offset:0 lds
    buffer_load_dwordx4 v2, s[16:19], s31 offen offset:1024 lds
    v_add_u32 v7, 0, v6
    v_add_u32 v10, 0, v9
    ds_read_b64_tr_b16 a[64:65], v7 offset:0
    ds_read_b64_tr_b16 a[66:67], v7 offset:768
    ds_read_b64_tr_b16 a[68:69], v7 offset:12288
    ds_read_b64_tr_b16 a[70:71], v7 offset:13056
    ds_read_b64_tr_b16 a[144:145], v7 offset:32
    ds_read_b64_tr_b16 a[146:147], v7 offset:800
    ds_read_b64_tr_b16 a[148:149], v7 offset:12320
    ds_read_b64_tr_b16 a[150:151], v7 offset:13088
    ds_read_b64_tr_b16 a[224:225], v10 offset:0
    ds_read_b64_tr_b16 a[226:227], v10 offset:768
    ds_read_b64_tr_b16 a[228:229], v10 offset:12288
    ds_read_b64_tr_b16 a[230:231], v10 offset:13056
    s_waitcnt lgkmcnt(0)
    s_waitcnt vmcnt(20)
    s_barrier
    s_add_u32 m0, s32, 0
    s_add_u32 s31, s33, 81920
    buffer_load_dwordx4 v2, s[16:19], s31 offen offset:0 lds
    buffer_load_dwordx4 v2, s[16:19], s31 offen offset:1024 lds
    buffer_load_dwordx4 v2, s[16:19], s31 offen offset:2048 lds
    buffer_load_dwordx4 v2, s[16:19], s31 offen offset:3072 lds
    s_add_u32 m0, s32, 4096
    s_add_u32 s31, s33, 86016
    buffer_load_dwordx4 v2, s[16:19], s31 offen offset:0 lds
    buffer_load_dwordx4 v2, s[16:19], s31 offen offset:1024 lds
    buffer_load_dwordx4 v2, s[16:19], s31 offen offset:2048 lds
    buffer_load_dwordx4 v2, s[16:19], s31 offen offset:3072 lds
    s_add_u32 m0, s32, 8192
    s_add_u32 s31, s33, 90112
    buffer_load_dwordx4 v2, s[16:19], s31 offen offset:0 lds
    buffer_load_dwordx4 v2, s[16:19], s31 offen offset:1024 lds
    v_add_u32 v7, 40960, v6
    v_add_u32 v10, 40960, v9
    ds_read_b64_tr_b16 a[72:73], v7 offset:0
    ds_read_b64_tr_b16 a[74:75], v7 offset:768
    ds_read_b64_tr_b16 a[76:77], v7 offset:12288
    ds_read_b64_tr_b16 a[78:79], v7 offset:13056
    ds_read_b64_tr_b16 a[152:153], v7 offset:32
    ds_read_b64_tr_b16 a[154:155], v7 offset:800
    ds_read_b64_tr_b16 a[156:157], v7 offset:12320
    ds_read_b64_tr_b16 a[158:159], v7 offset:13088
    ds_read_b64_tr_b16 a[232:233], v10 offset:0
    ds_read_b64_tr_b16 a[234:235], v10 offset:768
    ds_read_b64_tr_b16 a[236:237], v10 offset:12288
    ds_read_b64_tr_b16 a[238:239], v10 offset:13056
    s_waitcnt lgkmcnt(0)
    s_waitcnt vmcnt(20)
    s_barrier
    s_add_u32 m0, s32, 40960
    s_add_u32 s31, s33, 122880
    buffer_load_dwordx4 v2, s[16:19], s31 offen offset:0 lds
    buffer_load_dwordx4 v2, s[16:19], s31 offen offset:1024 lds
    buffer_load_dwordx4 v2, s[16:19], s31 offen offset:2048 lds
    buffer_load_dwordx4 v2, s[16:19], s31 offen offset:3072 lds
    s_add_u32 m0, s32, 45056
    s_add_u32 s31, s33, 126976
    buffer_load_dwordx4 v2, s[16:19], s31 offen offset:0 lds
    buffer_load_dwordx4 v2, s[16:19], s31 offen offset:1024 lds
    buffer_load_dwordx4 v2, s[16:19], s31 offen offset:2048 lds
    buffer_load_dwordx4 v2, s[16:19], s31 offen offset:3072 lds
    s_add_u32 m0, s32, 49152
    s_add_u32 s31, s33, 131072
    buffer_load_dwordx4 v2, s[16:19], s31 offen offset:0 lds
    buffer_load_dwordx4 v2, s[16:19], s31 offen offset:1024 lds
    v_add_u32 v7, 81920, v8
    ds_read_b64_tr_b16 a[240:241], v7 offset:0
    ds_read_b64_tr_b16 a[242:243], v7 offset:2560
    ds_read_b64_tr_b16 a[244:245], v7 offset:10240
    ds_read_b64_tr_b16 a[246:247], v7 offset:12800
    ds_read_b64_tr_b16 v[128:129], v7 offset:64
    ds_read_b64_tr_b16 v[130:131], v7 offset:2624
    ds_read_b64_tr_b16 v[132:133], v7 offset:10304
    ds_read_b64_tr_b16 v[134:135], v7 offset:12864
    ds_read_b64_tr_b16 v[160:161], v7 offset:128
    ds_read_b64_tr_b16 v[162:163], v7 offset:2688
    ds_read_b64_tr_b16 v[164:165], v7 offset:10368
    ds_read_b64_tr_b16 v[166:167], v7 offset:12928
    s_waitcnt lgkmcnt(0)
    ds_read_b64_tr_b16 v[192:193], v7 offset:192
    ds_read_b64_tr_b16 v[194:195], v7 offset:2752
    ds_read_b64_tr_b16 v[196:197], v7 offset:10432
    ds_read_b64_tr_b16 v[198:199], v7 offset:12992
    ds_read_b64_tr_b16 v[224:225], v7 offset:256
    ds_read_b64_tr_b16 v[226:227], v7 offset:2816
    ds_read_b64_tr_b16 v[228:229], v7 offset:10496
    ds_read_b64_tr_b16 v[230:231], v7 offset:13056
    s_waitcnt lgkmcnt(0)
    s_waitcnt vmcnt(20)
    s_barrier
    s_add_u32 m0, s32, 81920
    s_add_u32 s31, s33, 163840
    buffer_load_dwordx4 v2, s[16:19], s31 offen offset:0 lds
    buffer_load_dwordx4 v2, s[16:19], s31 offen offset:1024 lds
    buffer_load_dwordx4 v2, s[16:19], s31 offen offset:2048 lds
    buffer_load_dwordx4 v2, s[16:19], s31 offen offset:3072 lds
    s_add_u32 m0, s32, 86016
    s_add_u32 s31, s33, 167936
    buffer_load_dwordx4 v2, s[16:19], s31 offen offset:0 lds
    buffer_load_dwordx4 v2, s[16:19], s31 offen offset:1024 lds
    buffer_load_dwordx4 v2, s[16:19], s31 offen offset:2048 lds
    buffer_load_dwordx4 v2, s[16:19], s31 offen offset:3072 lds
    s_add_u32 m0, s32, 90112
    s_add_u32 s31, s33, 172032
    buffer_load_dwordx4 v2, s[16:19], s31 offen offset:0 lds
    buffer_load_dwordx4 v2, s[16:19], s31 offen offset:1024 lds
    v_add_u32 v7, 122880, v8
    ds_read_b64_tr_b16 a[248:249], v7 offset:0
    ds_read_b64_tr_b16 a[250:251], v7 offset:2560
    ds_read_b64_tr_b16 a[252:253], v7 offset:10240
    ds_read_b64_tr_b16 a[254:255], v7 offset:12800
    ds_read_b64_tr_b16 v[136:137], v7 offset:64
    ds_read_b64_tr_b16 v[138:139], v7 offset:2624
    ds_read_b64_tr_b16 v[140:141], v7 offset:10304
    ds_read_b64_tr_b16 v[142:143], v7 offset:12864
    ds_read_b64_tr_b16 v[168:169], v7 offset:128
    ds_read_b64_tr_b16 v[170:171], v7 offset:2688
    ds_read_b64_tr_b16 v[172:173], v7 offset:10368
    ds_read_b64_tr_b16 v[174:175], v7 offset:12928
    s_waitcnt lgkmcnt(0)
    ds_read_b64_tr_b16 v[200:201], v7 offset:192
    ds_read_b64_tr_b16 v[202:203], v7 offset:2752
    ds_read_b64_tr_b16 v[204:205], v7 offset:10432
    ds_read_b64_tr_b16 v[206:207], v7 offset:12992
    ds_read_b64_tr_b16 v[232:233], v7 offset:256
    ds_read_b64_tr_b16 v[234:235], v7 offset:2816
    ds_read_b64_tr_b16 v[236:237], v7 offset:10496
    ds_read_b64_tr_b16 v[238:239], v7 offset:13056
    s_waitcnt lgkmcnt(0)
    s_waitcnt vmcnt(20)
    s_barrier
    s_add_u32 m0, s32, 122880
    s_add_u32 s31, s33, 204800
    buffer_load_dwordx4 v2, s[16:19], s31 offen offset:0 lds
    buffer_load_dwordx4 v2, s[16:19], s31 offen offset:1024 lds
    buffer_load_dwordx4 v2, s[16:19], s31 offen offset:2048 lds
    buffer_load_dwordx4 v2, s[16:19], s31 offen offset:3072 lds
    s_add_u32 m0, s32, 126976
    s_add_u32 s31, s33, 208896
    buffer_load_dwordx4 v2, s[16:19], s31 offen offset:0 lds
    buffer_load_dwordx4 v2, s[16:19], s31 offen offset:1024 lds
    buffer_load_dwordx4 v2, s[16:19], s31 offen offset:2048 lds
    buffer_load_dwordx4 v2, s[16:19], s31 offen offset:3072 lds
    s_add_u32 m0, s32, 131072
    s_add_u32 s31, s33, 212992
    buffer_load_dwordx4 v2, s[16:19], s31 offen offset:0 lds
    buffer_load_dwordx4 v2, s[16:19], s31 offen offset:1024 lds
    v_add_u32 v7, 0, v8
    ds_read_b64_tr_b16 v[112:113], v7 offset:0
    ds_read_b64_tr_b16 v[114:115], v7 offset:2560
    ds_read_b64_tr_b16 v[116:117], v7 offset:10240
    ds_read_b64_tr_b16 v[118:119], v7 offset:12800
    ds_read_b64_tr_b16 v[144:145], v7 offset:64
    ds_read_b64_tr_b16 v[146:147], v7 offset:2624
    ds_read_b64_tr_b16 v[148:149], v7 offset:10304
    ds_read_b64_tr_b16 v[150:151], v7 offset:12864
    ds_read_b64_tr_b16 v[176:177], v7 offset:128
    ds_read_b64_tr_b16 v[178:179], v7 offset:2688
    ds_read_b64_tr_b16 v[180:181], v7 offset:10368
    ds_read_b64_tr_b16 v[182:183], v7 offset:12928
    s_waitcnt lgkmcnt(0)
    ds_read_b64_tr_b16 v[208:209], v7 offset:192
    ds_read_b64_tr_b16 v[210:211], v7 offset:2752
    ds_read_b64_tr_b16 v[212:213], v7 offset:10432
    ds_read_b64_tr_b16 v[214:215], v7 offset:12992
    ds_read_b64_tr_b16 v[240:241], v7 offset:256
    ds_read_b64_tr_b16 v[242:243], v7 offset:2816
    ds_read_b64_tr_b16 v[244:245], v7 offset:10496
    ds_read_b64_tr_b16 v[246:247], v7 offset:13056
    s_waitcnt lgkmcnt(0)
    s_waitcnt vmcnt(20)
    s_barrier
    v_add_u32 v7, 40960, v8
    ds_read_b64_tr_b16 v[120:121], v7 offset:0
    ds_read_b64_tr_b16 v[122:123], v7 offset:2560
    ds_read_b64_tr_b16 v[124:125], v7 offset:10240
    ds_read_b64_tr_b16 v[126:127], v7 offset:12800
    ds_read_b64_tr_b16 v[152:153], v7 offset:64
    ds_read_b64_tr_b16 v[154:155], v7 offset:2624
    ds_read_b64_tr_b16 v[156:157], v7 offset:10304
    ds_read_b64_tr_b16 v[158:159], v7 offset:12864
    ds_read_b64_tr_b16 v[184:185], v7 offset:128
    ds_read_b64_tr_b16 v[186:187], v7 offset:2688
    ds_read_b64_tr_b16 v[188:189], v7 offset:10368
    ds_read_b64_tr_b16 v[190:191], v7 offset:12928
    s_waitcnt lgkmcnt(0)
    ds_read_b64_tr_b16 v[216:217], v7 offset:192
    ds_read_b64_tr_b16 v[218:219], v7 offset:2752
    ds_read_b64_tr_b16 v[220:221], v7 offset:10432
    ds_read_b64_tr_b16 v[222:223], v7 offset:12992
    ds_read_b64_tr_b16 v[248:249], v7 offset:256
    ds_read_b64_tr_b16 v[250:251], v7 offset:2816
    ds_read_b64_tr_b16 v[252:253], v7 offset:10496
    ds_read_b64_tr_b16 v[254:255], v7 offset:13056
    s_waitcnt lgkmcnt(0)
    s_waitcnt vmcnt(10)
    s_barrier
    v_add_u32 v7, 81920, v8
    ds_read_b64_tr_b16 v[16:17], v7 offset:0
    ds_read_b64_tr_b16 v[18:19], v7 offset:2560
    ds_read_b64_tr_b16 v[20:21], v7 offset:10240
    ds_read_b64_tr_b16 v[22:23], v7 offset:12800
    ds_read_b64_tr_b16 v[32:33], v7 offset:64
    ds_read_b64_tr_b16 v[34:35], v7 offset:2624
    ds_read_b64_tr_b16 v[36:37], v7 offset:10304
    ds_read_b64_tr_b16 v[38:39], v7 offset:12864
    ds_read_b64_tr_b16 v[48:49], v7 offset:128
    ds_read_b64_tr_b16 v[50:51], v7 offset:2688
    ds_read_b64_tr_b16 v[52:53], v7 offset:10368
    ds_read_b64_tr_b16 v[54:55], v7 offset:12928
    s_waitcnt lgkmcnt(0)
    ds_read_b64_tr_b16 v[64:65], v7 offset:192
    ds_read_b64_tr_b16 v[66:67], v7 offset:2752
    ds_read_b64_tr_b16 v[68:69], v7 offset:10432
    ds_read_b64_tr_b16 v[70:71], v7 offset:12992
    ds_read_b64_tr_b16 v[80:81], v7 offset:256
    ds_read_b64_tr_b16 v[82:83], v7 offset:2816
    ds_read_b64_tr_b16 v[84:85], v7 offset:10496
    ds_read_b64_tr_b16 v[86:87], v7 offset:13056
    s_waitcnt lgkmcnt(0)
    s_waitcnt vmcnt(0)
    s_barrier
    v_add_u32 v7, 122880, v8
    ds_read_b64_tr_b16 v[24:25], v7 offset:0
    ds_read_b64_tr_b16 v[26:27], v7 offset:2560
    ds_read_b64_tr_b16 v[28:29], v7 offset:10240
    ds_read_b64_tr_b16 v[30:31], v7 offset:12800
    ds_read_b64_tr_b16 v[40:41], v7 offset:64
    ds_read_b64_tr_b16 v[42:43], v7 offset:2624
    ds_read_b64_tr_b16 v[44:45], v7 offset:10304
    ds_read_b64_tr_b16 v[46:47], v7 offset:12864
    ds_read_b64_tr_b16 v[56:57], v7 offset:128
    ds_read_b64_tr_b16 v[58:59], v7 offset:2688
    ds_read_b64_tr_b16 v[60:61], v7 offset:10368
    ds_read_b64_tr_b16 v[62:63], v7 offset:12928
    s_waitcnt lgkmcnt(0)
    ds_read_b64_tr_b16 v[72:73], v7 offset:192
    ds_read_b64_tr_b16 v[74:75], v7 offset:2752
    ds_read_b64_tr_b16 v[76:77], v7 offset:10432
    ds_read_b64_tr_b16 v[78:79], v7 offset:12992
    ds_read_b64_tr_b16 v[88:89], v7 offset:256
    ds_read_b64_tr_b16 v[90:91], v7 offset:2816
    ds_read_b64_tr_b16 v[92:93], v7 offset:10496
    ds_read_b64_tr_b16 v[94:95], v7 offset:13056
    s_waitcnt lgkmcnt(0)
    s_barrier
    s_mul_i32 s28, s24, 20480
    v_add_u32 v11, s28, v2
    ds_write_b128 v11, v[16:19] offset:0
    ds_write_b128 v11, v[20:23] offset:1024
    ds_write_b128 v11, v[24:27] offset:2048
    ds_write_b128 v11, v[28:31] offset:3072
    ds_write_b128 v11, v[32:35] offset:4096
    ds_write_b128 v11, v[36:39] offset:5120
    ds_write_b128 v11, v[40:43] offset:6144
    ds_write_b128 v11, v[44:47] offset:7168
    s_waitcnt lgkmcnt(0)
    ds_write_b128 v11, v[48:51] offset:8192
    ds_write_b128 v11, v[52:55] offset:9216
    ds_write_b128 v11, v[56:59] offset:10240
    ds_write_b128 v11, v[60:63] offset:11264
    ds_write_b128 v11, v[64:67] offset:12288
    ds_write_b128 v11, v[68:71] offset:13312
    ds_write_b128 v11, v[72:75] offset:14336
    ds_write_b128 v11, v[76:79] offset:15360
    s_waitcnt lgkmcnt(0)
    ds_write_b128 v11, v[80:83] offset:16384
    ds_write_b128 v11, v[84:87] offset:17408
    ds_write_b128 v11, v[88:91] offset:18432
    ds_write_b128 v11, v[92:95] offset:19456
    s_waitcnt lgkmcnt(0)
    v_add_u32 v3, 4096, v2
    v_add_u32 v4, 8192, v2
    v_and_b32 v8, 15, v1
    v_lshlrev_b32 v8, 3, v8
    v_lshrrev_b32 v12, 5, v1
    v_lshlrev_b32 v12, 6, v12
    v_xor_b32 v8, v8, v12
    v_lshrrev_b32 v12, 4, v1
    v_lshl_add_u32 v8, v12, 7, v8
    v_add_u32 v8, 92160, v8
    v_lshrrev_b32 v9, 2, v1
    v_lshlrev_b32 v9, 3, v9
    v_bfe_u32 v12, v1, 1, 1
    v_lshlrev_b32 v12, 6, v12
    v_xor_b32 v9, v9, v12
    v_and_b32 v12, 3, v1
    v_lshl_add_u32 v9, v12, 7, v9
    v_add_u32 v9, 92160, v9
    v_mov_b32 v10, 0x4444
    v_mov_b32 v12, 0xeeee
    v_and_b32 v13, 8, v1
    v_cmp_ne_u32 vcc, 0, v13
    s_nop 1
    v_cndmask_b32 v10, v10, v12, vcc
    s_lshr_b32 s28, s24, 1
    s_add_u32 s28, s28, 4
    s_lshl_b32 s28, s28, 9
    v_add_u32 v15, s28, v8
    s_lshl_b32 s28, s24, 9
    v_add_u32 v8, s28, v8
    s_and_b32 s28, s24, 1
    s_sub_u32 s82, s28, 1
    s_not_b32 s83, s82
    v_lshrrev_b32 v9, 2, v1
    v_lshlrev_b32 v9, 3, v9
    v_and_b32 v12, 1, v1
    v_lshl_add_u32 v9, v12, 7, v9
    v_xor_b32 v0, 64, v9
    v_add_u32 v9, 92160, v9
    v_add_u32 v0, 92416, v0
    v_lshrrev_b32 v14, 5, v1
    v_lshlrev_b32 v14, 11, v14
    v_and_b32 v12, 15, v1
    v_lshl_add_u32 v14, v12, 4, v14
    v_bfe_u32 v12, v1, 4, 1
    v_lshl_add_u32 v14, v12, 3, v14
    s_mul_i32 s28, s24, 20480
    s_lshl_b32 s29, s25, 8
    s_add_u32 s28, s28, s29
    s_add_u32 s28, s28, 45056
    v_add_u32 v14, s28, v14
    v_and_b32 v12, 3, v1
    v_lshlrev_b32 v12, 2, v12
    v_bfe_u32 v13, v1, 2, 1
    v_lshl_add_u32 v12, v13, 7, v12
    v_cmp_lt_u32 vcc, 7, v1
    v_mov_b32 v13, 16
    s_nop 0
    v_cndmask_b32 v12, v12, v13, vcc
L_vo_st:
    buffer_load_dword v13, v12, s[8:11], 0 offen sc1
    s_waitcnt vmcnt(0)
    v_cmp_gt_u32 vcc, 32, v13
    v_readlane_b32 s28, v13, 8
    s_cbranch_vccnz L_vo_st_no
    s_cmp_ge_u32 s28, 64
    s_cbranch_scc1 L_vo_st_ok
L_vo_st_no:
    s_sleep 4
    s_sub_u32 s27, s27, 1
    s_cbranch_scc1 L_fail
    s_branch L_vo_st
L_vo_st_ok:
    s_lshl_b32 s74, s26, 19
    s_add_u32 s74, s74, 192937984
    s_mov_b32 s77, 0
    s_and_b32 s28, s77, 3
    s_lshl_b32 s28, s28, 17
    s_add_u32 s76, s74, s28
    s_mov_b32 s95, 0
L_vo_loop:
    v_mov_b32 v56, 0
    v_mov_b32 v57, 0
    v_mov_b32 v58, 0
    v_mov_b32 v59, 0
    v_mov_b32 v60, 0
    v_mov_b32 v61, 0
    v_mov_b32 v62, 0
    v_mov_b32 v63, 0
    v_mov_b32 v64, 0
    v_mov_b32 v65, 0
    v_mov_b32 v66, 0
    v_mov_b32 v67, 0
    v_mov_b32 v68, 0
    v_mov_b32 v69, 0
    v_mov_b32 v70, 0
    v_mov_b32 v71, 0
    v_mov_b32 v72, 0
    v_mov_b32 v73, 0
    v_mov_b32 v74, 0
    v_mov_b32 v75, 0
    v_mov_b32 v100, 0
    v_mov_b32 v101, 0
    v_mov_b32 v102, 0
    v_mov_b32 v103, 0
    v_mov_b32 v104, 0
    v_mov_b32 v105, 0
    v_mov_b32 v106, 0
    v_mov_b32 v107, 0
    v_mov_b32 v108, 0
    v_mov_b32 v109, 0
    v_mov_b32 v110, 0
    v_mov_b32 v111, 0
    s_branch L_vo_poll
L_vo_poll_r:
    s_sub_u32 s27, s27, 1
    s_cbranch_scc1 L_fail
L_vo_poll:
    buffer_load_dwordx4 v[16:19], v2, s[4:7], s76 offen offset:0 sc1
    buffer_load_dwordx4 v[20:23], v2, s[4:7], s76 offen offset:1024 sc1
    buffer_load_dwordx4 v[24:27], v2, s[4:7], s76 offen offset:2048 sc1
    s_waitcnt vmcnt(0)
    v_max3_u32 v80, v16, v17, v18
    v_max3_u32 v81, v19, v20, v21
    v_max3_u32 v82, v22, v23, v24
    v_max3_u32 v83, v25, v26, v27
    v_max3_u32 v84, v80, v81, v82
    v_max_u32 v85, v84, v83
    v_cmp_eq_u32 vcc, -1, v85
    s_cbranch_vccnz L_vo_poll_r
L_vo_e0:
    buffer_load_dwordx4 v[28:31], v2, s[4:7], s76 offen offset:3072 sc1
    buffer_load_dwordx4 v[32:35], v3, s[4:7], s76 offen offset:0 sc1
    v_smfmac_f32_16x16x64_bf16 v[100:103], v[16:19], a[0:7], v10
    v_smfmac_f32_16x16x64_bf16 v[104:107], v[16:19], a[80:87], v10
    v_smfmac_f32_16x16x64_bf16 v[108:111], v[16:19], a[160:167], v10
    buffer_load_dwordx4 v[36:39], v3, s[4:7], s76 offen offset:1024 sc1
    v_smfmac_f32_16x16x64_bf16 v[100:103], v[20:23], a[8:15], v10
    v_smfmac_f32_16x16x64_bf16 v[104:107], v[20:23], a[88:95], v10
    v_smfmac_f32_16x16x64_bf16 v[108:111], v[20:23], a[168:175], v10
    buffer_load_dwordx4 v[40:43], v3, s[4:7], s76 offen offset:2048 sc1
    v_smfmac_f32_16x16x64_bf16 v[100:103], v[24:27], a[16:23], v10
    s_waitcnt vmcnt(3)
    v_max3_u32 v5, v28, v29, v30
    v_max_u32 v5, v5, v31
    v_smfmac_f32_16x16x64_bf16 v[104:107], v[24:27], a[96:103], v10
    v_cmp_eq_u32 vcc, -1, v5
    v_smfmac_f32_16x16x64_bf16 v[108:111], v[24:27], a[176:183], v10
    buffer_load_dwordx4 v[44:47], v3, s[4:7], s76 offen offset:3072 sc1
    s_cbranch_vccnz L_vo_rtv0_3
L_vo_bkv0_3:
L_vo_g3:
    v_smfmac_f32_16x16x64_bf16 v[100:103], v[28:31], a[24:31], v10
    s_waitcnt vmcnt(3)
    v_max3_u32 v5, v32, v33, v34
    v_max_u32 v5, v5, v35
    v_smfmac_f32_16x16x64_bf16 v[104:107], v[28:31], a[104:111], v10
    v_cmp_eq_u32 vcc, -1, v5
    v_smfmac_f32_16x16x64_bf16 v[108:111], v[28:31], a[184:191], v10
    buffer_load_dwordx4 v[48:51], v4, s[4:7], s76 offen offset:0 sc1
    s_cbranch_vccnz L_vo_rt4
L_vo_bk4:
    v_smfmac_f32_16x16x64_bf16 v[100:103], v[32:35], a[32:39], v10
    s_waitcnt vmcnt(3)
    v_max3_u32 v5, v36, v37, v38
    v_max_u32 v5, v5, v39
    v_smfmac_f32_16x16x64_bf16 v[104:107], v[32:35], a[112:119], v10
    v_cmp_eq_u32 vcc, -1, v5
    v_smfmac_f32_16x16x64_bf16 v[108:111], v[32:35], a[192:199], v10
    buffer_load_dwordx4 v[52:55], v4, s[4:7], s76 offen offset:1024 sc1
    s_cbranch_vccnz L_vo_rt5
L_vo_bk5:
    v_smfmac_f32_16x16x64_bf16 v[100:103], v[36:39], a[40:47], v10
    s_waitcnt vmcnt(3)
    v_max3_u32 v5, v40, v41, v42
    v_max_u32 v5, v5, v43
    v_smfmac_f32_16x16x64_bf16 v[104:107], v[36:39], a[120:127], v10
    v_cmp_eq_u32 vcc, -1, v5
    v_smfmac_f32_16x16x64_bf16 v[108:111], v[36:39], a[200:207], v10
    s_cbranch_vccnz L_vo_rt6
L_vo_bk6:
    v_smfmac_f32_16x16x64_bf16 v[100:103], v[40:43], a[48:55], v10
    s_waitcnt vmcnt(2)
    ds_read_b128 v[16:19], v11 offset:0
    v_max3_u32 v5, v44, v45, v46
    v_max_u32 v5, v5, v47
    v_smfmac_f32_16x16x64_bf16 v[104:107], v[40:43], a[128:135], v10
    ds_read_b128 v[20:23], v11 offset:1024
    v_cmp_eq_u32 vcc, -1, v5
    v_smfmac_f32_16x16x64_bf16 v[108:111], v[40:43], a[208:215], v10
    s_cbranch_vccnz L_vo_rt7
L_vo_bk7:
    v_smfmac_f32_16x16x64_bf16 v[100:103], v[44:47], a[56:63], v10
    s_waitcnt vmcnt(1)
    ds_read_b128 v[24:27], v11 offset:2048
    v_max3_u32 v5, v48, v49, v50
    v_max_u32 v5, v5, v51
    v_smfmac_f32_16x16x64_bf16 v[104:107], v[44:47], a[136:143], v10
    ds_read_b128 v[28:31], v11 offset:3072
    v_cmp_eq_u32 vcc, -1, v5
    v_smfmac_f32_16x16x64_bf16 v[108:111], v[44:47], a[216:223], v10
    s_cbranch_vccnz L_vo_rt8
L_vo_bk8:
    v_smfmac_f32_16x16x64_bf16 v[100:103], v[48:51], a[64:71], v10
    s_waitcnt vmcnt(0)
    ds_read_b128 v[32:35], v11 offset:4096
    v_max3_u32 v5, v52, v53, v54
    v_max_u32 v5, v5, v55
    v_smfmac_f32_16x16x64_bf16 v[104:107], v[48:51], a[144:151], v10
    ds_read_b128 v[36:39], v11 offset:5120
    v_cmp_eq_u32 vcc, -1, v5
    v_smfmac_f32_16x16x64_bf16 v[108:111], v[48:51], a[224:231], v10
    s_cbranch_vccnz L_vo_rt9
L_vo_bk9:
    v_smfmac_f32_16x16x64_bf16 v[100:103], v[52:55], a[72:79], v10
    ds_read_b128 v[40:43], v11 offset:6144
    ds_read_b128 v[44:47], v11 offset:7168
    v_smfmac_f32_16x16x64_bf16 v[104:107], v[52:55], a[152:159], v10
    v_smfmac_f32_16x16x64_bf16 v[108:111], v[52:55], a[232:239], v10
    s_nop 7
    v_mov_b32 v84, v108
    v_mov_b32 v85, v109
    v_mov_b32 v86, v110
    v_mov_b32 v87, v111
    v_permlane32_swap_b32 v100, v104
    v_permlane32_swap_b32 v101, v105
    v_permlane32_swap_b32 v102, v106
    v_permlane32_swap_b32 v103, v107
    v_permlane32_swap_b32 v108, v84
    v_permlane32_swap_b32 v109, v85
    v_permlane32_swap_b32 v110, v86
    v_permlane32_swap_b32 v111, v87
    v_pk_add_f32 v[100:101], v[100:101], v[104:105]
    v_pk_add_f32 v[102:103], v[102:103], v[106:107]
    v_cvt_pk_bf16_f32 v88, v100, v101
    v_cvt_pk_bf16_f32 v89, v102, v103
    ds_write_b64 v8, v[88:89]
    v_pk_add_f32 v[108:109], v[108:109], v[84:85]
    v_pk_add_f32 v[110:111], v[110:111], v[86:87]
    v_cvt_pk_bf16_f32 v90, v108, v109
    v_cvt_pk_bf16_f32 v91, v110, v111
    s_mov_b64 exec, s[82:83]
    ds_write_b64 v15, v[90:91]
    s_mov_b64 exec, -1
    s_waitcnt lgkmcnt(0)
    s_barrier
    ds_read_b64_tr_b16 v[76:77], v9 offset:0
    ds_read_b64_tr_b16 v[78:79], v0 offset:0
    ds_read_b64_tr_b16 v[80:81], v9 offset:512
    ds_read_b64_tr_b16 v[82:83], v0 offset:512
    ds_read_b64_tr_b16 v[84:85], v9 offset:1024
    ds_read_b64_tr_b16 v[86:87], v0 offset:1024
    ds_read_b64_tr_b16 v[88:89], v9 offset:1536
    ds_read_b64_tr_b16 v[90:91], v0 offset:1536
    ds_read_b64_tr_b16 v[92:93], v9 offset:2048
    ds_read_b64_tr_b16 v[94:95], v0 offset:2048
    ds_read_b64_tr_b16 v[96:97], v9 offset:2560
    ds_read_b64_tr_b16 v[98:99], v0 offset:2560
    s_waitcnt lgkmcnt(10)
    v_smfmac_f32_16x16x64_bf16 v[56:59], v[76:79], a[240:247], v10
    s_waitcnt lgkmcnt(8)
    v_smfmac_f32_16x16x64_bf16 v[56:59], v[80:83], a[248:255], v10
    s_waitcnt lgkmcnt(6)
    v_smfmac_f32_16x16x64_bf16 v[56:59], v[84:87], v[112:119], v10
    s_waitcnt lgkmcnt(4)
    v_smfmac_f32_16x16x64_bf16 v[56:59], v[88:91], v[120:127], v10
    s_waitcnt lgkmcnt(2)
    v_smfmac_f32_16x16x64_bf16 v[56:59], v[92:95], v[16:23], v10
    s_waitcnt lgkmcnt(0)
    v_smfmac_f32_16x16x64_bf16 v[56:59], v[96:99], v[24:31], v10
    v_smfmac_f32_16x16x64_bf16 v[60:63], v[76:79], v[128:135], v10
    ds_read_b128 v[16:19], v11 offset:8192
    ds_read_b128 v[20:23], v11 offset:9216
    v_smfmac_f32_16x16x64_bf16 v[60:63], v[80:83], v[136:143], v10
    ds_read_b128 v[24:27], v11 offset:10240
    ds_read_b128 v[28:31], v11 offset:11264
    v_smfmac_f32_16x16x64_bf16 v[60:63], v[84:87], v[144:151], v10
    v_smfmac_f32_16x16x64_bf16 v[60:63], v[88:91], v[152:159], v10
    v_smfmac_f32_16x16x64_bf16 v[60:63], v[92:95], v[32:39], v10
    v_cvt_pk_bf16_f32 v100, v56, v58
    v_smfmac_f32_16x16x64_bf16 v[60:63], v[96:99], v[40:47], v10
    v_cvt_pk_bf16_f32 v101, v57, v59
    v_smfmac_f32_16x16x64_bf16 v[64:67], v[76:79], v[160:167], v10
    ds_read_b128 v[32:35], v11 offset:12288
    ds_read_b128 v[36:39], v11 offset:13312
    v_min_u32 v100, -2, v100
    v_smfmac_f32_16x16x64_bf16 v[64:67], v[80:83], v[168:175], v10
    ds_read_b128 v[40:43], v11 offset:14336
    ds_read_b128 v[44:47], v11 offset:15360
    s_add_u32 s28, s76, 0
    v_min_u32 v101, -2, v101
    v_smfmac_f32_16x16x64_bf16 v[64:67], v[84:87], v[176:183], v10
    buffer_store_dwordx2 v[100:101], v14, s[4:7], s28 offen
    v_smfmac_f32_16x16x64_bf16 v[64:67], v[88:91], v[184:191], v10
    s_waitcnt lgkmcnt(4)
    v_smfmac_f32_16x16x64_bf16 v[64:67], v[92:95], v[16:23], v10
    v_cvt_pk_bf16_f32 v102, v60, v62
    v_smfmac_f32_16x16x64_bf16 v[64:67], v[96:99], v[24:31], v10
    v_cvt_pk_bf16_f32 v103, v61, v63
    v_smfmac_f32_16x16x64_bf16 v[68:71], v[76:79], v[192:199], v10
    ds_read_b128 v[16:19], v11 offset:16384
    ds_read_b128 v[20:23], v11 offset:17408
    v_min_u32 v102, -2, v102
    v_smfmac_f32_16x16x64_bf16 v[68:71], v[80:83], v[200:207], v10
    ds_read_b128 v[24:27], v11 offset:18432
    ds_read_b128 v[28:31], v11 offset:19456
    s_add_u32 s28, s76, 4096
    v_min_u32 v103, -2, v103
    v_smfmac_f32_16x16x64_bf16 v[68:71], v[84:87], v[208:215], v10
    buffer_store_dwordx2 v[102:103], v14, s[4:7], s28 offen
    v_smfmac_f32_16x16x64_bf16 v[68:71], v[88:91], v[216:223], v10
    s_waitcnt lgkmcnt(4)
    v_smfmac_f32_16x16x64_bf16 v[68:71], v[92:95], v[32:39], v10
    v_cvt_pk_bf16_f32 v104, v64, v66
    v_smfmac_f32_16x16x64_bf16 v[68:71], v[96:99], v[40:47], v10
    v_cvt_pk_bf16_f32 v105, v65, v67
    v_smfmac_f32_16x16x64_bf16 v[72:75], v[76:79], v[224:231], v10
    v_min_u32 v104, -2, v104
    v_smfmac_f32_16x16x64_bf16 v[72:75], v[80:83], v[232:239], v10
    s_add_u32 s28, s76, 8192
    v_min_u32 v105, -2, v105
    v_smfmac_f32_16x16x64_bf16 v[72:75], v[84:87], v[240:247], v10
    buffer_store_dwordx2 v[104:105], v14, s[4:7], s28 offen
    v_smfmac_f32_16x16x64_bf16 v[72:75], v[88:91], v[248:255], v10
    s_waitcnt lgkmcnt(0)
    v_smfmac_f32_16x16x64_bf16 v[72:75], v[92:95], v[16:23], v10
    v_cvt_pk_bf16_f32 v106, v68, v70
    v_smfmac_f32_16x16x64_bf16 v[72:75], v[96:99], v[24:31], v10
    v_cvt_pk_bf16_f32 v107, v69, v71
    v_min_u32 v106, -2, v106
    s_add_u32 s28, s76, 12288
    v_min_u32 v107, -2, v107
    buffer_store_dwordx2 v[106:107], v14, s[4:7], s28 offen
    s_nop 3
    v_cvt_pk_bf16_f32 v108, v72, v74
    v_cvt_pk_bf16_f32 v109, v73, v75
    v_min_u32 v108, -2, v108
    s_add_u32 s28, s76, 16384
    v_min_u32 v109, -2, v109
    buffer_store_dwordx2 v[108:109], v14, s[4:7], s28 offen
    s_barrier
    s_add_u32 s28, s77, 3
    s_and_b32 s28, s28, 3
    s_lshl_b32 s28, s28, 17
    s_add_u32 s28, s28, s74
    v_mov_b32 v6, -1
    v_mov_b32 v7, -1
    buffer_store_dwordx2 v[6:7], v14, s[4:7], s28 offen
    s_add_u32 s28, s28, 4096
    buffer_store_dwordx2 v[6:7], v14, s[4:7], s28 offen
    s_add_u32 s28, s28, 4096
    buffer_store_dwordx2 v[6:7], v14, s[4:7], s28 offen
    s_add_u32 s28, s28, 4096
    buffer_store_dwordx2 v[6:7], v14, s[4:7], s28 offen
    s_add_u32 s28, s28, 4096
    buffer_store_dwordx2 v[6:7], v14, s[4:7], s28 offen
    s_add_u32 s28, s28, 4096
    s_add_u32 s77, s77, 1
    s_and_b32 s28, s77, 3
    s_lshl_b32 s28, s28, 17
    s_add_u32 s76, s74, s28
    s_cmp_lt_u32 s77, 64
    s_cbranch_scc1 L_vo_loop
    s_waitcnt vmcnt(0)
    s_endpgm
L_vo_rtv0_3:
    s_add_u32 s95, s95, 1
    s_sub_u32 s27, s27, 1
    s_cbranch_scc1 L_fail
    buffer_load_dwordx4 v[28:31], v2, s[4:7], s76 offen offset:3072 sc1
    s_waitcnt vmcnt(0)
    v_max3_u32 v5, v28, v29, v30
    v_max_u32 v5, v5, v31
    v_cmp_eq_u32 vcc, -1, v5
    s_cbranch_vccnz L_vo_rtv0_3
    s_branch L_vo_bkv0_3
L_vo_rt4:
    s_add_u32 s95, s95, 1
    s_sub_u32 s27, s27, 1
    s_cbranch_scc1 L_fail
    buffer_load_dwordx4 v[32:35], v3, s[4:7], s76 offen offset:0 sc1
    s_waitcnt vmcnt(0)
    v_max3_u32 v5, v32, v33, v34
    v_max_u32 v5, v5, v35
    v_cmp_eq_u32 vcc, -1, v5
    s_cbranch_vccnz L_vo_rt4
    s_branch L_vo_bk4
L_vo_rt5:
    s_add_u32 s95, s95, 1
    s_sub_u32 s27, s27, 1
    s_cbranch_scc1 L_fail
    buffer_load_dwordx4 v[36:39], v3, s[4:7], s76 offen offset:1024 sc1
    s_waitcnt vmcnt(0)
    v_max3_u32 v5, v36, v37, v38
    v_max_u32 v5, v5, v39
    v_cmp_eq_u32 vcc, -1, v5
    s_cbranch_vccnz L_vo_rt5
    s_branch L_vo_bk5
L_vo_rt6:
    s_add_u32 s95, s95, 1
    s_sub_u32 s27, s27, 1
    s_cbranch_scc1 L_fail
    buffer_load_dwordx4 v[40:43], v3, s[4:7], s76 offen offset:2048 sc1
    s_waitcnt vmcnt(0)
    v_max3_u32 v5, v40, v41, v42
    v_max_u32 v5, v5, v43
    v_cmp_eq_u32 vcc, -1, v5
    s_cbranch_vccnz L_vo_rt6
    s_branch L_vo_bk6
L_vo_rt7:
    s_add_u32 s95, s95, 1
    s_sub_u32 s27, s27, 1
    s_cbranch_scc1 L_fail
    buffer_load_dwordx4 v[44:47], v3, s[4:7], s76 offen offset:3072 sc1
    s_waitcnt vmcnt(0)
    v_max3_u32 v5, v44, v45, v46
    v_max_u32 v5, v5, v47
    v_cmp_eq_u32 vcc, -1, v5
    s_cbranch_vccnz L_vo_rt7
    s_branch L_vo_bk7
L_vo_rt8:
    s_add_u32 s95, s95, 1
    s_sub_u32 s27, s27, 1
    s_cbranch_scc1 L_fail
    buffer_load_dwordx4 v[48:51], v4, s[4:7], s76 offen offset:0 sc1
    s_waitcnt vmcnt(0)
    v_max3_u32 v5, v48, v49, v50
    v_max_u32 v5, v5, v51
    v_cmp_eq_u32 vcc, -1, v5
    s_cbranch_vccnz L_vo_rt8
    s_branch L_vo_bk8
L_vo_rt9:
    s_add_u32 s95, s95, 1
    s_sub_u32 s27, s27, 1
    s_cbranch_scc1 L_fail
    buffer_load_dwordx4 v[52:55], v4, s[4:7], s76 offen offset:1024 sc1
    s_waitcnt vmcnt(0)
    v_max3_u32 v5, v52, v53, v54
    v_max_u32 v5, v5, v55
    v_cmp_eq_u32 vcc, -1, v5
    s_cbranch_vccnz L_vo_rt9
    s_branch L_vo_bk9
L_red:
    s_sub_u32 s25, s25, 16
    s_lshl_b32 s75, s25, 2
    s_add_u32 s75, s75, s24
    s_lshl_b32 s74, s26, 19
    s_add_u32 s74, s74, 192937984
    s_mul_i32 s28, s24, 1280
    s_add_u32 s28, s28, 12288
    v_add_u32 v3, s28, v2
    v_lshlrev_b32 v4, 2, v1
    s_add_u32 s28, s28, 1024
    v_add_u32 v4, s28, v4
    v_bfe_u32 v5, v1, 3, 2
    v_lshlrev_b32 v5, 4, v5
    v_lshrrev_b32 v12, 5, v1
    v_lshl_add_u32 v5, v12, 3, v5
    v_and_b32 v13, 7, v1
    v_add_u32 v5, v5, v13
    v_lshlrev_b32 v5, 4, v5
    s_lshl_b32 s28, s24, 10
    v_add_u32 v5, s28, v5
    s_lshl_b32 s28, s24, 1
    v_add_u32 v12, s28, v12
    v_and_b32 v6, 3, v12
    v_lshlrev_b32 v6, 4, v6
    v_lshrrev_b32 v12, 2, v12
    v_lshl_add_u32 v6, v12, 3, v6
    v_bfe_u32 v12, v1, 2, 3
    v_add_u32 v6, v6, v12
    v_lshlrev_b32 v6, 4, v6
    v_and_b32 v12, 3, v1
    v_lshl_add_u32 v6, v12, 2, v6
    v_add_u32 v6, 4096, v6
    s_lshl_b32 s28, s75, 11
    s_add_u32 s28, s28, 45056
    v_add_u32 v7, s28, v2
    v_lshlrev_b32 v8, 4, v13
    v_lshrrev_b32 v12, 5, v1
    v_lshl_add_u32 v8, v12, 7, v8
    v_bfe_u32 v12, v1, 4, 1
    v_lshl_add_u32 v8, v12, 3, v8
    s_lshl_b32 s28, s75, 8
    v_add_u32 v8, s28, v8
    s_mov_b32 s82, 0x00ff00ff
    s_mov_b32 s83, 0x00ff00ff
    v_mul_u32_u24 v13, 4, v1
    s_lshr_b32 s28, s75, 2
    s_lshl_b32 s28, s28, 14
    s_and_b32 s29, s75, 3
    s_lshl_b32 s29, s29, 11
    s_add_u32 s28, s28, s29
    s_add_u32 s28, s28, 195035136
    v_add_u32 v13, s28, v13
    v_bfe_u32 v12, v1, 3, 1
    v_lshl_add_u32 v8, v12, 2, v8
    s_add_u32 s29, s26, 0
    s_and_b32 s29, s29, 3
    s_lshl_b32 s29, s29, 9
    v_add_u32 v9, s29, v13
    s_add_u32 s29, s26, 1
    s_and_b32 s29, s29, 3
    s_lshl_b32 s29, s29, 9
    v_add_u32 v10, s29, v13
    s_add_u32 s29, s26, 2
    s_and_b32 s29, s29, 3
    s_lshl_b32 s29, s29, 9
    v_add_u32 v11, s29, v13
    s_add_u32 s29, s26, 3
    s_and_b32 s29, s29, 3
    s_lshl_b32 s29, s29, 9
    v_add_u32 v16, s29, v13
    s_lshl_b32 s28, s75, 15
    s_lshl_b32 s29, s26, 13
    s_add_u32 s28, s28, s29
    s_add_u32 s28, s28, 75497472
    v_add_u32 v18, s28, v2
    v_add_u32 v19, 4096, v18
    v_and_b32 v20, 7, v1
    s_lshl_b32 s28, s26, 3
    v_add_u32 v20, s28, v20
    v_lshlrev_b32 v20, 7, v20
    v_add_u32 v20, 192422912, v20
    s_mul_i32 s28, s26, 10
    s_add_u32 s28, s28, s25
    s_lshl_b32 s28, s28, 7
    s_add_u32 s28, s28, 192427008
    v_mov_b32 v21, s28
    s_mul_i32 s28, s26, 2621440
    s_lshl_b32 s29, s75, 10
    s_add_u32 s28, s28, s29
    s_add_u32 s28, s28, 159383552
    v_add_u32 v22, s28, v2
    s_mul_i32 s30, s24, 5120
    s_add_u32 s28, s30, 20480
    v_add_u32 v23, s28, v2
    v_add_u32 v24, 8192, v2
    v_mov_b32 v28, -1
    v_mov_b32 v29, -1
    v_mov_b32 v30, -1
    v_mov_b32 v31, -1
    s_mov_b32 s12, s38
    s_mov_b32 s13, s39
    s_mov_b32 s14, 10240
    s_mov_b32 s15, 0x20000
    v_and_b32 v12, 7, v1
    v_mul_u32_u24 v12, 1280, v12
    v_lshrrev_b32 v13, 3, v1
    v_lshl_add_u32 v12, v13, 2, v12
    s_lshl_b32 s28, s75, 5
    buffer_load_dword v82, v12, s[12:15], s28 offen
    v_and_b32 v12, 3, v1
    v_lshlrev_b32 v12, 2, v12
    v_bfe_u32 v13, v1, 2, 1
    v_lshl_add_u32 v12, v13, 7, v12
    v_cmp_lt_u32 vcc, 7, v1
    v_mov_b32 v13, 16
    s_nop 0
    v_cndmask_b32 v12, v12, v13, vcc
L_red_st:
    buffer_load_dword v13, v12, s[8:11], 0 offen sc1
    s_waitcnt vmcnt(0)
    v_cmp_gt_u32 vcc, 32, v13
    v_readlane_b32 s28, v13, 8
    s_cbranch_vccnz L_red_st_no
    s_cmp_ge_u32 s28, 64
    s_cbranch_scc1 L_red_st_ok
L_red_st_no:
    s_sleep 4
    s_sub_u32 s27, s27, 1
    s_cbranch_scc1 L_fail
    s_branch L_red_st
L_red_st_ok:
    v_min_u32 v82, -2, v82
    buffer_store_dword v82, v8, s[4:7], s74 offen
    s_mov_b32 s77, 0
    s_mov_b32 s78, 0
    s_mov_b32 s79, 0
    s_mov_b32 s80, 0
    s_mov_b32 s81, 0
    s_or_b32 s28, s75, s26
    s_cmp_eq_u32 s28, 0
    s_cbranch_scc0 L_red_polw
    s_mov_b32 s66, -1
    s_mov_b32 s67, -1
    s_mov_b32 s31, 8
L_red_pm:
    v_mov_b32 v84, -1
    v_mov_b32 v85, -1
    s_mov_b32 s29, 196608
    s_memtime s[92:93]
    s_waitcnt lgkmcnt(0)
    buffer_atomic_swap v84, v9, s[4:7], s29 offen sc0 sc1
    s_waitcnt vmcnt(0)
    s_memtime s[94:95]
    s_waitcnt lgkmcnt(0)
    s_sub_u32 s28, s94, s92
    s_min_u32 s66, s66, s28
    v_mov_b32 v84, -1
    v_mov_b32 v85, -1
    s_mov_b32 s29, 204800
    s_memtime s[92:93]
    s_waitcnt lgkmcnt(0)
    buffer_atomic_swap v84, v9, s[4:7], s29 offen sc0 sc1
    s_waitcnt vmcnt(0)
    s_memtime s[94:95]
    s_waitcnt lgkmcnt(0)
    s_sub_u32 s28, s94, s92
    s_min_u32 s67, s67, s28
    s_sub_u32 s31, s31, 1
    s_cmp_gt_u32 s31, 0
    s_cbranch_scc1 L_red_pm
    s_cmp_lt_u32 s67, s66
    s_cselect_b32 s28, 2, 1
    v_mov_b32 v12, s28
    v_mov_b32 v13, 20
    buffer_store_dword v12, v13, s[8:11], 0 offen sc1
L_red_polw:
    v_mov_b32 v13, 20
L_red_polp:
    buffer_load_dword v12, v13, s[8:11], 0 offen sc1
    s_waitcnt vmcnt(0)
    v_readfirstlane_b32 s28, v12
    s_nop 3
    s_cmp_lg_u32 s28, 0
    s_cbranch_scc1 L_red_polok
    s_sleep 4
    s_sub_u32 s27, s27, 1
    s_cbranch_scc1 L_fail
    s_branch L_red_polp
L_red_polok:
    s_and_b32 s28, s28, 2
    s_lshl_b32 s80, s28, 12
    s_mov_b32 s64, 1
    s_cmp_ge_u32 s78, s64
    s_cbranch_scc1 L_red_u0_ok
L_red_u0:
    buffer_load_dword v12, v20, s[4:7], 0 offen sc1
    s_waitcnt vmcnt(0)
    s_nop 1
    v_min_u32_dpp v12, v12, v12 row_shr:1 row_mask:0xf bank_mask:0xf
    s_nop 1
    v_min_u32_dpp v12, v12, v12 row_shr:2 row_mask:0xf bank_mask:0xf
    s_nop 1
    v_min_u32_dpp v12, v12, v12 row_shr:4 row_mask:0xf bank_mask:0xf
    s_nop 1
    v_min_u32_dpp v12, v12, v12 row_shr:8 row_mask:0xf bank_mask:0xf
    s_nop 1
    v_min_u32_dpp v12, v12, v12 row_bcast:15 row_mask:0xa bank_mask:0xf
    s_nop 1
    v_min_u32_dpp v12, v12, v12 row_bcast:31 row_mask:0xc bank_mask:0xf
    s_nop 0
    v_readlane_b32 s78, v12, 63
    s_nop 3
    s_cmp_ge_u32 s78, s64
    s_cbranch_scc1 L_red_u0_ok
    s_sub_u32 s27, s27, 1
    s_cbranch_scc1 L_fail
    s_branch L_red_u0
L_red_u0_ok:
    buffer_load_dwordx4 v[128:131], v18, s[4:7], s79 offen offset:0 sc1
    buffer_load_dwordx4 v[132:135], v18, s[4:7], s79 offen offset:1024 sc1
    buffer_load_dwordx4 v[136:139], v18, s[4:7], s79 offen offset:2048 sc1
    buffer_load_dwordx4 v[140:143], v18, s[4:7], s79 offen offset:3072 sc1
    buffer_load_dwordx4 v[144:147], v19, s[4:7], s79 offen offset:0 sc1
    buffer_load_dwordx4 v[148:151], v19, s[4:7], s79 offen offset:1024 sc1
    buffer_load_dwordx4 v[152:155], v19, s[4:7], s79 offen offset:2048 sc1
    buffer_load_dwordx4 v[156:159], v19, s[4:7], s79 offen offset:3072 sc1
    s_add_u32 s79, s79, 1310720
L_red_loop:
    s_and_b32 s28, s77, 3
    s_lshl_b32 s28, s28, 17
    s_add_u32 s76, s74, s28
    s_lshl_b32 s65, s28, 1
    s_add_u32 s65, s65, s80
    s_add_u32 s66, s65, 1048576
    s_add_u32 s69, s77, 1
    s_and_b32 s69, s69, 3
    s_lshl_b32 s69, s69, 17
    s_add_u32 s69, s69, s74
    buffer_load_dwordx4 v[64:67], v3, s[4:7], s76 offen sc1
    buffer_load_dword v68, v4, s[4:7], s76 offen sc1
L_red0_um:
    buffer_load_dwordx4 v[160:163], v7, s[4:7], s76 offen sc1
    buffer_load_dwordx4 v[164:167], v7, s[4:7], s76 offen offset:1024 sc1
    buffer_load_dwordx4 v[72:75], v3, s[4:7], s76 offen sc1
    buffer_load_dword v76, v4, s[4:7], s76 offen sc1
    s_waitcnt vmcnt(4)
    v_max3_u32 v60, v64, v65, v66
    v_max_u32 v61, v67, v68
    v_max_u32 v62, v60, v61
    v_cmp_eq_u32 vcc, -1, v62
    s_cbranch_vccz L_red0_pUA
    buffer_load_dwordx4 v[64:67], v3, s[4:7], s76 offen sc1
    buffer_load_dword v68, v4, s[4:7], s76 offen sc1
    s_waitcnt vmcnt(2)
    v_max3_u32 v60, v72, v73, v74
    v_max_u32 v61, v75, v76
    v_max_u32 v62, v60, v61
    v_cmp_eq_u32 vcc, -1, v62
    s_cbranch_vccz L_red0_pUB
    v_max3_u32 v60, v160, v161, v162
    v_max3_u32 v61, v163, v164, v165
    v_max_u32 v62, v166, v167
    v_max3_u32 v63, v60, v61, v62
    v_cmp_eq_u32 vcc, -1, v63
    s_cbranch_vccz L_red0_pp
    s_sub_u32 s27, s27, 1
    s_cbranch_scc0 L_red0_um
    s_branch L_fail
L_red0_pp:
    buffer_load_dwordx4 v[72:75], v3, s[4:7], s76 offen sc1
    buffer_load_dword v76, v4, s[4:7], s76 offen sc1
    s_waitcnt vmcnt(2)
    v_max3_u32 v60, v64, v65, v66
    v_max_u32 v61, v67, v68
    v_max_u32 v62, v60, v61
    v_cmp_eq_u32 vcc, -1, v62
    s_cbranch_vccz L_red0_pA
    buffer_load_dwordx4 v[64:67], v3, s[4:7], s76 offen sc1
    buffer_load_dword v68, v4, s[4:7], s76 offen sc1
    s_waitcnt vmcnt(2)
    v_max3_u32 v60, v72, v73, v74
    v_max_u32 v61, v75, v76
    v_max_u32 v62, v60, v61
    v_cmp_eq_u32 vcc, -1, v62
    s_cbranch_vccz L_red0_pB
    s_sub_u32 s27, s27, 1
    s_cbranch_scc0 L_red0_pp
    s_branch L_fail
L_red0_pB:
    ds_write_b128 v5, v[72:75]
    ds_write_b32 v6, v76
    s_branch L_red0_pw
L_red0_pA:
    ds_write_b128 v5, v[64:67]
    ds_write_b32 v6, v68
L_red0_pw:
    s_waitcnt lgkmcnt(0)
    s_barrier
    ds_read_b128 v[32:35], v2 offset:0
    ds_read_b128 v[36:39], v2 offset:1024
    ds_read_b128 v[40:43], v2 offset:2048
    ds_read_b128 v[44:47], v2 offset:3072
    ds_read_b128 v[48:51], v2 offset:4096
    s_waitcnt lgkmcnt(4)
    v_mfma_f32_16x16x32_bf16 v[52:55], v[128:131], v[32:35], 0
    v_mfma_f32_16x16x32_bf16 v[56:59], v[132:135], v[32:35], 0
    s_waitcnt lgkmcnt(3)
    v_mfma_f32_16x16x32_bf16 v[52:55], v[136:139], v[36:39], v[52:55]
    v_mfma_f32_16x16x32_bf16 v[56:59], v[140:143], v[36:39], v[56:59]
    s_waitcnt lgkmcnt(2)
    v_mfma_f32_16x16x32_bf16 v[52:55], v[144:147], v[40:43], v[52:55]
    v_mfma_f32_16x16x32_bf16 v[56:59], v[148:151], v[40:43], v[56:59]
    s_waitcnt lgkmcnt(1)
    v_mfma_f32_16x16x32_bf16 v[52:55], v[152:155], v[44:47], v[52:55]
    v_mfma_f32_16x16x32_bf16 v[56:59], v[156:159], v[44:47], v[56:59]
    s_waitcnt lgkmcnt(0)
    v_mfma_f32_16x16x32_bf16 v[52:55], v[160:163], v[48:51], v[52:55]
    v_mfma_f32_16x16x32_bf16 v[56:59], v[164:167], v[48:51], v[56:59]
    s_nop 7
    v_add_f32_dpp v80, v56, v52 row_ror:8 row_mask:0xf bank_mask:0x3
    v_add_f32_dpp v81, v57, v53 row_ror:8 row_mask:0xf bank_mask:0x3
    v_add_f32_dpp v80, v54, v58 row_ror:8 row_mask:0xf bank_mask:0xc
    v_add_f32_dpp v81, v55, v59 row_ror:8 row_mask:0xf bank_mask:0xc
    v_cvt_pk_bf16_f32 v83, v80, v81
    v_min_u32 v83, -2, v83
    buffer_store_dword v83, v9, s[4:7], s65 offen offset:0 sc1
    buffer_store_dword v83, v9, s[4:7], s65 offen offset:256 sc1
    ds_read_b128 a[0:3], v24 offset:0
    ds_read_b128 a[4:7], v24 offset:10240
    ds_read_b128 a[8:11], v24 offset:1024
    ds_read_b128 a[12:15], v24 offset:11264
    ds_read_b128 a[16:19], v24 offset:2048
    ds_read_b128 a[20:23], v24 offset:12288
    ds_read_b128 a[24:27], v24 offset:3072
    s_waitcnt lgkmcnt(6)
    v_mfma_f32_16x16x32_bf16 v[96:99], v[168:171], a[0:3], 0
    ds_read_b128 a[28:31], v24 offset:13312
    s_waitcnt lgkmcnt(6)
    v_mfma_f32_16x16x32_bf16 v[100:103], v[168:171], a[4:7], 0
    ds_read_b128 a[0:3], v24 offset:4096
    s_waitcnt lgkmcnt(6)
    v_mfma_f32_16x16x32_bf16 v[96:99], v[172:175], a[8:11], v[96:99]
    ds_read_b128 a[4:7], v24 offset:14336
    s_waitcnt lgkmcnt(6)
    v_mfma_f32_16x16x32_bf16 v[100:103], v[172:175], a[12:15], v[100:103]
    ds_read_b128 a[8:11], v24 offset:5120
    s_waitcnt lgkmcnt(6)
    v_mfma_f32_16x16x32_bf16 v[96:99], v[176:179], a[16:19], v[96:99]
    ds_read_b128 a[12:15], v24 offset:15360
    s_waitcnt lgkmcnt(6)
    v_mfma_f32_16x16x32_bf16 v[100:103], v[176:179], a[20:23], v[100:103]
    ds_read_b128 a[16:19], v24 offset:6144
    s_waitcnt lgkmcnt(6)
    v_mfma_f32_16x16x32_bf16 v[96:99], v[180:183], a[24:27], v[96:99]
    ds_read_b128 a[20:23], v24 offset:16384
    s_waitcnt lgkmcnt(6)
    v_mfma_f32_16x16x32_bf16 v[100:103], v[180:183], a[28:31], v[100:103]
    buffer_load_dword v84, v10, s[4:7], s65 offen offset:0 sc1
    buffer_load_dword v85, v11, s[4:7], s65 offen offset:0 sc1
    buffer_load_dword v86, v16, s[4:7], s65 offen offset:0 sc1
    ds_read_b128 a[24:27], v24 offset:7168
    s_waitcnt lgkmcnt(6)
    v_mfma_f32_16x16x32_bf16 v[96:99], v[184:187], a[0:3], v[96:99]
    ds_read_b128 a[28:31], v24 offset:17408
    s_waitcnt lgkmcnt(6)
    v_mfma_f32_16x16x32_bf16 v[100:103], v[184:187], a[4:7], v[100:103]
    ds_read_b128 a[0:3], v24 offset:8192
    s_waitcnt lgkmcnt(6)
    v_mfma_f32_16x16x32_bf16 v[96:99], v[188:191], a[8:11], v[96:99]
    ds_read_b128 a[4:7], v24 offset:18432
    s_waitcnt lgkmcnt(6)
    v_mfma_f32_16x16x32_bf16 v[100:103], v[188:191], a[12:15], v[100:103]
    ds_read_b128 a[8:11], v24 offset:9216
    s_waitcnt lgkmcnt(6)
    v_mfma_f32_16x16x32_bf16 v[96:99], v[192:195], a[16:19], v[96:99]
    ds_read_b128 a[12:15], v24 offset:19456
    s_waitcnt lgkmcnt(6)
    v_mfma_f32_16x16x32_bf16 v[100:103], v[192:195], a[20:23], v[100:103]
    s_waitcnt lgkmcnt(5)
    v_mfma_f32_16x16x32_bf16 v[96:99], v[196:199], a[24:27], v[96:99]
    s_waitcnt lgkmcnt(4)
    v_mfma_f32_16x16x32_bf16 v[100:103], v[196:199], a[28:31], v[100:103]
    s_waitcnt lgkmcnt(3)
    v_mfma_f32_16x16x32_bf16 v[96:99], v[200:203], a[0:3], v[96:99]
    s_waitcnt lgkmcnt(2)
    v_mfma_f32_16x16x32_bf16 v[100:103], v[200:203], a[4:7], v[100:103]
    s_waitcnt lgkmcnt(1)
    v_mfma_f32_16x16x32_bf16 v[96:99], v[204:207], a[8:11], v[96:99]
    s_waitcnt lgkmcnt(0)
    v_mfma_f32_16x16x32_bf16 v[100:103], v[204:207], a[12:15], v[100:103]
    buffer_load_dword v104, v10, s[4:7], s65 offen offset:256 sc1
    buffer_load_dword v105, v11, s[4:7], s65 offen offset:256 sc1
    buffer_load_dword v106, v16, s[4:7], s65 offen offset:256 sc1
    s_waitcnt vmcnt(3)
    v_max3_u32 v60, v84, v85, v86
    v_cmp_eq_u32 vcc, -1, v60
    s_cbranch_vccz L_red0_xok
    s_waitcnt vmcnt(0)
    v_min_u32 v84, v84, v104
    v_min_u32 v85, v85, v105
    v_min_u32 v86, v86, v106
    v_max3_u32 v60, v84, v85, v86
    v_cmp_eq_u32 vcc, -1, v60
    s_cbranch_vccz L_red0_xok
    s_branch L_red0_x
L_red0_x_r:
    s_sub_u32 s27, s27, 1
    s_cbranch_scc1 L_fail
L_red0_x:
    buffer_load_dword v84, v10, s[4:7], s65 offen offset:0 sc1
    buffer_load_dword v85, v11, s[4:7], s65 offen offset:0 sc1
    buffer_load_dword v86, v16, s[4:7], s65 offen offset:0 sc1
    s_waitcnt vmcnt(0)
    v_max3_u32 v60, v84, v85, v86
    v_cmp_eq_u32 vcc, -1, v60
    s_cbranch_vccnz L_red0_x_r
L_red0_xok:
    v_lshlrev_b32 v90, 16, v84
    v_and_b32 v91, 0xffff0000, v84
    v_lshlrev_b32 v92, 16, v85
    v_and_b32 v93, 0xffff0000, v85
    v_lshlrev_b32 v94, 16, v86
    v_and_b32 v95, 0xffff0000, v86
    v_pk_add_f32 v[80:81], v[80:81], v[90:91]
    v_pk_add_f32 v[92:93], v[92:93], v[94:95]
    v_pk_add_f32 v[80:81], v[80:81], v[92:93]
    v_cvt_pk_bf16_f32 v82, v80, v81
    v_min_u32 v82, -2, v82
    buffer_store_dword v82, v8, s[4:7], s69 offen
    s_barrier
    s_add_u32 s28, s77, 3
    s_and_b32 s28, s28, 3
    s_lshl_b32 s28, s28, 17
    s_add_u32 s28, s28, s74
    s_add_u32 m0, s30, 8192
    s_nop 0
    buffer_load_dwordx4 v23, s[4:7], s28 offen offset:0 sc1 lds
    buffer_load_dwordx4 v23, s[4:7], s28 offen offset:1024 sc1 lds
    buffer_load_dwordx4 v23, s[4:7], s28 offen offset:2048 sc1 lds
    buffer_load_dwordx4 v23, s[4:7], s28 offen offset:3072 sc1 lds
    s_add_u32 m0, s30, 12288
    s_add_u32 s28, s28, 4096
    buffer_load_dwordx4 v23, s[4:7], s28 offen sc1 lds
    s_add_u32 s64, s77, 2
    s_cmp_ge_u32 s78, s64
    s_cbranch_scc1 L_red0_u_ok
L_red0_u:
    buffer_load_dword v12, v20, s[4:7], 0 offen sc1
    s_waitcnt vmcnt(0)
    s_nop 1
    v_min_u32_dpp v12, v12, v12 row_shr:1 row_mask:0xf bank_mask:0xf
    s_nop 1
    v_min_u32_dpp v12, v12, v12 row_shr:2 row_mask:0xf bank_mask:0xf
    s_nop 1
    v_min_u32_dpp v12, v12, v12 row_shr:4 row_mask:0xf bank_mask:0xf
    s_nop 1
    v_min_u32_dpp v12, v12, v12 row_shr:8 row_mask:0xf bank_mask:0xf
    s_nop 1
    v_min_u32_dpp v12, v12, v12 row_bcast:15 row_mask:0xa bank_mask:0xf
    s_nop 1
    v_min_u32_dpp v12, v12, v12 row_bcast:31 row_mask:0xc bank_mask:0xf
    s_nop 0
    v_readlane_b32 s78, v12, 63
    s_nop 3
    s_cmp_ge_u32 s78, s64
    s_cbranch_scc1 L_red0_u_ok
    s_sub_u32 s27, s27, 1
    s_cbranch_scc1 L_fail
    s_branch L_red0_u
L_red0_u_ok:
    buffer_load_dwordx4 v[168:171], v18, s[4:7], s79 offen offset:0 sc1
    buffer_load_dwordx4 v[172:175], v18, s[4:7], s79 offen offset:1024 sc1
    buffer_load_dwordx4 v[176:179], v18, s[4:7], s79 offen offset:2048 sc1
    buffer_load_dwordx4 v[180:183], v18, s[4:7], s79 offen offset:3072 sc1
    buffer_load_dwordx4 v[184:187], v19, s[4:7], s79 offen offset:0 sc1
    buffer_load_dwordx4 v[188:191], v19, s[4:7], s79 offen offset:1024 sc1
    buffer_load_dwordx4 v[192:195], v19, s[4:7], s79 offen offset:2048 sc1
    buffer_load_dwordx4 v[196:199], v19, s[4:7], s79 offen offset:3072 sc1
    s_add_u32 s79, s79, 1310720
    buffer_store_dword v28, v8, s[4:7], s76 offen
    s_cmp_lt_u32 s77, 2
    s_cbranch_scc1 L_red0_noxo
    v_cvt_pk_bf16_f32 v116, v96, v97
    v_cvt_pk_bf16_f32 v117, v98, v99
    v_cvt_pk_bf16_f32 v118, v100, v101
    v_cvt_pk_bf16_f32 v119, v102, v103
    buffer_store_dwordx4 v[116:119], v22, s[4:7], s81 offen sc1
    s_add_u32 s81, s81, 40960
    s_sub_u32 s28, s77, 2
    s_cmp_eq_u32 s24, 0
    s_cbranch_scc0 L_red0_pub
    v_mov_b32 v12, s28
    s_mov_b64 exec, 1
    buffer_store_dword v12, v21, s[4:7], 0 offen offset:0 sc1
    s_mov_b64 exec, -1
L_red0_pub:
L_red0_noxo:
    s_add_u32 s67, s77, 3
    s_and_b32 s67, s67, 3
    s_lshl_b32 s67, s67, 18
    s_add_u32 s67, s67, s80
    buffer_store_dword v28, v9, s[4:7], s67 offen offset:0 sc1
    buffer_store_dword v28, v9, s[4:7], s67 offen offset:256 sc1
    s_add_u32 s77, s77, 1
    s_and_b32 s28, s77, 3
    s_lshl_b32 s28, s28, 17
    s_add_u32 s76, s74, s28
    s_lshl_b32 s65, s28, 1
    s_add_u32 s65, s65, s80
    s_add_u32 s66, s65, 1048576
    s_add_u32 s69, s77, 1
    s_and_b32 s69, s69, 3
    s_lshl_b32 s69, s69, 17
    s_add_u32 s69, s69, s74
    buffer_load_dwordx4 v[64:67], v3, s[4:7], s76 offen sc1
    buffer_load_dword v68, v4, s[4:7], s76 offen sc1
L_red1_um:
    buffer_load_dwordx4 v[200:203], v7, s[4:7], s76 offen sc1
    buffer_load_dwordx4 v[204:207], v7, s[4:7], s76 offen offset:1024 sc1
    buffer_load_dwordx4 v[72:75], v3, s[4:7], s76 offen sc1
    buffer_load_dword v76, v4, s[4:7], s76 offen sc1
    s_waitcnt vmcnt(4)
    v_max3_u32 v60, v64, v65, v66
    v_max_u32 v61, v67, v68
    v_max_u32 v62, v60, v61
    v_cmp_eq_u32 vcc, -1, v62
    s_cbranch_vccz L_red1_pUA
    buffer_load_dwordx4 v[64:67], v3, s[4:7], s76 offen sc1
    buffer_load_dword v68, v4, s[4:7], s76 offen sc1
    s_waitcnt vmcnt(2)
    v_max3_u32 v60, v72, v73, v74
    v_max_u32 v61, v75, v76
    v_max_u32 v62, v60, v61
    v_cmp_eq_u32 vcc, -1, v62
    s_cbranch_vccz L_red1_pUB
    v_max3_u32 v60, v200, v201, v202
    v_max3_u32 v61, v203, v204, v205
    v_max_u32 v62, v206, v207
    v_max3_u32 v63, v60, v61, v62
    v_cmp_eq_u32 vcc, -1, v63
    s_cbranch_vccz L_red1_pp
    s_sub_u32 s27, s27, 1
    s_cbranch_scc0 L_red1_um
    s_branch L_fail
L_red1_pp:
    buffer_load_dwordx4 v[72:75], v3, s[4:7], s76 offen sc1
    buffer_load_dword v76, v4, s[4:7], s76 offen sc1
    s_waitcnt vmcnt(2)
    v_max3_u32 v60, v64, v65, v66
    v_max_u32 v61, v67, v68
    v_max_u32 v62, v60, v61
    v_cmp_eq_u32 vcc, -1, v62
    s_cbranch_vccz L_red1_pA
    buffer_load_dwordx4 v[64:67], v3, s[4:7], s76 offen sc1
    buffer_load_dword v68, v4, s[4:7], s76 offen sc1
    s_waitcnt vmcnt(2)
    v_max3_u32 v60, v72, v73, v74
    v_max_u32 v61, v75, v76
    v_max_u32 v62, v60, v61
    v_cmp_eq_u32 vcc, -1, v62
    s_cbranch_vccz L_red1_pB
    s_sub_u32 s27, s27, 1
    s_cbranch_scc0 L_red1_pp
    s_branch L_fail
L_red1_pB:
    ds_write_b128 v5, v[72:75]
    ds_write_b32 v6, v76
    s_branch L_red1_pw
L_red1_pA:
    ds_write_b128 v5, v[64:67]
    ds_write_b32 v6, v68
L_red1_pw:
    s_waitcnt lgkmcnt(0)
    s_barrier
    ds_read_b128 v[32:35], v2 offset:0
    ds_read_b128 v[36:39], v2 offset:1024
    ds_read_b128 v[40:43], v2 offset:2048
    ds_read_b128 v[44:47], v2 offset:3072
    ds_read_b128 v[48:51], v2 offset:4096
    s_waitcnt lgkmcnt(4)
    v_mfma_f32_16x16x32_bf16 v[52:55], v[168:171], v[32:35], 0
    v_mfma_f32_16x16x32_bf16 v[56:59], v[172:175], v[32:35], 0
    s_waitcnt lgkmcnt(3)
    v_mfma_f32_16x16x32_bf16 v[52:55], v[176:179], v[36:39], v[52:55]
    v_mfma_f32_16x16x32_bf16 v[56:59], v[180:183], v[36:39], v[56:59]
    s_waitcnt lgkmcnt(2)
    v_mfma_f32_16x16x32_bf16 v[52:55], v[184:187], v[40:43], v[52:55]
    v_mfma_f32_16x16x32_bf16 v[56:59], v[188:191], v[40:43], v[56:59]
    s_waitcnt lgkmcnt(1)
    v_mfma_f32_16x16x32_bf16 v[52:55], v[192:195], v[44:47], v[52:55]
    v_mfma_f32_16x16x32_bf16 v[56:59], v[196:199], v[44:47], v[56:59]
    s_waitcnt lgkmcnt(0)
    v_mfma_f32_16x16x32_bf16 v[52:55], v[200:203], v[48:51], v[52:55]
    v_mfma_f32_16x16x32_bf16 v[56:59], v[204:207], v[48:51], v[56:59]
    s_nop 7
    v_add_f32_dpp v80, v56, v52 row_ror:8 row_mask:0xf bank_mask:0x3
    v_add_f32_dpp v81, v57, v53 row_ror:8 row_mask:0xf bank_mask:0x3
    v_add_f32_dpp v80, v54, v58 row_ror:8 row_mask:0xf bank_mask:0xc
    v_add_f32_dpp v81, v55, v59 row_ror:8 row_mask:0xf bank_mask:0xc
    v_cvt_pk_bf16_f32 v83, v80, v81
    v_min_u32 v83, -2, v83
    buffer_store_dword v83, v9, s[4:7], s65 offen offset:0 sc1
    buffer_store_dword v83, v9, s[4:7], s65 offen offset:256 sc1
    ds_read_b128 a[0:3], v24 offset:0
    ds_read_b128 a[4:7], v24 offset:10240
    ds_read_b128 a[8:11], v24 offset:1024
    ds_read_b128 a[12:15], v24 offset:11264
    ds_read_b128 a[16:19], v24 offset:2048
    ds_read_b128 a[20:23], v24 offset:12288
    ds_read_b128 a[24:27], v24 offset:3072
    s_waitcnt lgkmcnt(6)
    v_mfma_f32_16x16x32_bf16 v[96:99], v[208:211], a[0:3], 0
    ds_read_b128 a[28:31], v24 offset:13312
    s_waitcnt lgkmcnt(6)
    v_mfma_f32_16x16x32_bf16 v[100:103], v[208:211], a[4:7], 0
    ds_read_b128 a[0:3], v24 offset:4096
    s_waitcnt lgkmcnt(6)
    v_mfma_f32_16x16x32_bf16 v[96:99], v[212:215], a[8:11], v[96:99]
    ds_read_b128 a[4:7], v24 offset:14336
    s_waitcnt lgkmcnt(6)
    v_mfma_f32_16x16x32_bf16 v[100:103], v[212:215], a[12:15], v[100:103]
    ds_read_b128 a[8:11], v24 offset:5120
    s_waitcnt lgkmcnt(6)
    v_mfma_f32_16x16x32_bf16 v[96:99], v[216:219], a[16:19], v[96:99]
    ds_read_b128 a[12:15], v24 offset:15360
    s_waitcnt lgkmcnt(6)
    v_mfma_f32_16x16x32_bf16 v[100:103], v[216:219], a[20:23], v[100:103]
    ds_read_b128 a[16:19], v24 offset:6144
    s_waitcnt lgkmcnt(6)
    v_mfma_f32_16x16x32_bf16 v[96:99], v[220:223], a[24:27], v[96:99]
    ds_read_b128 a[20:23], v24 offset:16384
    s_waitcnt lgkmcnt(6)
    v_mfma_f32_16x16x32_bf16 v[100:103], v[220:223], a[28:31], v[100:103]
    buffer_load_dword v84, v10, s[4:7], s65 offen offset:0 sc1
    buffer_load_dword v85, v11, s[4:7], s65 offen offset:0 sc1
    buffer_load_dword v86, v16, s[4:7], s65 offen offset:0 sc1
    ds_read_b128 a[24:27], v24 offset:7168
    s_waitcnt lgkmcnt(6)
    v_mfma_f32_16x16x32_bf16 v[96:99], v[224:227], a[0:3], v[96:99]
    ds_read_b128 a[28:31], v24 offset:17408
    s_waitcnt lgkmcnt(6)
    v_mfma_f32_16x16x32_bf16 v[100:103], v[224:227], a[4:7], v[100:103]
    ds_read_b128 a[0:3], v24 offset:8192
    s_waitcnt lgkmcnt(6)
    v_mfma_f32_16x16x32_bf16 v[96:99], v[228:231], a[8:11], v[96:99]
    ds_read_b128 a[4:7], v24 offset:18432
    s_waitcnt lgkmcnt(6)
    v_mfma_f32_16x16x32_bf16 v[100:103], v[228:231], a[12:15], v[100:103]
    ds_read_b128 a[8:11], v24 offset:9216
    s_waitcnt lgkmcnt(6)
    v_mfma_f32_16x16x32_bf16 v[96:99], v[232:235], a[16:19], v[96:99]
    ds_read_b128 a[12:15], v24 offset:19456
    s_waitcnt lgkmcnt(6)
    v_mfma_f32_16x16x32_bf16 v[100:103], v[232:235], a[20:23], v[100:103]
    s_waitcnt lgkmcnt(5)
    v_mfma_f32_16x16x32_bf16 v[96:99], v[236:239], a[24:27], v[96:99]
    s_waitcnt lgkmcnt(4)
    v_mfma_f32_16x16x32_bf16 v[100:103], v[236:239], a[28:31], v[100:103]
    s_waitcnt lgkmcnt(3)
    v_mfma_f32_16x16x32_bf16 v[96:99], v[240:243], a[0:3], v[96:99]
    s_waitcnt lgkmcnt(2)
    v_mfma_f32_16x16x32_bf16 v[100:103], v[240:243], a[4:7], v[100:103]
    s_waitcnt lgkmcnt(1)
    v_mfma_f32_16x16x32_bf16 v[96:99], v[244:247], a[8:11], v[96:99]
    s_waitcnt lgkmcnt(0)
    v_mfma_f32_16x16x32_bf16 v[100:103], v[244:247], a[12:15], v[100:103]
    buffer_load_dword v104, v10, s[4:7], s65 offen offset:256 sc1
    buffer_load_dword v105, v11, s[4:7], s65 offen offset:256 sc1
    buffer_load_dword v106, v16, s[4:7], s65 offen offset:256 sc1
    s_waitcnt vmcnt(3)
    v_max3_u32 v60, v84, v85, v86
    v_cmp_eq_u32 vcc, -1, v60
    s_cbranch_vccz L_red1_xok
    s_waitcnt vmcnt(0)
    v_min_u32 v84, v84, v104
    v_min_u32 v85, v85, v105
    v_min_u32 v86, v86, v106
    v_max3_u32 v60, v84, v85, v86
    v_cmp_eq_u32 vcc, -1, v60
    s_cbranch_vccz L_red1_xok
    s_branch L_red1_x
L_red1_x_r:
    s_sub_u32 s27, s27, 1
    s_cbranch_scc1 L_fail
L_red1_x:
    buffer_load_dword v84, v10, s[4:7], s65 offen offset:0 sc1
    buffer_load_dword v85, v11, s[4:7], s65 offen offset:0 sc1
    buffer_load_dword v86, v16, s[4:7], s65 offen offset:0 sc1
    s_waitcnt vmcnt(0)
    v_max3_u32 v60, v84, v85, v86
    v_cmp_eq_u32 vcc, -1, v60
    s_cbranch_vccnz L_red1_x_r
L_red1_xok:
    v_lshlrev_b32 v90, 16, v84
    v_and_b32 v91, 0xffff0000, v84
    v_lshlrev_b32 v92, 16, v85
    v_and_b32 v93, 0xffff0000, v85
    v_lshlrev_b32 v94, 16, v86
    v_and_b32 v95, 0xffff0000, v86
    v_pk_add_f32 v[80:81], v[80:81], v[90:91]
    v_pk_add_f32 v[92:93], v[92:93], v[94:95]
    v_pk_add_f32 v[80:81], v[80:81], v[92:93]
    v_cvt_pk_bf16_f32 v82, v80, v81
    v_min_u32 v82, -2, v82
    buffer_store_dword v82, v8, s[4:7], s69 offen
    s_barrier
    s_add_u32 s28, s77, 3
    s_and_b32 s28, s28, 3
    s_lshl_b32 s28, s28, 17
    s_add_u32 s28, s28, s74
    s_add_u32 m0, s30, 8192
    s_nop 0
    buffer_load_dwordx4 v23, s[4:7], s28 offen offset:0 sc1 lds
    buffer_load_dwordx4 v23, s[4:7], s28 offen offset:1024 sc1 lds
    buffer_load_dwordx4 v23, s[4:7], s28 offen offset:2048 sc1 lds
    buffer_load_dwordx4 v23, s[4:7], s28 offen offset:3072 sc1 lds
    s_add_u32 m0, s30, 12288
    s_add_u32 s28, s28, 4096
    buffer_load_dwordx4 v23, s[4:7], s28 offen sc1 lds
    s_add_u32 s64, s77, 2
    s_cmp_ge_u32 s78, s64
    s_cbranch_scc1 L_red1_u_ok
L_red1_u:
    buffer_load_dword v12, v20, s[4:7], 0 offen sc1
    s_waitcnt vmcnt(0)
    s_nop 1
    v_min_u32_dpp v12, v12, v12 row_shr:1 row_mask:0xf bank_mask:0xf
    s_nop 1
    v_min_u32_dpp v12, v12, v12 row_shr:2 row_mask:0xf bank_mask:0xf
    s_nop 1
    v_min_u32_dpp v12, v12, v12 row_shr:4 row_mask:0xf bank_mask:0xf
    s_nop 1
    v_min_u32_dpp v12, v12, v12 row_shr:8 row_mask:0xf bank_mask:0xf
    s_nop 1
    v_min_u32_dpp v12, v12, v12 row_bcast:15 row_mask:0xa bank_mask:0xf
    s_nop 1
    v_min_u32_dpp v12, v12, v12 row_bcast:31 row_mask:0xc bank_mask:0xf
    s_nop 0
    v_readlane_b32 s78, v12, 63
    s_nop 3
    s_cmp_ge_u32 s78, s64
    s_cbranch_scc1 L_red1_u_ok
    s_sub_u32 s27, s27, 1
    s_cbranch_scc1 L_fail
    s_branch L_red1_u
L_red1_u_ok:
    buffer_load_dwordx4 v[208:211], v18, s[4:7], s79 offen offset:0 sc1
    buffer_load_dwordx4 v[212:215], v18, s[4:7], s79 offen offset:1024 sc1
    buffer_load_dwordx4 v[216:219], v18, s[4:7], s79 offen offset:2048 sc1
    buffer_load_dwordx4 v[220:223], v18, s[4:7], s79 offen offset:3072 sc1
    buffer_load_dwordx4 v[224:227], v19, s[4:7], s79 offen offset:0 sc1
    buffer_load_dwordx4 v[228:231], v19, s[4:7], s79 offen offset:1024 sc1
    buffer_load_dwordx4 v[232:235], v19, s[4:7], s79 offen offset:2048 sc1
    buffer_load_dwordx4 v[236:239], v19, s[4:7], s79 offen offset:3072 sc1
    s_add_u32 s79, s79, 1310720
    buffer_store_dword v28, v8, s[4:7], s76 offen
    s_cmp_lt_u32 s77, 2
    s_cbranch_scc1 L_red1_noxo
    v_cvt_pk_bf16_f32 v116, v96, v97
    v_cvt_pk_bf16_f32 v117, v98, v99
    v_cvt_pk_bf16_f32 v118, v100, v101
    v_cvt_pk_bf16_f32 v119, v102, v103
    buffer_store_dwordx4 v[116:119], v22, s[4:7], s81 offen sc1
    s_add_u32 s81, s81, 40960
    s_sub_u32 s28, s77, 2
    s_cmp_eq_u32 s24, 0
    s_cbranch_scc0 L_red1_pub
    v_mov_b32 v12, s28
    s_mov_b64 exec, 1
    buffer_store_dword v12, v21, s[4:7], 0 offen offset:0 sc1
    s_mov_b64 exec, -1
L_red1_pub:
L_red1_noxo:
    s_add_u32 s67, s77, 3
    s_and_b32 s67, s67, 3
    s_lshl_b32 s67, s67, 18
    s_add_u32 s67, s67, s80
    buffer_store_dword v28, v9, s[4:7], s67 offen offset:0 sc1
    buffer_store_dword v28, v9, s[4:7], s67 offen offset:256 sc1
    s_add_u32 s77, s77, 1
    s_and_b32 s28, s77, 3
    s_lshl_b32 s28, s28, 17
    s_add_u32 s76, s74, s28
    s_lshl_b32 s65, s28, 1
    s_add_u32 s65, s65, s80
    s_add_u32 s66, s65, 1048576
    s_add_u32 s69, s77, 1
    s_and_b32 s69, s69, 3
    s_lshl_b32 s69, s69, 17
    s_add_u32 s69, s69, s74
    buffer_load_dwordx4 v[64:67], v3, s[4:7], s76 offen sc1
    buffer_load_dword v68, v4, s[4:7], s76 offen sc1
L_red2_um:
    buffer_load_dwordx4 v[240:243], v7, s[4:7], s76 offen sc1
    buffer_load_dwordx4 v[244:247], v7, s[4:7], s76 offen offset:1024 sc1
    buffer_load_dwordx4 v[72:75], v3, s[4:7], s76 offen sc1
    buffer_load_dword v76, v4, s[4:7], s76 offen sc1
    s_waitcnt vmcnt(4)
    v_max3_u32 v60, v64, v65, v66
    v_max_u32 v61, v67, v68
    v_max_u32 v62, v60, v61
    v_cmp_eq_u32 vcc, -1, v62
    s_cbranch_vccz L_red2_pUA
    buffer_load_dwordx4 v[64:67], v3, s[4:7], s76 offen sc1
    buffer_load_dword v68, v4, s[4:7], s76 offen sc1
    s_waitcnt vmcnt(2)
    v_max3_u32 v60, v72, v73, v74
    v_max_u32 v61, v75, v76
    v_max_u32 v62, v60, v61
    v_cmp_eq_u32 vcc, -1, v62
    s_cbranch_vccz L_red2_pUB
    v_max3_u32 v60, v240, v241, v242
    v_max3_u32 v61, v243, v244, v245
    v_max_u32 v62, v246, v247
    v_max3_u32 v63, v60, v61, v62
    v_cmp_eq_u32 vcc, -1, v63
    s_cbranch_vccz L_red2_pp
    s_sub_u32 s27, s27, 1
    s_cbranch_scc0 L_red2_um
    s_branch L_fail
L_red2_pp:
    buffer_load_dwordx4 v[72:75], v3, s[4:7], s76 offen sc1
    buffer_load_dword v76, v4, s[4:7], s76 offen sc1
    s_waitcnt vmcnt(2)
    v_max3_u32 v60, v64, v65, v66
    v_max_u32 v61, v67, v68
    v_max_u32 v62, v60, v61
    v_cmp_eq_u32 vcc, -1, v62
    s_cbranch_vccz L_red2_pA
    buffer_load_dwordx4 v[64:67], v3, s[4:7], s76 offen sc1
    buffer_load_dword v68, v4, s[4:7], s76 offen sc1
    s_waitcnt vmcnt(2)
    v_max3_u32 v60, v72, v73, v74
    v_max_u32 v61, v75, v76
    v_max_u32 v62, v60, v61
    v_cmp_eq_u32 vcc, -1, v62
    s_cbranch_vccz L_red2_pB
    s_sub_u32 s27, s27, 1
    s_cbranch_scc0 L_red2_pp
    s_branch L_fail
L_red2_pB:
    ds_write_b128 v5, v[72:75]
    ds_write_b32 v6, v76
    s_branch L_red2_pw
L_red2_pA:
    ds_write_b128 v5, v[64:67]
    ds_write_b32 v6, v68
L_red2_pw:
    s_waitcnt lgkmcnt(0)
    s_barrier
    ds_read_b128 v[32:35], v2 offset:0
    ds_read_b128 v[36:39], v2 offset:1024
    ds_read_b128 v[40:43], v2 offset:2048
    ds_read_b128 v[44:47], v2 offset:3072
    ds_read_b128 v[48:51], v2 offset:4096
    s_waitcnt lgkmcnt(4)
    v_mfma_f32_16x16x32_bf16 v[52:55], v[208:211], v[32:35], 0
    v_mfma_f32_16x16x32_bf16 v[56:59], v[212:215], v[32:35], 0
    s_waitcnt lgkmcnt(3)
    v_mfma_f32_16x16x32_bf16 v[52:55], v[216:219], v[36:39], v[52:55]
    v_mfma_f32_16x16x32_bf16 v[56:59], v[220:223], v[36:39], v[56:59]
    s_waitcnt lgkmcnt(2)
    v_mfma_f32_16x16x32_bf16 v[52:55], v[224:227], v[40:43], v[52:55]
    v_mfma_f32_16x16x32_bf16 v[56:59], v[228:231], v[40:43], v[56:59]
    s_waitcnt lgkmcnt(1)
    v_mfma_f32_16x16x32_bf16 v[52:55], v[232:235], v[44:47], v[52:55]
    v_mfma_f32_16x16x32_bf16 v[56:59], v[236:239], v[44:47], v[56:59]
    s_waitcnt lgkmcnt(0)
    v_mfma_f32_16x16x32_bf16 v[52:55], v[240:243], v[48:51], v[52:55]
    v_mfma_f32_16x16x32_bf16 v[56:59], v[244:247], v[48:51], v[56:59]
    s_nop 7
    v_add_f32_dpp v80, v56, v52 row_ror:8 row_mask:0xf bank_mask:0x3
    v_add_f32_dpp v81, v57, v53 row_ror:8 row_mask:0xf bank_mask:0x3
    v_add_f32_dpp v80, v54, v58 row_ror:8 row_mask:0xf bank_mask:0xc
    v_add_f32_dpp v81, v55, v59 row_ror:8 row_mask:0xf bank_mask:0xc
    v_cvt_pk_bf16_f32 v83, v80, v81
    v_min_u32 v83, -2, v83
    buffer_store_dword v83, v9, s[4:7], s65 offen offset:0 sc1
    buffer_store_dword v83, v9, s[4:7], s65 offen offset:256 sc1
    ds_read_b128 a[0:3], v24 offset:0
    ds_read_b128 a[4:7], v24 offset:10240
    ds_read_b128 a[8:11], v24 offset:1024
    ds_read_b128 a[12:15], v24 offset:11264
    ds_read_b128 a[16:19], v24 offset:2048
    ds_read_b128 a[20:23], v24 offset:12288
    ds_read_b128 a[24:27], v24 offset:3072
    s_waitcnt lgkmcnt(6)
    v_mfma_f32_16x16x32_bf16 v[96:99], v[128:131], a[0:3], 0
    ds_read_b128 a[28:31], v24 offset:13312
    s_waitcnt lgkmcnt(6)
    v_mfma_f32_16x16x32_bf16 v[100:103], v[128:131], a[4:7], 0
    ds_read_b128 a[0:3], v24 offset:4096
    s_waitcnt lgkmcnt(6)
    v_mfma_f32_16x16x32_bf16 v[96:99], v[132:135], a[8:11], v[96:99]
    ds_read_b128 a[4:7], v24 offset:14336
    s_waitcnt lgkmcnt(6)
    v_mfma_f32_16x16x32_bf16 v[100:103], v[132:135], a[12:15], v[100:103]
    ds_read_b128 a[8:11], v24 offset:5120
    s_waitcnt lgkmcnt(6)
    v_mfma_f32_16x16x32_bf16 v[96:99], v[136:139], a[16:19], v[96:99]
    ds_read_b128 a[12:15], v24 offset:15360
    s_waitcnt lgkmcnt(6)
    v_mfma_f32_16x16x32_bf16 v[100:103], v[136:139], a[20:23], v[100:103]
    ds_read_b128 a[16:19], v24 offset:6144
    s_waitcnt lgkmcnt(6)
    v_mfma_f32_16x16x32_bf16 v[96:99], v[140:143], a[24:27], v[96:99]
    ds_read_b128 a[20:23], v24 offset:16384
    s_waitcnt lgkmcnt(6)
    v_mfma_f32_16x16x32_bf16 v[100:103], v[140:143], a[28:31], v[100:103]
    buffer_load_dword v84, v10, s[4:7], s65 offen offset:0 sc1
    buffer_load_dword v85, v11, s[4:7], s65 offen offset:0 sc1
    buffer_load_dword v86, v16, s[4:7], s65 offen offset:0 sc1
    ds_read_b128 a[24:27], v24 offset:7168
    s_waitcnt lgkmcnt(6)
    v_mfma_f32_16x16x32_bf16 v[96:99], v[144:147], a[0:3], v[96:99]
    ds_read_b128 a[28:31], v24 offset:17408
    s_waitcnt lgkmcnt(6)
    v_mfma_f32_16x16x32_bf16 v[100:103], v[144:147], a[4:7], v[100:103]
    ds_read_b128 a[0:3], v24 offset:8192
    s_waitcnt lgkmcnt(6)
    v_mfma_f32_16x16x32_bf16 v[96:99], v[148:151], a[8:11], v[96:99]
    ds_read_b128 a[4:7], v24 offset:18432
    s_waitcnt lgkmcnt(6)
    v_mfma_f32_16x16x32_bf16 v[100:103], v[148:151], a[12:15], v[100:103]
    ds_read_b128 a[8:11], v24 offset:9216
    s_waitcnt lgkmcnt(6)
    v_mfma_f32_16x16x32_bf16 v[96:99], v[152:155], a[16:19], v[96:99]
    ds_read_b128 a[12:15], v24 offset:19456
    s_waitcnt lgkmcnt(6)
    v_mfma_f32_16x16x32_bf16 v[100:103], v[152:155], a[20:23], v[100:103]
    s_waitcnt lgkmcnt(5)
    v_mfma_f32_16x16x32_bf16 v[96:99], v[156:159], a[24:27], v[96:99]
    s_waitcnt lgkmcnt(4)
    v_mfma_f32_16x16x32_bf16 v[100:103], v[156:159], a[28:31], v[100:103]
    s_waitcnt lgkmcnt(3)
    v_mfma_f32_16x16x32_bf16 v[96:99], v[160:163], a[0:3], v[96:99]
    s_waitcnt lgkmcnt(2)
    v_mfma_f32_16x16x32_bf16 v[100:103], v[160:163], a[4:7], v[100:103]
    s_waitcnt lgkmcnt(1)
    v_mfma_f32_16x16x32_bf16 v[96:99], v[164:167], a[8:11], v[96:99]
    s_waitcnt lgkmcnt(0)
    v_mfma_f32_16x16x32_bf16 v[100:103], v[164:167], a[12:15], v[100:103]
    buffer_load_dword v104, v10, s[4:7], s65 offen offset:256 sc1
    buffer_load_dword v105, v11, s[4:7], s65 offen offset:256 sc1
    buffer_load_dword v106, v16, s[4:7], s65 offen offset:256 sc1
    s_waitcnt vmcnt(3)
    v_max3_u32 v60, v84, v85, v86
    v_cmp_eq_u32 vcc, -1, v60
    s_cbranch_vccz L_red2_xok
    s_waitcnt vmcnt(0)
    v_min_u32 v84, v84, v104
    v_min_u32 v85, v85, v105
    v_min_u32 v86, v86, v106
    v_max3_u32 v60, v84, v85, v86
    v_cmp_eq_u32 vcc, -1, v60
    s_cbranch_vccz L_red2_xok
    s_branch L_red2_x
L_red2_x_r:
    s_sub_u32 s27, s27, 1
    s_cbranch_scc1 L_fail
L_red2_x:
    buffer_load_dword v84, v10, s[4:7], s65 offen offset:0 sc1
    buffer_load_dword v85, v11, s[4:7], s65 offen offset:0 sc1
    buffer_load_dword v86, v16, s[4:7], s65 offen offset:0 sc1
    s_waitcnt vmcnt(0)
    v_max3_u32 v60, v84, v85, v86
    v_cmp_eq_u32 vcc, -1, v60
    s_cbranch_vccnz L_red2_x_r
L_red2_xok:
    v_lshlrev_b32 v90, 16, v84
    v_and_b32 v91, 0xffff0000, v84
    v_lshlrev_b32 v92, 16, v85
    v_and_b32 v93, 0xffff0000, v85
    v_lshlrev_b32 v94, 16, v86
    v_and_b32 v95, 0xffff0000, v86
    v_pk_add_f32 v[80:81], v[80:81], v[90:91]
    v_pk_add_f32 v[92:93], v[92:93], v[94:95]
    v_pk_add_f32 v[80:81], v[80:81], v[92:93]
    v_cvt_pk_bf16_f32 v82, v80, v81
    v_min_u32 v82, -2, v82
    buffer_store_dword v82, v8, s[4:7], s69 offen
    s_barrier
    s_add_u32 s28, s77, 3
    s_and_b32 s28, s28, 3
    s_lshl_b32 s28, s28, 17
    s_add_u32 s28, s28, s74
    s_add_u32 m0, s30, 8192
    s_nop 0
    buffer_load_dwordx4 v23, s[4:7], s28 offen offset:0 sc1 lds
    buffer_load_dwordx4 v23, s[4:7], s28 offen offset:1024 sc1 lds
    buffer_load_dwordx4 v23, s[4:7], s28 offen offset:2048 sc1 lds
    buffer_load_dwordx4 v23, s[4:7], s28 offen offset:3072 sc1 lds
    s_add_u32 m0, s30, 12288
    s_add_u32 s28, s28, 4096
    buffer_load_dwordx4 v23, s[4:7], s28 offen sc1 lds
    s_add_u32 s64, s77, 2
    s_cmp_ge_u32 s78, s64
    s_cbranch_scc1 L_red2_u_ok
L_red2_u:
    buffer_load_dword v12, v20, s[4:7], 0 offen sc1
    s_waitcnt vmcnt(0)
    s_nop 1
    v_min_u32_dpp v12, v12, v12 row_shr:1 row_mask:0xf bank_mask:0xf
    s_nop 1
    v_min_u32_dpp v12, v12, v12 row_shr:2 row_mask:0xf bank_mask:0xf
    s_nop 1
    v_min_u32_dpp v12, v12, v12 row_shr:4 row_mask:0xf bank_mask:0xf
    s_nop 1
    v_min_u32_dpp v12, v12, v12 row_shr:8 row_mask:0xf bank_mask:0xf
    s_nop 1
    v_min_u32_dpp v12, v12, v12 row_bcast:15 row_mask:0xa bank_mask:0xf
    s_nop 1
    v_min_u32_dpp v12, v12, v12 row_bcast:31 row_mask:0xc bank_mask:0xf
    s_nop 0
    v_readlane_b32 s78, v12, 63
    s_nop 3
    s_cmp_ge_u32 s78, s64
    s_cbranch_scc1 L_red2_u_ok
    s_sub_u32 s27, s27, 1
    s_cbranch_scc1 L_fail
    s_branch L_red2_u
L_red2_u_ok:
    buffer_load_dwordx4 v[128:131], v18, s[4:7], s79 offen offset:0 sc1
    buffer_load_dwordx4 v[132:135], v18, s[4:7], s79 offen offset:1024 sc1
    buffer_load_dwordx4 v[136:139], v18, s[4:7], s79 offen offset:2048 sc1
    buffer_load_dwordx4 v[140:143], v18, s[4:7], s79 offen offset:3072 sc1
    buffer_load_dwordx4 v[144:147], v19, s[4:7], s79 offen offset:0 sc1
    buffer_load_dwordx4 v[148:151], v19, s[4:7], s79 offen offset:1024 sc1
    buffer_load_dwordx4 v[152:155], v19, s[4:7], s79 offen offset:2048 sc1
    buffer_load_dwordx4 v[156:159], v19, s[4:7], s79 offen offset:3072 sc1
    s_add_u32 s79, s79, 1310720
    buffer_store_dword v28, v8, s[4:7], s76 offen
    v_cvt_pk_bf16_f32 v116, v96, v97
    v_cvt_pk_bf16_f32 v117, v98, v99
    v_cvt_pk_bf16_f32 v118, v100, v101
    v_cvt_pk_bf16_f32 v119, v102, v103
    buffer_store_dwordx4 v[116:119], v22, s[4:7], s81 offen sc1
    s_add_u32 s81, s81, 40960
    s_sub_u32 s28, s77, 2
    s_cmp_eq_u32 s24, 0
    s_cbranch_scc0 L_red2_pub
    v_mov_b32 v12, s28
    s_mov_b64 exec, 1
    buffer_store_dword v12, v21, s[4:7], 0 offen offset:0 sc1
    s_mov_b64 exec, -1
L_red2_pub:
    s_add_u32 s67, s77, 3
    s_and_b32 s67, s67, 3
    s_lshl_b32 s67, s67, 18
    s_add_u32 s67, s67, s80
    buffer_store_dword v28, v9, s[4:7], s67 offen offset:0 sc1
    buffer_store_dword v28, v9, s[4:7], s67 offen offset:256 sc1
    s_add_u32 s77, s77, 1
    s_cmp_lt_u32 s77, 63
    s_cbranch_scc1 L_red_loop
    s_waitcnt vmcnt(0)
    s_barrier
    s_cmp_eq_u32 s24, 0
    s_cbranch_scc0 L_red_pe0
    v_mov_b32 v12, 61
    s_mov_b64 exec, 1
    buffer_store_dword v12, v21, s[4:7], 0 offen offset:0 sc1
    s_mov_b64 exec, -1
L_red_pe0:
    ds_read_b128 a[0:3], v24 offset:0
    ds_read_b128 a[4:7], v24 offset:10240
    ds_read_b128 a[8:11], v24 offset:1024
    ds_read_b128 a[12:15], v24 offset:11264
    ds_read_b128 a[16:19], v24 offset:2048
    ds_read_b128 a[20:23], v24 offset:12288
    ds_read_b128 a[24:27], v24 offset:3072
    s_waitcnt lgkmcnt(6)
    v_mfma_f32_16x16x32_bf16 v[96:99], v[168:171], a[0:3], 0
    ds_read_b128 a[28:31], v24 offset:13312
    s_waitcnt lgkmcnt(6)
    v_mfma_f32_16x16x32_bf16 v[100:103], v[168:171], a[4:7], 0
    ds_read_b128 a[0:3], v24 offset:4096
    s_waitcnt lgkmcnt(6)
    v_mfma_f32_16x16x32_bf16 v[96:99], v[172:175], a[8:11], v[96:99]
    ds_read_b128 a[4:7], v24 offset:14336
    s_waitcnt lgkmcnt(6)
    v_mfma_f32_16x16x32_bf16 v[100:103], v[172:175], a[12:15], v[100:103]
    ds_read_b128 a[8:11], v24 offset:5120
    s_waitcnt lgkmcnt(6)
    v_mfma_f32_16x16x32_bf16 v[96:99], v[176:179], a[16:19], v[96:99]
    ds_read_b128 a[12:15], v24 offset:15360
    s_waitcnt lgkmcnt(6)
    v_mfma_f32_16x16x32_bf16 v[100:103], v[176:179], a[20:23], v[100:103]
    ds_read_b128 a[16:19], v24 offset:6144
    s_waitcnt lgkmcnt(6)
    v_mfma_f32_16x16x32_bf16 v[96:99], v[180:183], a[24:27], v[96:99]
    ds_read_b128 a[20:23], v24 offset:16384
    s_waitcnt lgkmcnt(6)
    v_mfma_f32_16x16x32_bf16 v[100:103], v[180:183], a[28:31], v[100:103]
    ds_read_b128 a[24:27], v24 offset:7168
    s_waitcnt lgkmcnt(6)
    v_mfma_f32_16x16x32_bf16 v[96:99], v[184:187], a[0:3], v[96:99]
    ds_read_b128 a[28:31], v24 offset:17408
    s_waitcnt lgkmcnt(6)
    v_mfma_f32_16x16x32_bf16 v[100:103], v[184:187], a[4:7], v[100:103]
    ds_read_b128 a[0:3], v24 offset:8192
    s_waitcnt lgkmcnt(6)
    v_mfma_f32_16x16x32_bf16 v[96:99], v[188:191], a[8:11], v[96:99]
    ds_read_b128 a[4:7], v24 offset:18432
    s_waitcnt lgkmcnt(6)
    v_mfma_f32_16x16x32_bf16 v[100:103], v[188:191], a[12:15], v[100:103]
    ds_read_b128 a[8:11], v24 offset:9216
    s_waitcnt lgkmcnt(6)
    v_mfma_f32_16x16x32_bf16 v[96:99], v[192:195], a[16:19], v[96:99]
    ds_read_b128 a[12:15], v24 offset:19456
    s_waitcnt lgkmcnt(6)
    v_mfma_f32_16x16x32_bf16 v[100:103], v[192:195], a[20:23], v[100:103]
    s_waitcnt lgkmcnt(5)
    v_mfma_f32_16x16x32_bf16 v[96:99], v[196:199], a[24:27], v[96:99]
    s_waitcnt lgkmcnt(4)
    v_mfma_f32_16x16x32_bf16 v[100:103], v[196:199], a[28:31], v[100:103]
    s_waitcnt lgkmcnt(3)
    v_mfma_f32_16x16x32_bf16 v[96:99], v[200:203], a[0:3], v[96:99]
    s_waitcnt lgkmcnt(2)
    v_mfma_f32_16x16x32_bf16 v[100:103], v[200:203], a[4:7], v[100:103]
    s_waitcnt lgkmcnt(1)
    v_mfma_f32_16x16x32_bf16 v[96:99], v[204:207], a[8:11], v[96:99]
    s_waitcnt lgkmcnt(0)
    v_mfma_f32_16x16x32_bf16 v[100:103], v[204:207], a[12:15], v[100:103]
    s_nop 7
    v_cvt_pk_bf16_f32 v116, v96, v97
    v_cvt_pk_bf16_f32 v117, v98, v99
    v_cvt_pk_bf16_f32 v118, v100, v101
    v_cvt_pk_bf16_f32 v119, v102, v103
    buffer_store_dwordx4 v[116:119], v22, s[4:7], s81 offen sc1
    s_add_u32 s81, s81, 40960
    s_and_b32 s28, s77, 3
    s_lshl_b32 s28, s28, 17
    s_add_u32 s76, s74, s28
    buffer_load_dwordx4 v[64:67], v3, s[4:7], s76 offen sc1
    buffer_load_dword v68, v4, s[4:7], s76 offen sc1
L_rede0_um:
    buffer_load_dwordx4 v[160:163], v7, s[4:7], s76 offen sc1
    buffer_load_dwordx4 v[164:167], v7, s[4:7], s76 offen offset:1024 sc1
    buffer_load_dwordx4 v[72:75], v3, s[4:7], s76 offen sc1
    buffer_load_dword v76, v4, s[4:7], s76 offen sc1
    s_waitcnt vmcnt(4)
    v_max3_u32 v60, v64, v65, v66
    v_max_u32 v61, v67, v68
    v_max_u32 v62, v60, v61
    v_cmp_eq_u32 vcc, -1, v62
    s_cbranch_vccz L_rede0_pUA
    buffer_load_dwordx4 v[64:67], v3, s[4:7], s76 offen sc1
    buffer_load_dword v68, v4, s[4:7], s76 offen sc1
    s_waitcnt vmcnt(2)
    v_max3_u32 v60, v72, v73, v74
    v_max_u32 v61, v75, v76
    v_max_u32 v62, v60, v61
    v_cmp_eq_u32 vcc, -1, v62
    s_cbranch_vccz L_rede0_pUB
    v_max3_u32 v60, v160, v161, v162
    v_max3_u32 v61, v163, v164, v165
    v_max_u32 v62, v166, v167
    v_max3_u32 v63, v60, v61, v62
    v_cmp_eq_u32 vcc, -1, v63
    s_cbranch_vccz L_rede0_pp
    s_sub_u32 s27, s27, 1
    s_cbranch_scc0 L_rede0_um
    s_branch L_fail
L_rede0_pp:
    buffer_load_dwordx4 v[72:75], v3, s[4:7], s76 offen sc1
    buffer_load_dword v76, v4, s[4:7], s76 offen sc1
    s_waitcnt vmcnt(2)
    v_max3_u32 v60, v64, v65, v66
    v_max_u32 v61, v67, v68
    v_max_u32 v62, v60, v61
    v_cmp_eq_u32 vcc, -1, v62
    s_cbranch_vccz L_rede0_pA
    buffer_load_dwordx4 v[64:67], v3, s[4:7], s76 offen sc1
    buffer_load_dword v68, v4, s[4:7], s76 offen sc1
    s_waitcnt vmcnt(2)
    v_max3_u32 v60, v72, v73, v74
    v_max_u32 v61, v75, v76
    v_max_u32 v62, v60, v61
    v_cmp_eq_u32 vcc, -1, v62
    s_cbranch_vccz L_rede0_pB
    s_sub_u32 s27, s27, 1
    s_cbranch_scc0 L_rede0_pp
    s_branch L_fail
L_rede0_pB:
    ds_write_b128 v5, v[72:75]
    ds_write_b32 v6, v76
    s_branch L_rede0_pw
L_rede0_pA:
    ds_write_b128 v5, v[64:67]
    ds_write_b32 v6, v68
L_rede0_pw:
    s_waitcnt lgkmcnt(0)
    s_barrier
    s_add_u32 s28, s77, 3
    s_and_b32 s28, s28, 3
    s_lshl_b32 s28, s28, 17
    s_add_u32 s28, s28, s74
    s_add_u32 m0, s30, 8192
    s_nop 0
    buffer_load_dwordx4 v23, s[4:7], s28 offen offset:0 sc1 lds
    buffer_load_dwordx4 v23, s[4:7], s28 offen offset:1024 sc1 lds
    buffer_load_dwordx4 v23, s[4:7], s28 offen offset:2048 sc1 lds
    buffer_load_dwordx4 v23, s[4:7], s28 offen offset:3072 sc1 lds
    s_add_u32 m0, s30, 12288
    s_add_u32 s28, s28, 4096
    buffer_load_dwordx4 v23, s[4:7], s28 offen sc1 lds
    s_waitcnt vmcnt(0)
    s_barrier
    s_cmp_eq_u32 s24, 0
    s_cbranch_scc0 L_red_pe1
    v_mov_b32 v12, 62
    s_mov_b64 exec, 1
    buffer_store_dword v12, v21, s[4:7], 0 offen offset:0 sc1
    s_mov_b64 exec, -1
L_red_pe1:
    ds_read_b128 a[0:3], v24 offset:0
    ds_read_b128 a[4:7], v24 offset:10240
    ds_read_b128 a[8:11], v24 offset:1024
    ds_read_b128 a[12:15], v24 offset:11264
    ds_read_b128 a[16:19], v24 offset:2048
    ds_read_b128 a[20:23], v24 offset:12288
    ds_read_b128 a[24:27], v24 offset:3072
    s_waitcnt lgkmcnt(6)
    v_mfma_f32_16x16x32_bf16 v[96:99], v[208:211], a[0:3], 0
    ds_read_b128 a[28:31], v24 offset:13312
    s_waitcnt lgkmcnt(6)
    v_mfma_f32_16x16x32_bf16 v[100:103], v[208:211], a[4:7], 0
    ds_read_b128 a[0:3], v24 offset:4096
    s_waitcnt lgkmcnt(6)
    v_mfma_f32_16x16x32_bf16 v[96:99], v[212:215], a[8:11], v[96:99]
    ds_read_b128 a[4:7], v24 offset:14336
    s_waitcnt lgkmcnt(6)
    v_mfma_f32_16x16x32_bf16 v[100:103], v[212:215], a[12:15], v[100:103]
    ds_read_b128 a[8:11], v24 offset:5120
    s_waitcnt lgkmcnt(6)
    v_mfma_f32_16x16x32_bf16 v[96:99], v[216:219], a[16:19], v[96:99]
    ds_read_b128 a[12:15], v24 offset:15360
    s_waitcnt lgkmcnt(6)
    v_mfma_f32_16x16x32_bf16 v[100:103], v[216:219], a[20:23], v[100:103]
    ds_read_b128 a[16:19], v24 offset:6144
    s_waitcnt lgkmcnt(6)
    v_mfma_f32_16x16x32_bf16 v[96:99], v[220:223], a[24:27], v[96:99]
    ds_read_b128 a[20:23], v24 offset:16384
    s_waitcnt lgkmcnt(6)
    v_mfma_f32_16x16x32_bf16 v[100:103], v[220:223], a[28:31], v[100:103]
    ds_read_b128 a[24:27], v24 offset:7168
    s_waitcnt lgkmcnt(6)
    v_mfma_f32_16x16x32_bf16 v[96:99], v[224:227], a[0:3], v[96:99]
    ds_read_b128 a[28:31], v24 offset:17408
    s_waitcnt lgkmcnt(6)
    v_mfma_f32_16x16x32_bf16 v[100:103], v[224:227], a[4:7], v[100:103]
    ds_read_b128 a[0:3], v24 offset:8192
    s_waitcnt lgkmcnt(6)
    v_mfma_f32_16x16x32_bf16 v[96:99], v[228:231], a[8:11], v[96:99]
    ds_read_b128 a[4:7], v24 offset:18432
    s_waitcnt lgkmcnt(6)
    v_mfma_f32_16x16x32_bf16 v[100:103], v[228:231], a[12:15], v[100:103]
    ds_read_b128 a[8:11], v24 offset:9216
    s_waitcnt lgkmcnt(6)
    v_mfma_f32_16x16x32_bf16 v[96:99], v[232:235], a[16:19], v[96:99]
    ds_read_b128 a[12:15], v24 offset:19456
    s_waitcnt lgkmcnt(6)
    v_mfma_f32_16x16x32_bf16 v[100:103], v[232:235], a[20:23], v[100:103]
    s_waitcnt lgkmcnt(5)
    v_mfma_f32_16x16x32_bf16 v[96:99], v[236:239], a[24:27], v[96:99]
    s_waitcnt lgkmcnt(4)
    v_mfma_f32_16x16x32_bf16 v[100:103], v[236:239], a[28:31], v[100:103]
    s_waitcnt lgkmcnt(3)
    v_mfma_f32_16x16x32_bf16 v[96:99], v[240:243], a[0:3], v[96:99]
    s_waitcnt lgkmcnt(2)
    v_mfma_f32_16x16x32_bf16 v[100:103], v[240:243], a[4:7], v[100:103]
    s_waitcnt lgkmcnt(1)
    v_mfma_f32_16x16x32_bf16 v[96:99], v[244:247], a[8:11], v[96:99]
    s_waitcnt lgkmcnt(0)
    v_mfma_f32_16x16x32_bf16 v[100:103], v[244:247], a[12:15], v[100:103]
    s_nop 7
    v_cvt_pk_bf16_f32 v116, v96, v97
    v_cvt_pk_bf16_f32 v117, v98, v99
    v_cvt_pk_bf16_f32 v118, v100, v101
    v_cvt_pk_bf16_f32 v119, v102, v103
    buffer_store_dwordx4 v[116:119], v22, s[4:7], s81 offen sc1
    s_add_u32 s81, s81, 40960
    s_mov_b32 s77, 64
    s_and_b32 s28, s77, 3
    s_lshl_b32 s28, s28, 17
    s_add_u32 s76, s74, s28
    buffer_load_dwordx4 v[64:67], v3, s[4:7], s76 offen sc1
    buffer_load_dword v68, v4, s[4:7], s76 offen sc1
L_rede1_pp:
    buffer_load_dwordx4 v[72:75], v3, s[4:7], s76 offen sc1
    buffer_load_dword v76, v4, s[4:7], s76 offen sc1
    s_waitcnt vmcnt(2)
    v_max3_u32 v60, v64, v65, v66
    v_max_u32 v61, v67, v68
    v_max_u32 v62, v60, v61
    v_cmp_eq_u32 vcc, -1, v62
    s_cbranch_vccz L_rede1_pA
    buffer_load_dwordx4 v[64:67], v3, s[4:7], s76 offen sc1
    buffer_load_dword v68, v4, s[4:7], s76 offen sc1
    s_waitcnt vmcnt(2)
    v_max3_u32 v60, v72, v73, v74
    v_max_u32 v61, v75, v76
    v_max_u32 v62, v60, v61
    v_cmp_eq_u32 vcc, -1, v62
    s_cbranch_vccz L_rede1_pB
    s_sub_u32 s27, s27, 1
    s_cbranch_scc0 L_rede1_pp
    s_branch L_fail
L_rede1_pB:
    ds_write_b128 v5, v[72:75]
    ds_write_b32 v6, v76
    s_branch L_rede1_pw
L_rede1_pA:
    ds_write_b128 v5, v[64:67]
    ds_write_b32 v6, v68
L_rede1_pw:
    s_waitcnt lgkmcnt(0)
    s_barrier
    s_add_u32 s28, s77, 3
    s_and_b32 s28, s28, 3
    s_lshl_b32 s28, s28, 17
    s_add_u32 s28, s28, s74
    s_add_u32 m0, s30, 8192
    s_nop 0
    buffer_load_dwordx4 v23, s[4:7], s28 offen offset:0 sc1 lds
    buffer_load_dwordx4 v23, s[4:7], s28 offen offset:1024 sc1 lds
    buffer_load_dwordx4 v23, s[4:7], s28 offen offset:2048 sc1 lds
    buffer_load_dwordx4 v23, s[4:7], s28 offen offset:3072 sc1 lds
    s_add_u32 m0, s30, 12288
    s_add_u32 s28, s28, 4096
    buffer_load_dwordx4 v23, s[4:7], s28 offen sc1 lds
    s_waitcnt vmcnt(0)
    s_barrier
    s_cmp_eq_u32 s24, 0
    s_cbranch_scc0 L_red_pe2
    v_mov_b32 v12, 63
    s_mov_b64 exec, 1
    buffer_store_dword v12, v21, s[4:7], 0 offen offset:0 sc1
    s_mov_b64 exec, -1
L_red_pe2:
    ds_read_b128 a[0:3], v24 offset:0
    ds_read_b128 a[4:7], v24 offset:10240
    ds_read_b128 a[8:11], v24 offset:1024
    ds_read_b128 a[12:15], v24 offset:11264
    ds_read_b128 a[16:19], v24 offset:2048
    ds_read_b128 a[20:23], v24 offset:12288
    ds_read_b128 a[24:27], v24 offset:3072
    s_waitcnt lgkmcnt(6)
    v_mfma_f32_16x16x32_bf16 v[96:99], v[128:131], a[0:3], 0
    ds_read_b128 a[28:31], v24 offset:13312
    s_waitcnt lgkmcnt(6)
    v_mfma_f32_16x16x32_bf16 v[100:103], v[128:131], a[4:7], 0
    ds_read_b128 a[0:3], v24 offset:4096
    s_waitcnt lgkmcnt(6)
    v_mfma_f32_16x16x32_bf16 v[96:99], v[132:135], a[8:11], v[96:99]
    ds_read_b128 a[4:7], v24 offset:14336
    s_waitcnt lgkmcnt(6)
    v_mfma_f32_16x16x32_bf16 v[100:103], v[132:135], a[12:15], v[100:103]
    ds_read_b128 a[8:11], v24 offset:5120
    s_waitcnt lgkmcnt(6)
    v_mfma_f32_16x16x32_bf16 v[96:99], v[136:139], a[16:19], v[96:99]
    ds_read_b128 a[12:15], v24 offset:15360
    s_waitcnt lgkmcnt(6)
    v_mfma_f32_16x16x32_bf16 v[100:103], v[136:139], a[20:23], v[100:103]
    ds_read_b128 a[16:19], v24 offset:6144
    s_waitcnt lgkmcnt(6)
    v_mfma_f32_16x16x32_bf16 v[96:99], v[140:143], a[24:27], v[96:99]
    ds_read_b128 a[20:23], v24 offset:16384
    s_waitcnt lgkmcnt(6)
    v_mfma_f32_16x16x32_bf16 v[100:103], v[140:143], a[28:31], v[100:103]
    ds_read_b128 a[24:27], v24 offset:7168
    s_waitcnt lgkmcnt(6)
    v_mfma_f32_16x16x32_bf16 v[96:99], v[144:147], a[0:3], v[96:99]
    ds_read_b128 a[28:31], v24 offset:17408
    s_waitcnt lgkmcnt(6)
    v_mfma_f32_16x16x32_bf16 v[100:103], v[144:147], a[4:7], v[100:103]
    ds_read_b128 a[0:3], v24 offset:8192
    s_waitcnt lgkmcnt(6)
    v_mfma_f32_16x16x32_bf16 v[96:99], v[148:151], a[8:11], v[96:99]
    ds_read_b128 a[4:7], v24 offset:18432
    s_waitcnt lgkmcnt(6)
    v_mfma_f32_16x16x32_bf16 v[100:103], v[148:151], a[12:15], v[100:103]
    ds_read_b128 a[8:11], v24 offset:9216
    s_waitcnt lgkmcnt(6)
    v_mfma_f32_16x16x32_bf16 v[96:99], v[152:155], a[16:19], v[96:99]
    ds_read_b128 a[12:15], v24 offset:19456
    s_waitcnt lgkmcnt(6)
    v_mfma_f32_16x16x32_bf16 v[100:103], v[152:155], a[20:23], v[100:103]
    s_waitcnt lgkmcnt(5)
    v_mfma_f32_16x16x32_bf16 v[96:99], v[156:159], a[24:27], v[96:99]
    s_waitcnt lgkmcnt(4)
    v_mfma_f32_16x16x32_bf16 v[100:103], v[156:159], a[28:31], v[100:103]
    s_waitcnt lgkmcnt(3)
    v_mfma_f32_16x16x32_bf16 v[96:99], v[160:163], a[0:3], v[96:99]
    s_waitcnt lgkmcnt(2)
    v_mfma_f32_16x16x32_bf16 v[100:103], v[160:163], a[4:7], v[100:103]
    s_waitcnt lgkmcnt(1)
    v_mfma_f32_16x16x32_bf16 v[96:99], v[164:167], a[8:11], v[96:99]
    s_waitcnt lgkmcnt(0)
    v_mfma_f32_16x16x32_bf16 v[100:103], v[164:167], a[12:15], v[100:103]
    s_nop 7
    v_cvt_pk_bf16_f32 v116, v96, v97
    v_cvt_pk_bf16_f32 v117, v98, v99
    v_cvt_pk_bf16_f32 v118, v100, v101
    v_cvt_pk_bf16_f32 v119, v102, v103
    buffer_store_dwordx4 v[116:119], v22, s[4:7], s81 offen sc1
    s_add_u32 s81, s81, 40960
    s_waitcnt vmcnt(0)
    s_barrier
    s_cmp_eq_u32 s24, 0
    s_cbranch_scc0 L_red_pubend
    v_mov_b32 v12, 64
    s_mov_b64 exec, 1
    buffer_store_dword v12, v21, s[4:7], 0 offen offset:0 sc1
    s_mov_b64 exec, -1
L_red_pubend:
    s_waitcnt vmcnt(0)
    s_endpgm
L_red0_pUB:
    ds_write_b128 v5, v[72:75]
    ds_write_b32 v6, v76
    s_branch L_red0_pU
L_red0_pUA:
    ds_write_b128 v5, v[64:67]
    ds_write_b32 v6, v68
    s_waitcnt vmcnt(2)
L_red0_pU:
    v_max3_u32 v60, v160, v161, v162
    v_max3_u32 v61, v163, v164, v165
    v_max_u32 v62, v166, v167
    v_max3_u32 v63, v60, v61, v62
    v_cmp_eq_u32 vcc, -1, v63
    s_cbranch_vccz L_red0_pw
    s_branch L_red0_umf
L_red0_umf_r:
    s_sub_u32 s27, s27, 1
    s_cbranch_scc1 L_fail
L_red0_umf:
    buffer_load_dwordx4 v[160:163], v7, s[4:7], s76 offen sc1
    buffer_load_dwordx4 v[164:167], v7, s[4:7], s76 offen offset:1024 sc1
    s_waitcnt vmcnt(0)
    v_max3_u32 v60, v160, v161, v162
    v_max3_u32 v61, v163, v164, v165
    v_max_u32 v62, v166, v167
    v_max3_u32 v63, v60, v61, v62
    v_cmp_eq_u32 vcc, -1, v63
    s_cbranch_vccnz L_red0_umf_r
    s_branch L_red0_pw
L_red1_pUB:
    ds_write_b128 v5, v[72:75]
    ds_write_b32 v6, v76
    s_branch L_red1_pU
L_red1_pUA:
    ds_write_b128 v5, v[64:67]
    ds_write_b32 v6, v68
    s_waitcnt vmcnt(2)
L_red1_pU:
    v_max3_u32 v60, v200, v201, v202
    v_max3_u32 v61, v203, v204, v205
    v_max_u32 v62, v206, v207
    v_max3_u32 v63, v60, v61, v62
    v_cmp_eq_u32 vcc, -1, v63
    s_cbranch_vccz L_red1_pw
    s_branch L_red1_umf
L_red1_umf_r:
    s_sub_u32 s27, s27, 1
    s_cbranch_scc1 L_fail
L_red1_umf:
    buffer_load_dwordx4 v[200:203], v7, s[4:7], s76 offen sc1
    buffer_load_dwordx4 v[204:207], v7, s[4:7], s76 offen offset:1024 sc1
    s_waitcnt vmcnt(0)
    v_max3_u32 v60, v200, v201, v202
    v_max3_u32 v61, v203, v204, v205
    v_max_u32 v62, v206, v207
    v_max3_u32 v63, v60, v61, v62
    v_cmp_eq_u32 vcc, -1, v63
    s_cbranch_vccnz L_red1_umf_r
    s_branch L_red1_pw
L_red2_pUB:
    ds_write_b128 v5, v[72:75]
    ds_write_b32 v6, v76
    s_branch L_red2_pU
L_red2_pUA:
    ds_write_b128 v5, v[64:67]
    ds_write_b32 v6, v68
    s_waitcnt vmcnt(2)
L_red2_pU:
    v_max3_u32 v60, v240, v241, v242
    v_max3_u32 v61, v243, v244, v245
    v_max_u32 v62, v246, v247
    v_max3_u32 v63, v60, v61, v62
    v_cmp_eq_u32 vcc, -1, v63
    s_cbranch_vccz L_red2_pw
    s_branch L_red2_umf
L_red2_umf_r:
    s_sub_u32 s27, s27, 1
    s_cbranch_scc1 L_fail
L_red2_umf:
    buffer_load_dwordx4 v[240:243], v7, s[4:7], s76 offen sc1
    buffer_load_dwordx4 v[244:247], v7, s[4:7], s76 offen offset:1024 sc1
    s_waitcnt vmcnt(0)
    v_max3_u32 v60, v240, v241, v242
    v_max3_u32 v61, v243, v244, v245
    v_max_u32 v62, v246, v247
    v_max3_u32 v63, v60, v61, v62
    v_cmp_eq_u32 vcc, -1, v63
    s_cbranch_vccnz L_red2_umf_r
    s_branch L_red2_pw
L_rede0_pUB:
    ds_write_b128 v5, v[72:75]
    ds_write_b32 v6, v76
    s_branch L_rede0_pU
L_rede0_pUA:
    ds_write_b128 v5, v[64:67]
    ds_write_b32 v6, v68
    s_waitcnt vmcnt(2)
L_rede0_pU:
    v_max3_u32 v60, v160, v161, v162
    v_max3_u32 v61, v163, v164, v165
    v_max_u32 v62, v166, v167
    v_max3_u32 v63, v60, v61, v62
    v_cmp_eq_u32 vcc, -1, v63
    s_cbranch_vccz L_rede0_pw
    s_branch L_rede0_umf
L_rede0_umf_r:
    s_sub_u32 s27, s27, 1
    s_cbranch_scc1 L_fail
L_rede0_umf:
    buffer_load_dwordx4 v[160:163], v7, s[4:7], s76 offen sc1
    buffer_load_dwordx4 v[164:167], v7, s[4:7], s76 offen offset:1024 sc1
    s_waitcnt vmcnt(0)
    v_max3_u32 v60, v160, v161, v162
    v_max3_u32 v61, v163, v164, v165
    v_max_u32 v62, v166, v167
    v_max3_u32 v63, v60, v61, v62
    v_cmp_eq_u32 vcc, -1, v63
    s_cbranch_vccnz L_rede0_umf_r
    s_branch L_rede0_pw
L_sum:
    s_mov_b32 s12, s68
    s_mov_b32 s13, s69
    s_mov_b32 s14, 10485760
    s_mov_b32 s15, 0x20000
    v_and_b32 v3, 3, v1
    v_mul_u32_u24 v3, 10, v3
    v_add_u32 v3, s75, v3
    v_lshlrev_b32 v3, 7, v3
    v_add_u32 v3, 192427008, v3
    s_lshl_b32 s28, s75, 2
    s_add_u32 s28, s28, s24
    s_lshl_b32 s29, s28, 10
    s_add_u32 s29, s29, 159383552
    v_add_u32 v4, s29, v2
    v_add_u32 v5, 2621440, v4
    v_add_u32 v6, 2621440, v5
    v_add_u32 v7, 2621440, v6
    v_and_b32 v8, 15, v1
    v_mul_u32_u24 v8, 5120, v8
    v_lshrrev_b32 v9, 4, v1
    v_lshl_add_u32 v8, v9, 4, v8
    s_lshl_b32 s28, s28, 6
    v_add_u32 v8, s28, v8
    v_add_u32 v9, 81920, v8
    s_mov_b32 s78, 0
    s_mul_i32 s79, s77, 40960
    s_mul_i32 s80, s77, 163840
L_sum_loop:
    s_add_u32 s64, s77, 1
    s_cmp_ge_u32 s77, 62
    s_cbranch_scc1 L_sum_fast
    s_cmp_ge_u32 s78, s64
    s_cbranch_scc1 L_sum_w_ok
L_sum_w:
    buffer_load_dword v12, v3, s[4:7], 0 offen sc1
    s_waitcnt vmcnt(0)
    s_nop 1
    v_min_u32_dpp v12, v12, v12 row_shr:1 row_mask:0xf bank_mask:0xf
    s_nop 1
    v_min_u32_dpp v12, v12, v12 row_shr:2 row_mask:0xf bank_mask:0xf
    s_nop 1
    v_min_u32_dpp v12, v12, v12 row_shr:4 row_mask:0xf bank_mask:0xf
    s_nop 1
    v_min_u32_dpp v12, v12, v12 row_shr:8 row_mask:0xf bank_mask:0xf
    s_nop 1
    v_min_u32_dpp v12, v12, v12 row_bcast:15 row_mask:0xa bank_mask:0xf
    s_nop 1
    v_min_u32_dpp v12, v12, v12 row_bcast:31 row_mask:0xc bank_mask:0xf
    s_nop 0
    v_readlane_b32 s78, v12, 63
    s_nop 3
    s_cmp_ge_u32 s78, s64
    s_cbranch_scc1 L_sum_w_ok
    s_sleep 32
    s_sub_u32 s27, s27, 1
    s_cbranch_scc1 L_fail
    s_branch L_sum_w
L_sum_w_ok:
L_sum_fast:
    s_cmp_ge_u32 s78, s64
    s_cbranch_scc1 L_sum_wf_ok
L_sum_wf:
    buffer_load_dword v12, v3, s[4:7], 0 offen sc1
    s_waitcnt vmcnt(0)
    s_nop 1
    v_min_u32_dpp v12, v12, v12 row_shr:1 row_mask:0xf bank_mask:0xf
    s_nop 1
    v_min_u32_dpp v12, v12, v12 row_shr:2 row_mask:0xf bank_mask:0xf
    s_nop 1
    v_min_u32_dpp v12, v12, v12 row_shr:4 row_mask:0xf bank_mask:0xf
    s_nop 1
    v_min_u32_dpp v12, v12, v12 row_shr:8 row_mask:0xf bank_mask:0xf
    s_nop 1
    v_min_u32_dpp v12, v12, v12 row_bcast:15 row_mask:0xa bank_mask:0xf
    s_nop 1
    v_min_u32_dpp v12, v12, v12 row_bcast:31 row_mask:0xc bank_mask:0xf
    s_nop 0
    v_readlane_b32 s78, v12, 63
    s_nop 3
    s_cmp_ge_u32 s78, s64
    s_cbranch_scc1 L_sum_wf_ok
    s_sleep 2
    s_sub_u32 s27, s27, 1
    s_cbranch_scc1 L_fail
    s_branch L_sum_wf
L_sum_wf_ok:
    buffer_load_dwordx4 v[48:51], v4, s[4:7], s79 offen sc1
    buffer_load_dwordx4 v[52:55], v5, s[4:7], s79 offen sc1
    buffer_load_dwordx4 v[56:59], v6, s[4:7], s79 offen sc1
    buffer_load_dwordx4 v[60:63], v7, s[4:7], s79 offen sc1
    s_waitcnt vmcnt(0)
    v_lshlrev_b32 v16, 16, v48
    v_and_b32 v17, 0xffff0000, v48
    v_lshlrev_b32 v18, 16, v49
    v_and_b32 v19, 0xffff0000, v49
    v_lshlrev_b32 v20, 16, v50
    v_and_b32 v21, 0xffff0000, v50
    v_lshlrev_b32 v22, 16, v51
    v_and_b32 v23, 0xffff0000, v51
    v_lshlrev_b32 v24, 16, v52
    v_and_b32 v25, 0xffff0000, v52
    v_lshlrev_b32 v26, 16, v53
    v_and_b32 v27, 0xffff0000, v53
    v_lshlrev_b32 v28, 16, v54
    v_and_b32 v29, 0xffff0000, v54
    v_lshlrev_b32 v30, 16, v55
    v_and_b32 v31, 0xffff0000, v55
    v_lshlrev_b32 v32, 16, v56
    v_and_b32 v33, 0xffff0000, v56
    v_lshlrev_b32 v34, 16, v57
    v_and_b32 v35, 0xffff0000, v57
    v_lshlrev_b32 v36, 16, v58
    v_and_b32 v37, 0xffff0000, v58
    v_lshlrev_b32 v38, 16, v59
    v_and_b32 v39, 0xffff0000, v59
    v_lshlrev_b32 v40, 16, v60
    v_and_b32 v41, 0xffff0000, v60
    v_lshlrev_b32 v42, 16, v61
    v_and_b32 v43, 0xffff0000, v61
    v_lshlrev_b32 v44, 16, v62
    v_and_b32 v45, 0xffff0000, v62
    v_lshlrev_b32 v46, 16, v63
    v_and_b32 v47, 0xffff0000, v63
    v_add_f32 v16, v16, v24
    v_add_f32 v32, v32, v40
    v_add_f32 v16, v16, v32
    v_add_f32 v17, v17, v25
    v_add_f32 v33, v33, v41
    v_add_f32 v17, v17, v33
    v_add_f32 v18, v18, v26
    v_add_f32 v34, v34, v42
    v_add_f32 v18, v18, v34
    v_add_f32 v19, v19, v27
    v_add_f32 v35, v35, v43
    v_add_f32 v19, v19, v35
    v_add_f32 v20, v20, v28
    v_add_f32 v36, v36, v44
    v_add_f32 v20, v20, v36
    v_add_f32 v21, v21, v29
    v_add_f32 v37, v37, v45
    v_add_f32 v21, v21, v37
    v_add_f32 v22, v22, v30
    v_add_f32 v38, v38, v46
    v_add_f32 v22, v22, v38
    v_add_f32 v23, v23, v31
    v_add_f32 v39, v39, v47
    v_add_f32 v23, v23, v39
    v_cvt_pk_bf16_f32 v24, v16, v17
    v_cvt_pk_bf16_f32 v25, v18, v19
    v_cvt_pk_bf16_f32 v26, v20, v21
    v_cvt_pk_bf16_f32 v27, v22, v23
    v_lshlrev_b32 v16, 16, v24
    v_and_b32 v17, 0xffff0000, v24
    v_lshlrev_b32 v18, 16, v25
    v_and_b32 v19, 0xffff0000, v25
    v_lshlrev_b32 v20, 16, v26
    v_and_b32 v21, 0xffff0000, v26
    v_lshlrev_b32 v22, 16, v27
    v_and_b32 v23, 0xffff0000, v27
    buffer_store_dwordx4 v[16:19], v8, s[12:15], s80 offen
    buffer_store_dwordx4 v[20:23], v9, s[12:15], s80 offen
    s_add_u32 s79, s79, 163840
    s_add_u32 s80, s80, 655360
    s_add_u32 s77, s77, 4
    s_cmp_lt_u32 s77, 64
    s_cbranch_scc1 L_sum_loop
    s_waitcnt vmcnt(0)
    s_endpgm
L_ssm:
    v_and_b32 v4, 3, v1
    v_lshlrev_b32 v4, 2, v4
    v_bfe_u32 v5, v1, 2, 1
    v_lshl_add_u32 v4, v5, 7, v4
    v_cmp_lt_u32 vcc, 7, v1
    v_mov_b32 v5, 16
    s_nop 0
    v_cndmask_b32 v4, v4, v5, vcc
L_ssm_go_s:
    buffer_load_dword v5, v4, s[8:11], 0 offen sc1
    s_waitcnt vmcnt(0)
    v_cmp_gt_u32 vcc, 32, v5
    v_readlane_b32 s28, v5, 8
    s_cbranch_vccnz L_ssm_go_s_no
    s_cmp_ge_u32 s28, 64
    s_cbranch_scc1 L_ssm_go_s_ok
L_ssm_go_s_no:
    s_sleep 4
    s_sub_u32 s27, s27, 1
    s_cbranch_scc1 L_fail
    s_branch L_ssm_go_s
L_ssm_go_s_ok:
    s_and_b32 s28, s26, 3
    s_mul_i32 s28, s28, 768
    s_add_u32 s28, s28, 192413700
    v_mov_b32 v4, s28
L_ssm_go:
    buffer_load_dword v5, v4, s[4:7], 0 offen sc1
    s_waitcnt vmcnt(0)
    v_cmp_eq_u32 vcc, 0, v5
    s_cbranch_vccz L_ssm_go_ok
    s_sleep 8
    s_sub_u32 s27, s27, 1
    s_cbranch_scc1 L_fail
    s_branch L_ssm_go
L_ssm_go_ok:
    s_sub_u32 s75, s25, 26
    s_lshl_b32 s75, s75, 2
    s_add_u32 s75, s75, s26
    s_cmp_lt_u32 s75, 10
    s_cbranch_scc1 L_b1
    s_sub_u32 s75, s75, 10
    s_branch L_b2
L_b1:
    s_mov_b32 s12, s56
    s_mov_b32 s13, s57
    s_mov_b32 s14, 819200
    s_mov_b32 s15, 0x20000
    s_mov_b32 s20, s58
    s_mov_b32 s21, s59
    s_mov_b32 s22, 819200
    s_mov_b32 s23, 0x20000
    s_mov_b32 s16, s50
    s_mov_b32 s17, s51
    s_mov_b32 s18, 2621440
    s_mov_b32 s19, 0x20000
    s_lshl_b32 s74, s75, 6
    s_lshr_b32 s28, s24, 1
    s_lshl_b32 s28, s28, 5
    s_add_u32 s74, s74, s28
    s_and_b32 s28, s24, 1
    s_lshl_b32 s28, s28, 2
    s_add_u32 s74, s74, s28
    v_bfe_u32 v3, v1, 2, 2
    v_lshlrev_b32 v3, 3, v3
    v_and_b32 v4, 3, v1
    v_add_u32 v3, v3, v4
    v_add_u32 v3, s74, v3
    v_mul_u32_u24 v3, 1280, v3
    v_lshrrev_b32 v4, 4, v1
    v_lshl_add_u32 v3, v4, 4, v3
    buffer_load_dwordx4 a[0:3], v3, s[12:15], 0 offen offset:0
    buffer_load_dwordx4 a[80:83], v3, s[20:23], 0 offen offset:0
    buffer_load_dwordx4 a[4:7], v3, s[12:15], 0 offen offset:64
    buffer_load_dwordx4 a[84:87], v3, s[20:23], 0 offen offset:64
    buffer_load_dwordx4 a[8:11], v3, s[12:15], 0 offen offset:128
    buffer_load_dwordx4 a[88:91], v3, s[20:23], 0 offen offset:128
    buffer_load_dwordx4 a[12:15], v3, s[12:15], 0 offen offset:192
    buffer_load_dwordx4 a[92:95], v3, s[20:23], 0 offen offset:192
    buffer_load_dwordx4 a[16:19], v3, s[12:15], 0 offen offset:256
    buffer_load_dwordx4 a[96:99], v3, s[20:23], 0 offen offset:256
    buffer_load_dwordx4 a[20:23], v3, s[12:15], 0 offen offset:320
    buffer_load_dwordx4 a[100:103], v3, s[20:23], 0 offen offset:320
    buffer_load_dwordx4 a[24:27], v3, s[12:15], 0 offen offset:384
    buffer_load_dwordx4 a[104:107], v3, s[20:23], 0 offen offset:384
    buffer_load_dwordx4 a[28:31], v3, s[12:15], 0 offen offset:448
    buffer_load_dwordx4 a[108:111], v3, s[20:23], 0 offen offset:448
    buffer_load_dwordx4 a[32:35], v3, s[12:15], 0 offen offset:512
    buffer_load_dwordx4 a[112:115], v3, s[20:23], 0 offen offset:512
    buffer_load_dwordx4 a[36:39], v3, s[12:15], 0 offen offset:576
    buffer_load_dwordx4 a[116:119], v3, s[20:23], 0 offen offset:576
    buffer_load_dwordx4 a[40:43], v3, s[12:15], 0 offen offset:640
    buffer_load_dwordx4 a[120:123], v3, s[20:23], 0 offen offset:640
    buffer_load_dwordx4 a[44:47], v3, s[12:15], 0 offen offset:704
    buffer_load_dwordx4 a[124:127], v3, s[20:23], 0 offen offset:704
    buffer_load_dwordx4 a[48:51], v3, s[12:15], 0 offen offset:768
    buffer_load_dwordx4 a[128:131], v3, s[20:23], 0 offen offset:768
    buffer_load_dwordx4 a[52:55], v3, s[12:15], 0 offen offset:832
    buffer_load_dwordx4 a[132:135], v3, s[20:23], 0 offen offset:832
    buffer_load_dwordx4 a[56:59], v3, s[12:15], 0 offen offset:896
    buffer_load_dwordx4 a[136:139], v3, s[20:23], 0 offen offset:896
    buffer_load_dwordx4 a[60:63], v3, s[12:15], 0 offen offset:960
    buffer_load_dwordx4 a[140:143], v3, s[20:23], 0 offen offset:960
    buffer_load_dwordx4 a[64:67], v3, s[12:15], 0 offen offset:1024
    buffer_load_dwordx4 a[144:147], v3, s[20:23], 0 offen offset:1024
    buffer_load_dwordx4 a[68:71], v3, s[12:15], 0 offen offset:1088
    buffer_load_dwordx4 a[148:151], v3, s[20:23], 0 offen offset:1088
    buffer_load_dwordx4 a[72:75], v3, s[12:15], 0 offen offset:1152
    buffer_load_dwordx4 a[152:155], v3, s[20:23], 0 offen offset:1152
    buffer_load_dwordx4 a[76:79], v3, s[12:15], 0 offen offset:1216
    buffer_load_dwordx4 a[156:159], v3, s[20:23], 0 offen offset:1216
    v_lshrrev_b32 v5, 3, v1
    v_and_b32 v3, 7, v1
    v_xor_b32 v3, v3, v5
    v_lshlrev_b32 v3, 4, v3
    v_mul_u32_u24 v5, 1280, v5
    v_add_u32 v3, v3, v5
    s_mul_i32 s30, s24, 10240
    v_add_u32 v3, s30, v3
    v_and_b32 v6, 7, v1
    v_xor_b32 v5, v4, v6
    v_lshlrev_b32 v5, 4, v5
    v_lshl_add_u32 v5, v6, 7, v5
    v_bfe_u32 v6, v1, 3, 1
    v_mul_u32_u24 v6, 10240, v6
    v_add_u32 v8, v5, v6
    v_xor_b32 v9, 64, v8
    s_mov_b32 s78, 0
    s_mov_b32 s80, s30
    s_add_u32 m0, s80, 0
    s_nop 0
    buffer_load_dwordx4 v3, s[16:19], s78 offen offset:0 lds
    s_add_u32 m0, s80, 896
    s_nop 0
    buffer_load_dwordx4 v3, s[16:19], s78 offen offset:128 lds
    s_add_u32 m0, s80, 1792
    s_nop 0
    buffer_load_dwordx4 v3, s[16:19], s78 offen offset:256 lds
    s_add_u32 m0, s80, 2688
    s_nop 0
    buffer_load_dwordx4 v3, s[16:19], s78 offen offset:384 lds
    s_add_u32 m0, s80, 3584
    s_nop 0
    buffer_load_dwordx4 v3, s[16:19], s78 offen offset:512 lds
    s_add_u32 m0, s80, 4480
    s_nop 0
    buffer_load_dwordx4 v3, s[16:19], s78 offen offset:640 lds
    s_add_u32 m0, s80, 5376
    s_nop 0
    buffer_load_dwordx4 v3, s[16:19], s78 offen offset:768 lds
    s_add_u32 m0, s80, 6272
    s_nop 0
    buffer_load_dwordx4 v3, s[16:19], s78 offen offset:896 lds
    s_add_u32 m0, s80, 7168
    s_nop 0
    buffer_load_dwordx4 v3, s[16:19], s78 offen offset:1024 lds
    s_add_u32 m0, s80, 8064
    s_nop 0
    buffer_load_dwordx4 v3, s[16:19], s78 offen offset:1152 lds
    s_mov_b32 s78, 40960
    s_add_u32 s80, s30, 40960
    s_add_u32 m0, s80, 0
    s_nop 0
    buffer_load_dwordx4 v3, s[16:19], s78 offen offset:0 lds
    s_add_u32 m0, s80, 896
    s_nop 0
    buffer_load_dwordx4 v3, s[16:19], s78 offen offset:128 lds
    s_add_u32 m0, s80, 1792
    s_nop 0
    buffer_load_dwordx4 v3, s[16:19], s78 offen offset:256 lds
    s_add_u32 m0, s80, 2688
    s_nop 0
    buffer_load_dwordx4 v3, s[16:19], s78 offen offset:384 lds
    s_add_u32 m0, s80, 3584
    s_nop 0
    buffer_load_dwordx4 v3, s[16:19], s78 offen offset:512 lds
    s_add_u32 m0, s80, 4480
    s_nop 0
    buffer_load_dwordx4 v3, s[16:19], s78 offen offset:640 lds
    s_add_u32 m0, s80, 5376
    s_nop 0
    buffer_load_dwordx4 v3, s[16:19], s78 offen offset:768 lds
    s_add_u32 m0, s80, 6272
    s_nop 0
    buffer_load_dwordx4 v3, s[16:19], s78 offen offset:896 lds
    s_add_u32 m0, s80, 7168
    s_nop 0
    buffer_load_dwordx4 v3, s[16:19], s78 offen offset:1024 lds
    s_add_u32 m0, s80, 8064
    s_nop 0
    buffer_load_dwordx4 v3, s[16:19], s78 offen offset:1152 lds
    s_mov_b32 s12, s52
    s_mov_b32 s13, s53
    s_mov_b32 s14, 1280
    s_mov_b32 s15, 0x20000
    s_mov_b32 s20, s54
    s_mov_b32 s21, s55
    s_mov_b32 s22, 1280
    s_mov_b32 s23, 0x20000
    s_mov_b32 s32, s64
    s_mov_b32 s33, s65
    s_mov_b32 s34, 1280
    s_mov_b32 s35, 0x20000
    v_lshlrev_b32 v5, 4, v4
    s_lshl_b32 s28, s74, 1
    v_add_u32 v5, s28, v5
    buffer_load_dwordx2 v[16:17], v5, s[12:15], 0 offen
    buffer_load_dwordx2 v[18:19], v5, s[20:23], 0 offen
    buffer_load_dwordx2 v[20:21], v5, s[32:35], 0 offen
    s_mov_b32 s81, 1069066811
    s_mov_b32 s82, 1042479491
    s_waitcnt vmcnt(0)
    v_lshlrev_b32 v24, 16, v16
    v_and_b32 v25, 0xffff0000, v16
    v_lshlrev_b32 v26, 16, v17
    v_and_b32 v27, 0xffff0000, v17
    v_lshlrev_b32 v28, 16, v18
    v_and_b32 v29, 0xffff0000, v18
    v_lshlrev_b32 v30, 16, v19
    v_and_b32 v31, 0xffff0000, v19
    v_lshlrev_b32 v32, 16, v20
    v_and_b32 v33, 0xffff0000, v20
    v_lshlrev_b32 v34, 16, v21
    v_and_b32 v35, 0xffff0000, v21
    v_and_b32 v40, 15, v1
    v_cmp_eq_u32 vcc, 0, v40
    v_mov_b32 v41, 0
    v_mul_f32 v36, s81, v32
    v_exp_f32 v36, v36
    s_nop 0
    v_cvt_pk_bf16_f32 v36, v36, v36
    v_lshlrev_b32 v36, 16, v36
    v_mul_f32 v37, v36, v24
    v_mul_f32 v38, v36, v28
    v_mul_f32 v37, s81, v37
    v_exp_f32 v37, v37
    v_mul_f32 v38, s82, v38
    v_fract_f32 v38, v38
    v_cos_f32 v39, v38
    v_sin_f32 v38, v38
    s_nop 0
    v_mul_f32 v136, v37, v39
    v_mul_f32 v137, v37, v38
    v_add_f32 v36, -1.0, v136
    v_mul_f32 v37, v24, v24
    v_fma_f32 v37, v28, v28, v37
    v_rcp_f32 v37, v37
    v_mul_f32 v38, v36, v24
    v_fma_f32 v38, v137, v28, v38
    v_mul_f32 v39, v137, v24
    v_fma_f32 v39, -v36, v28, v39
    v_add_f32 v37, v37, v37
    v_mul_f32 v128, v38, v37
    v_mul_f32 v132, v39, v37
    v_mul_f32 v148, v136, v136
    v_mul_f32 v149, v136, v137
    v_fma_f32 v148, -v137, v137, v148
    v_fma_f32 v149, v137, v136, v149
    v_mul_f32 v160, v148, v148
    v_mul_f32 v161, v148, v149
    v_fma_f32 v160, -v149, v149, v160
    v_fma_f32 v161, v149, v148, v161
    v_mul_f32 v172, v160, v160
    v_mul_f32 v173, v160, v161
    v_fma_f32 v172, -v161, v161, v172
    v_fma_f32 v173, v161, v160, v173
    v_sub_f32 v138, 0, v137
    v_sub_f32 v150, 0, v149
    v_sub_f32 v162, 0, v161
    v_sub_f32 v174, 0, v173
    v_cndmask_b32 v184, v41, v136, vcc
    v_cndmask_b32 v185, v41, v137, vcc
    v_cndmask_b32 v186, v41, v138, vcc
    v_mul_f32 v36, s81, v33
    v_exp_f32 v36, v36
    s_nop 0
    v_cvt_pk_bf16_f32 v36, v36, v36
    v_lshlrev_b32 v36, 16, v36
    v_mul_f32 v37, v36, v25
    v_mul_f32 v38, v36, v29
    v_mul_f32 v37, s81, v37
    v_exp_f32 v37, v37
    v_mul_f32 v38, s82, v38
    v_fract_f32 v38, v38
    v_cos_f32 v39, v38
    v_sin_f32 v38, v38
    s_nop 0
    v_mul_f32 v139, v37, v39
    v_mul_f32 v140, v37, v38
    v_add_f32 v36, -1.0, v139
    v_mul_f32 v37, v25, v25
    v_fma_f32 v37, v29, v29, v37
    v_rcp_f32 v37, v37
    v_mul_f32 v38, v36, v25
    v_fma_f32 v38, v140, v29, v38
    v_mul_f32 v39, v140, v25
    v_fma_f32 v39, -v36, v29, v39
    v_add_f32 v37, v37, v37
    v_mul_f32 v129, v38, v37
    v_mul_f32 v133, v39, v37
    v_mul_f32 v151, v139, v139
    v_mul_f32 v152, v139, v140
    v_fma_f32 v151, -v140, v140, v151
    v_fma_f32 v152, v140, v139, v152
    v_mul_f32 v163, v151, v151
    v_mul_f32 v164, v151, v152
    v_fma_f32 v163, -v152, v152, v163
    v_fma_f32 v164, v152, v151, v164
    v_mul_f32 v175, v163, v163
    v_mul_f32 v176, v163, v164
    v_fma_f32 v175, -v164, v164, v175
    v_fma_f32 v176, v164, v163, v176
    v_sub_f32 v141, 0, v140
    v_sub_f32 v153, 0, v152
    v_sub_f32 v165, 0, v164
    v_sub_f32 v177, 0, v176
    v_cndmask_b32 v187, v41, v139, vcc
    v_cndmask_b32 v188, v41, v140, vcc
    v_cndmask_b32 v189, v41, v141, vcc
    v_mul_f32 v36, s81, v34
    v_exp_f32 v36, v36
    s_nop 0
    v_cvt_pk_bf16_f32 v36, v36, v36
    v_lshlrev_b32 v36, 16, v36
    v_mul_f32 v37, v36, v26
    v_mul_f32 v38, v36, v30
    v_mul_f32 v37, s81, v37
    v_exp_f32 v37, v37
    v_mul_f32 v38, s82, v38
    v_fract_f32 v38, v38
    v_cos_f32 v39, v38
    v_sin_f32 v38, v38
    s_nop 0
    v_mul_f32 v142, v37, v39
    v_mul_f32 v143, v37, v38
    v_add_f32 v36, -1.0, v142
    v_mul_f32 v37, v26, v26
    v_fma_f32 v37, v30, v30, v37
    v_rcp_f32 v37, v37
    v_mul_f32 v38, v36, v26
    v_fma_f32 v38, v143, v30, v38
    v_mul_f32 v39, v143, v26
    v_fma_f32 v39, -v36, v30, v39
    v_add_f32 v37, v37, v37
    v_mul_f32 v130, v38, v37
    v_mul_f32 v134, v39, v37
    v_mul_f32 v154, v142, v142
    v_mul_f32 v155, v142, v143
    v_fma_f32 v154, -v143, v143, v154
    v_fma_f32 v155, v143, v142, v155
    v_mul_f32 v166, v154, v154
    v_mul_f32 v167, v154, v155
    v_fma_f32 v166, -v155, v155, v166
    v_fma_f32 v167, v155, v154, v167
    v_mul_f32 v178, v166, v166
    v_mul_f32 v179, v166, v167
    v_fma_f32 v178, -v167, v167, v178
    v_fma_f32 v179, v167, v166, v179
    v_sub_f32 v144, 0, v143
    v_sub_f32 v156, 0, v155
    v_sub_f32 v168, 0, v167
    v_sub_f32 v180, 0, v179
    v_cndmask_b32 v190, v41, v142, vcc
    v_cndmask_b32 v191, v41, v143, vcc
    v_cndmask_b32 v192, v41, v144, vcc
    v_mul_f32 v36, s81, v35
    v_exp_f32 v36, v36
    s_nop 0
    v_cvt_pk_bf16_f32 v36, v36, v36
    v_lshlrev_b32 v36, 16, v36
    v_mul_f32 v37, v36, v27
    v_mul_f32 v38, v36, v31
    v_mul_f32 v37, s81, v37
    v_exp_f32 v37, v37
    v_mul_f32 v38, s82, v38
    v_fract_f32 v38, v38
    v_cos_f32 v39, v38
    v_sin_f32 v38, v38
    s_nop 0
    v_mul_f32 v145, v37, v39
    v_mul_f32 v146, v37, v38
    v_add_f32 v36, -1.0, v145
    v_mul_f32 v37, v27, v27
    v_fma_f32 v37, v31, v31, v37
    v_rcp_f32 v37, v37
    v_mul_f32 v38, v36, v27
    v_fma_f32 v38, v146, v31, v38
    v_mul_f32 v39, v146, v27
    v_fma_f32 v39, -v36, v31, v39
    v_add_f32 v37, v37, v37
    v_mul_f32 v131, v38, v37
    v_mul_f32 v135, v39, v37
    v_mul_f32 v157, v145, v145
    v_mul_f32 v158, v145, v146
    v_fma_f32 v157, -v146, v146, v157
    v_fma_f32 v158, v146, v145, v158
    v_mul_f32 v169, v157, v157
    v_mul_f32 v170, v157, v158
    v_fma_f32 v169, -v158, v158, v169
    v_fma_f32 v170, v158, v157, v170
    v_mul_f32 v181, v169, v169
    v_mul_f32 v182, v169, v170
    v_fma_f32 v181, -v170, v170, v181
    v_fma_f32 v182, v170, v169, v182
    v_sub_f32 v147, 0, v146
    v_sub_f32 v159, 0, v158
    v_sub_f32 v171, 0, v170
    v_sub_f32 v183, 0, v182
    v_cndmask_b32 v193, v41, v145, vcc
    v_cndmask_b32 v194, v41, v146, vcc
    v_cndmask_b32 v195, v41, v147, vcc
    s_lshl_b32 s28, s75, 12
    s_lshl_b32 s29, s24, 10
    s_add_u32 s28, s28, s29
    s_add_u32 s28, s28, 186646528
    v_add_u32 v6, s28, v2
    s_lshl_b32 s28, s75, 7
    s_add_u32 s28, s28, 192435200
    v_mov_b32 v10, s28
    v_and_b32 v12, 3, v1
    v_lshlrev_b32 v12, 2, v12
    v_bfe_u32 v13, v1, 2, 1
    v_lshl_add_u32 v12, v13, 7, v12
    v_cmp_lt_u32 vcc, 7, v1
    v_mov_b32 v13, 16
    s_nop 0
    v_cndmask_b32 v12, v12, v13, vcc
L_b1_st:
    buffer_load_dword v13, v12, s[8:11], 0 offen sc1
    s_waitcnt vmcnt(0)
    v_cmp_gt_u32 vcc, 32, v13
    v_readlane_b32 s28, v13, 8
    s_cbranch_vccnz L_b1_st_no
    s_cmp_ge_u32 s28, 64
    s_cbranch_scc1 L_b1_st_ok
L_b1_st_no:
    s_sleep 4
    s_sub_u32 s27, s27, 1
    s_cbranch_scc1 L_fail
    s_branch L_b1_st
L_b1_st_ok:
    v_mov_b32 v96, 0
    v_mov_b32 v16, 0
    v_mov_b32 v97, 0
    v_mov_b32 v17, 0
    v_mov_b32 v98, 0
    v_mov_b32 v18, 0
    v_mov_b32 v99, 0
    v_mov_b32 v19, 0
    v_mov_b32 v100, 0
    v_mov_b32 v20, 0
    v_mov_b32 v101, 0
    v_mov_b32 v21, 0
    v_mov_b32 v102, 0
    v_mov_b32 v22, 0
    v_mov_b32 v103, 0
    v_mov_b32 v23, 0
    v_mov_b32 v104, 0
    v_mov_b32 v24, 0
    v_mov_b32 v105, 0
    v_mov_b32 v25, 0
    v_mov_b32 v106, 0
    v_mov_b32 v26, 0
    v_mov_b32 v107, 0
    v_mov_b32 v27, 0
    v_mov_b32 v108, 0
    v_mov_b32 v28, 0
    v_mov_b32 v109, 0
    v_mov_b32 v29, 0
    v_mov_b32 v110, 0
    v_mov_b32 v30, 0
    v_mov_b32 v111, 0
    v_mov_b32 v31, 0
    s_mov_b32 s77, 0
    s_mov_b32 s76, 5242880
    s_mov_b32 s65, 0
    s_mov_b32 s78, 81920
    s_mov_b32 s79, 81920
    s_mov_b32 s83, 0
L_b1_loop:
    s_waitcnt vmcnt(12)
    s_barrier
    s_sub_u32 s28, s77, 2
    s_max_i32 s28, s28, 0
    s_cmp_eq_u32 s24, 0
    s_cbranch_scc0 L_b1_pub
    v_mov_b32 v13, s28
    s_mov_b64 exec, 1
    buffer_store_dword v13, v10, s[4:7], 0 offen offset:0 sc1
    s_mov_b64 exec, -1
L_b1_pub:
    s_add_u32 s80, s30, s79
    v_add_u32 v11, s83, v8
    v_add_u32 v12, s83, v9
    ds_read_b128 v[48:51], v11 offset:0
    ds_read_b128 v[52:55], v12 offset:0
    ds_read_b128 v[56:59], v11 offset:1024
    ds_read_b128 v[60:63], v12 offset:1024
    ds_read_b128 v[64:67], v11 offset:2048
    ds_read_b128 v[68:71], v12 offset:2048
    ds_read_b128 v[72:75], v11 offset:3072
    s_waitcnt lgkmcnt(6)
    v_mfma_f32_16x16x32_bf16 v[16:19], a[0:3], v[48:51], 0
    v_mfma_f32_16x16x32_bf16 v[20:23], a[80:83], v[48:51], 0
    ds_read_b128 v[76:79], v12 offset:3072
    s_add_u32 m0, s80, 0
    s_nop 0
    buffer_load_dwordx4 v3, s[16:19], s78 offen offset:0 lds
    s_waitcnt lgkmcnt(6)
    v_mfma_f32_16x16x32_bf16 v[16:19], a[4:7], v[52:55], v[16:19]
    v_mfma_f32_16x16x32_bf16 v[20:23], a[84:87], v[52:55], v[20:23]
    v_mul_f32 v104, v24, v128
    v_mul_f32 v108, v24, v132
    v_fma_f32 v104, -v28, v132, v104
    v_fma_f32 v108, v28, v128, v108
    ds_read_b128 v[48:51], v11 offset:4096
    s_waitcnt lgkmcnt(6)
    v_mfma_f32_16x16x32_bf16 v[16:19], a[8:11], v[56:59], v[16:19]
    v_mul_f32 v105, v25, v129
    v_mul_f32 v109, v25, v133
    v_fma_f32 v105, -v29, v133, v105
    v_fma_f32 v109, v29, v129, v109
    v_mfma_f32_16x16x32_bf16 v[20:23], a[88:91], v[56:59], v[20:23]
    v_mul_f32 v106, v26, v130
    v_mul_f32 v110, v26, v134
    v_fma_f32 v106, -v30, v134, v106
    v_fma_f32 v110, v30, v130, v110
    ds_read_b128 v[52:55], v12 offset:4096
    s_waitcnt lgkmcnt(6)
    v_mfma_f32_16x16x32_bf16 v[16:19], a[12:15], v[60:63], v[16:19]
    v_mul_f32 v107, v27, v131
    v_mul_f32 v111, v27, v135
    v_fma_f32 v107, -v31, v135, v107
    v_fma_f32 v111, v31, v131, v111
    v_mfma_f32_16x16x32_bf16 v[20:23], a[92:95], v[60:63], v[20:23]
    v_fmac_f32_dpp v104, v96, v184 row_ror:1 row_mask:0xf bank_mask:0xf
    v_fmac_f32_dpp v108, v100, v184 row_ror:1 row_mask:0xf bank_mask:0xf
    v_fmac_f32_dpp v104, v100, v186 row_ror:1 row_mask:0xf bank_mask:0xf
    v_fmac_f32_dpp v108, v96, v185 row_ror:1 row_mask:0xf bank_mask:0xf
    ds_read_b128 v[56:59], v11 offset:5120
    s_waitcnt lgkmcnt(6)
    v_mfma_f32_16x16x32_bf16 v[16:19], a[16:19], v[64:67], v[16:19]
    v_fmac_f32_dpp v105, v97, v187 row_ror:1 row_mask:0xf bank_mask:0xf
    v_fmac_f32_dpp v109, v101, v187 row_ror:1 row_mask:0xf bank_mask:0xf
    v_fmac_f32_dpp v105, v101, v189 row_ror:1 row_mask:0xf bank_mask:0xf
    v_fmac_f32_dpp v109, v97, v188 row_ror:1 row_mask:0xf bank_mask:0xf
    v_mfma_f32_16x16x32_bf16 v[20:23], a[96:99], v[64:67], v[20:23]
    v_fmac_f32_dpp v106, v98, v190 row_ror:1 row_mask:0xf bank_mask:0xf
    v_fmac_f32_dpp v110, v102, v190 row_ror:1 row_mask:0xf bank_mask:0xf
    v_fmac_f32_dpp v106, v102, v192 row_ror:1 row_mask:0xf bank_mask:0xf
    v_fmac_f32_dpp v110, v98, v191 row_ror:1 row_mask:0xf bank_mask:0xf
    ds_read_b128 v[60:63], v12 offset:5120
    s_add_u32 m0, s80, 896
    s_nop 0
    buffer_load_dwordx4 v3, s[16:19], s78 offen offset:128 lds
    s_waitcnt lgkmcnt(6)
    v_mfma_f32_16x16x32_bf16 v[16:19], a[20:23], v[68:71], v[16:19]
    v_fmac_f32_dpp v107, v99, v193 row_ror:1 row_mask:0xf bank_mask:0xf
    v_fmac_f32_dpp v111, v103, v193 row_ror:1 row_mask:0xf bank_mask:0xf
    v_fmac_f32_dpp v107, v103, v195 row_ror:1 row_mask:0xf bank_mask:0xf
    v_fmac_f32_dpp v111, v99, v194 row_ror:1 row_mask:0xf bank_mask:0xf
    v_mfma_f32_16x16x32_bf16 v[20:23], a[100:103], v[68:71], v[20:23]
    v_mov_b32_dpp v88, v104 row_shr:1 row_mask:0xf bank_mask:0xf bound_ctrl:0
    v_mov_b32_dpp v89, v105 row_shr:1 row_mask:0xf bank_mask:0xf bound_ctrl:0
    v_mov_b32_dpp v90, v106 row_shr:1 row_mask:0xf bank_mask:0xf bound_ctrl:0
    v_mov_b32_dpp v91, v107 row_shr:1 row_mask:0xf bank_mask:0xf bound_ctrl:0
    ds_read_b128 v[64:67], v11 offset:6144
    s_waitcnt lgkmcnt(6)
    v_mfma_f32_16x16x32_bf16 v[16:19], a[24:27], v[72:75], v[16:19]
    v_fmac_f32_dpp v104, v108, v138 row_shr:1 row_mask:0xf bank_mask:0xf bound_ctrl:0
    v_fmac_f32_dpp v105, v109, v141 row_shr:1 row_mask:0xf bank_mask:0xf bound_ctrl:0
    v_fmac_f32_dpp v106, v110, v144 row_shr:1 row_mask:0xf bank_mask:0xf bound_ctrl:0
    v_fmac_f32_dpp v107, v111, v147 row_shr:1 row_mask:0xf bank_mask:0xf bound_ctrl:0
    v_mfma_f32_16x16x32_bf16 v[20:23], a[104:107], v[72:75], v[20:23]
    v_fmac_f32_dpp v108, v108, v136 row_shr:1 row_mask:0xf bank_mask:0xf bound_ctrl:0
    v_fmac_f32_dpp v109, v109, v139 row_shr:1 row_mask:0xf bank_mask:0xf bound_ctrl:0
    v_fmac_f32_dpp v110, v110, v142 row_shr:1 row_mask:0xf bank_mask:0xf bound_ctrl:0
    v_fmac_f32_dpp v111, v111, v145 row_shr:1 row_mask:0xf bank_mask:0xf bound_ctrl:0
    ds_read_b128 v[68:71], v12 offset:6144
    s_waitcnt lgkmcnt(6)
    v_mfma_f32_16x16x32_bf16 v[16:19], a[28:31], v[76:79], v[16:19]
    v_fmac_f32 v104, v88, v136
    v_fmac_f32 v105, v89, v139
    v_fmac_f32 v106, v90, v142
    v_fmac_f32 v107, v91, v145
    v_mfma_f32_16x16x32_bf16 v[20:23], a[108:111], v[76:79], v[20:23]
    v_fmac_f32 v108, v88, v137
    v_fmac_f32 v109, v89, v140
    v_fmac_f32 v110, v90, v143
    v_fmac_f32 v111, v91, v146
    ds_read_b128 v[72:75], v11 offset:7168
    s_waitcnt lgkmcnt(6)
    v_mfma_f32_16x16x32_bf16 v[16:19], a[32:35], v[48:51], v[16:19]
    v_mov_b32_dpp v88, v104 row_shr:2 row_mask:0xf bank_mask:0xf bound_ctrl:0
    v_mov_b32_dpp v89, v105 row_shr:2 row_mask:0xf bank_mask:0xf bound_ctrl:0
    v_mov_b32_dpp v90, v106 row_shr:2 row_mask:0xf bank_mask:0xf bound_ctrl:0
    v_mov_b32_dpp v91, v107 row_shr:2 row_mask:0xf bank_mask:0xf bound_ctrl:0
    v_mfma_f32_16x16x32_bf16 v[20:23], a[112:115], v[48:51], v[20:23]
    v_fmac_f32_dpp v104, v108, v150 row_shr:2 row_mask:0xf bank_mask:0xf bound_ctrl:0
    v_fmac_f32_dpp v105, v109, v153 row_shr:2 row_mask:0xf bank_mask:0xf bound_ctrl:0
    v_fmac_f32_dpp v106, v110, v156 row_shr:2 row_mask:0xf bank_mask:0xf bound_ctrl:0
    v_fmac_f32_dpp v107, v111, v159 row_shr:2 row_mask:0xf bank_mask:0xf bound_ctrl:0
    ds_read_b128 v[76:79], v12 offset:7168
    s_add_u32 m0, s80, 1792
    s_nop 0
    buffer_load_dwordx4 v3, s[16:19], s78 offen offset:256 lds
    s_waitcnt lgkmcnt(6)
    v_mfma_f32_16x16x32_bf16 v[16:19], a[36:39], v[52:55], v[16:19]
    v_fmac_f32_dpp v108, v108, v148 row_shr:2 row_mask:0xf bank_mask:0xf bound_ctrl:0
    v_fmac_f32_dpp v109, v109, v151 row_shr:2 row_mask:0xf bank_mask:0xf bound_ctrl:0
    v_fmac_f32_dpp v110, v110, v154 row_shr:2 row_mask:0xf bank_mask:0xf bound_ctrl:0
    v_fmac_f32_dpp v111, v111, v157 row_shr:2 row_mask:0xf bank_mask:0xf bound_ctrl:0
    v_mfma_f32_16x16x32_bf16 v[20:23], a[116:119], v[52:55], v[20:23]
    v_fmac_f32 v104, v88, v148
    v_fmac_f32 v105, v89, v151
    v_fmac_f32 v106, v90, v154
    v_fmac_f32 v107, v91, v157
    ds_read_b128 v[48:51], v11 offset:8192
    s_waitcnt lgkmcnt(6)
    v_mfma_f32_16x16x32_bf16 v[16:19], a[40:43], v[56:59], v[16:19]
    v_fmac_f32 v108, v88, v149
    v_fmac_f32 v109, v89, v152
    v_fmac_f32 v110, v90, v155
    v_fmac_f32 v111, v91, v158
    v_mfma_f32_16x16x32_bf16 v[20:23], a[120:123], v[56:59], v[20:23]
    v_mov_b32_dpp v88, v104 row_shr:4 row_mask:0xf bank_mask:0xf bound_ctrl:0
    v_mov_b32_dpp v89, v105 row_shr:4 row_mask:0xf bank_mask:0xf bound_ctrl:0
    v_mov_b32_dpp v90, v106 row_shr:4 row_mask:0xf bank_mask:0xf bound_ctrl:0
    v_mov_b32_dpp v91, v107 row_shr:4 row_mask:0xf bank_mask:0xf bound_ctrl:0
    ds_read_b128 v[52:55], v12 offset:8192
    s_waitcnt lgkmcnt(6)
    v_mfma_f32_16x16x32_bf16 v[16:19], a[44:47], v[60:63], v[16:19]
    v_fmac_f32_dpp v104, v108, v162 row_shr:4 row_mask:0xf bank_mask:0xf bound_ctrl:0
    v_fmac_f32_dpp v105, v109, v165 row_shr:4 row_mask:0xf bank_mask:0xf bound_ctrl:0
    v_fmac_f32_dpp v106, v110, v168 row_shr:4 row_mask:0xf bank_mask:0xf bound_ctrl:0
    v_fmac_f32_dpp v107, v111, v171 row_shr:4 row_mask:0xf bank_mask:0xf bound_ctrl:0
    v_mfma_f32_16x16x32_bf16 v[20:23], a[124:127], v[60:63], v[20:23]
    v_fmac_f32_dpp v108, v108, v160 row_shr:4 row_mask:0xf bank_mask:0xf bound_ctrl:0
    v_fmac_f32_dpp v109, v109, v163 row_shr:4 row_mask:0xf bank_mask:0xf bound_ctrl:0
    v_fmac_f32_dpp v110, v110, v166 row_shr:4 row_mask:0xf bank_mask:0xf bound_ctrl:0
    ds_read_b128 v[56:59], v11 offset:9216
    s_waitcnt lgkmcnt(6)
    v_mfma_f32_16x16x32_bf16 v[16:19], a[48:51], v[64:67], v[16:19]
    v_fmac_f32_dpp v111, v111, v169 row_shr:4 row_mask:0xf bank_mask:0xf bound_ctrl:0
    v_fmac_f32 v104, v88, v160
    v_fmac_f32 v105, v89, v163
    v_mfma_f32_16x16x32_bf16 v[20:23], a[128:131], v[64:67], v[20:23]
    v_fmac_f32 v106, v90, v166
    v_fmac_f32 v107, v91, v169
    v_fmac_f32 v108, v88, v161
    ds_read_b128 v[60:63], v12 offset:9216
    s_add_u32 m0, s80, 2688
    s_nop 0
    buffer_load_dwordx4 v3, s[16:19], s78 offen offset:384 lds
    s_waitcnt lgkmcnt(6)
    v_mfma_f32_16x16x32_bf16 v[16:19], a[52:55], v[68:71], v[16:19]
    v_fmac_f32 v109, v89, v164
    v_fmac_f32 v110, v90, v167
    v_fmac_f32 v111, v91, v170
    v_mfma_f32_16x16x32_bf16 v[20:23], a[132:135], v[68:71], v[20:23]
    v_mov_b32_dpp v88, v104 row_shr:8 row_mask:0xf bank_mask:0xf bound_ctrl:0
    v_mov_b32_dpp v89, v105 row_shr:8 row_mask:0xf bank_mask:0xf bound_ctrl:0
    v_mov_b32_dpp v90, v106 row_shr:8 row_mask:0xf bank_mask:0xf bound_ctrl:0
    ds_read_b128 v[64:67], v11 offset:20480
    s_waitcnt lgkmcnt(6)
    v_mfma_f32_16x16x32_bf16 v[16:19], a[56:59], v[72:75], v[16:19]
    v_mov_b32_dpp v91, v107 row_shr:8 row_mask:0xf bank_mask:0xf bound_ctrl:0
    v_fmac_f32_dpp v104, v108, v174 row_shr:8 row_mask:0xf bank_mask:0xf bound_ctrl:0
    v_fmac_f32_dpp v105, v109, v177 row_shr:8 row_mask:0xf bank_mask:0xf bound_ctrl:0
    v_mfma_f32_16x16x32_bf16 v[20:23], a[136:139], v[72:75], v[20:23]
    v_fmac_f32_dpp v106, v110, v180 row_shr:8 row_mask:0xf bank_mask:0xf bound_ctrl:0
    v_fmac_f32_dpp v107, v111, v183 row_shr:8 row_mask:0xf bank_mask:0xf bound_ctrl:0
    v_fmac_f32_dpp v108, v108, v172 row_shr:8 row_mask:0xf bank_mask:0xf bound_ctrl:0
    ds_read_b128 v[68:71], v12 offset:20480
    s_waitcnt lgkmcnt(6)
    v_mfma_f32_16x16x32_bf16 v[16:19], a[60:63], v[76:79], v[16:19]
    v_fmac_f32_dpp v109, v109, v175 row_shr:8 row_mask:0xf bank_mask:0xf bound_ctrl:0
    v_fmac_f32_dpp v110, v110, v178 row_shr:8 row_mask:0xf bank_mask:0xf bound_ctrl:0
    v_fmac_f32_dpp v111, v111, v181 row_shr:8 row_mask:0xf bank_mask:0xf bound_ctrl:0
    v_mfma_f32_16x16x32_bf16 v[20:23], a[140:143], v[76:79], v[20:23]
    v_fmac_f32 v104, v88, v172
    v_fmac_f32 v105, v89, v175
    v_fmac_f32 v106, v90, v178
    ds_read_b128 v[72:75], v11 offset:21504
    s_waitcnt lgkmcnt(6)
    v_mfma_f32_16x16x32_bf16 v[16:19], a[64:67], v[48:51], v[16:19]
    v_fmac_f32 v107, v91, v181
    v_fmac_f32 v108, v88, v173
    v_fmac_f32 v109, v89, v176
    v_mfma_f32_16x16x32_bf16 v[20:23], a[144:147], v[48:51], v[20:23]
    v_fmac_f32 v110, v90, v179
    v_fmac_f32 v111, v91, v182
    v_cvt_pk_bf16_f32 v84, v104, v105
    ds_read_b128 v[76:79], v12 offset:21504
    s_add_u32 m0, s80, 3584
    s_nop 0
    buffer_load_dwordx4 v3, s[16:19], s78 offen offset:512 lds
    s_waitcnt lgkmcnt(6)
    v_mfma_f32_16x16x32_bf16 v[16:19], a[68:71], v[52:55], v[16:19]
    v_cvt_pk_bf16_f32 v85, v106, v107
    v_cvt_pk_bf16_f32 v86, -v108, -v109
    v_cvt_pk_bf16_f32 v87, -v110, -v111
    v_mfma_f32_16x16x32_bf16 v[20:23], a[148:151], v[52:55], v[20:23]
    buffer_store_dwordx4 v[84:87], v6, s[4:7], s76 offen sc1
    s_mov_b32 s76, s65
    s_add_u32 s65, s65, 40960
    ds_read_b128 v[48:51], v11 offset:22528
    s_waitcnt lgkmcnt(6)
    v_mfma_f32_16x16x32_bf16 v[16:19], a[72:75], v[56:59], v[16:19]
    v_mfma_f32_16x16x32_bf16 v[20:23], a[152:155], v[56:59], v[20:23]
    ds_read_b128 v[52:55], v12 offset:22528
    s_waitcnt lgkmcnt(6)
    v_mfma_f32_16x16x32_bf16 v[16:19], a[76:79], v[60:63], v[16:19]
    v_mfma_f32_16x16x32_bf16 v[20:23], a[156:159], v[60:63], v[20:23]
    ds_read_b128 v[56:59], v11 offset:23552
    s_waitcnt lgkmcnt(6)
    v_mfma_f32_16x16x32_bf16 v[24:27], a[0:3], v[64:67], 0
    v_mfma_f32_16x16x32_bf16 v[28:31], a[80:83], v[64:67], 0
    ds_read_b128 v[60:63], v12 offset:23552
    s_add_u32 m0, s80, 4480
    s_nop 0
    buffer_load_dwordx4 v3, s[16:19], s78 offen offset:640 lds
    s_waitcnt lgkmcnt(6)
    v_mfma_f32_16x16x32_bf16 v[24:27], a[4:7], v[68:71], v[24:27]
    v_mfma_f32_16x16x32_bf16 v[28:31], a[84:87], v[68:71], v[28:31]
    v_mul_f32 v96, v16, v128
    v_mul_f32 v100, v16, v132
    v_fma_f32 v96, -v20, v132, v96
    v_fma_f32 v100, v20, v128, v100
    ds_read_b128 v[64:67], v11 offset:24576
    s_waitcnt lgkmcnt(6)
    v_mfma_f32_16x16x32_bf16 v[24:27], a[8:11], v[72:75], v[24:27]
    v_mul_f32 v97, v17, v129
    v_mul_f32 v101, v17, v133
    v_fma_f32 v97, -v21, v133, v97
    v_fma_f32 v101, v21, v129, v101
    v_mfma_f32_16x16x32_bf16 v[28:31], a[88:91], v[72:75], v[28:31]
    v_mul_f32 v98, v18, v130
    v_mul_f32 v102, v18, v134
    v_fma_f32 v98, -v22, v134, v98
    v_fma_f32 v102, v22, v130, v102
    ds_read_b128 v[68:71], v12 offset:24576
    s_waitcnt lgkmcnt(6)
    v_mfma_f32_16x16x32_bf16 v[24:27], a[12:15], v[76:79], v[24:27]
    v_mul_f32 v99, v19, v131
    v_mul_f32 v103, v19, v135
    v_fma_f32 v99, -v23, v135, v99
    v_fma_f32 v103, v23, v131, v103
    v_mfma_f32_16x16x32_bf16 v[28:31], a[92:95], v[76:79], v[28:31]
    v_fmac_f32_dpp v96, v104, v184 row_ror:1 row_mask:0xf bank_mask:0xf
    v_fmac_f32_dpp v100, v108, v184 row_ror:1 row_mask:0xf bank_mask:0xf
    v_fmac_f32_dpp v96, v108, v186 row_ror:1 row_mask:0xf bank_mask:0xf
    v_fmac_f32_dpp v100, v104, v185 row_ror:1 row_mask:0xf bank_mask:0xf
    ds_read_b128 v[72:75], v11 offset:25600
    s_waitcnt lgkmcnt(6)
    v_mfma_f32_16x16x32_bf16 v[24:27], a[16:19], v[48:51], v[24:27]
    v_fmac_f32_dpp v97, v105, v187 row_ror:1 row_mask:0xf bank_mask:0xf
    v_fmac_f32_dpp v101, v109, v187 row_ror:1 row_mask:0xf bank_mask:0xf
    v_fmac_f32_dpp v97, v109, v189 row_ror:1 row_mask:0xf bank_mask:0xf
    v_fmac_f32_dpp v101, v105, v188 row_ror:1 row_mask:0xf bank_mask:0xf
    v_mfma_f32_16x16x32_bf16 v[28:31], a[96:99], v[48:51], v[28:31]
    v_fmac_f32_dpp v98, v106, v190 row_ror:1 row_mask:0xf bank_mask:0xf
    v_fmac_f32_dpp v102, v110, v190 row_ror:1 row_mask:0xf bank_mask:0xf
    v_fmac_f32_dpp v98, v110, v192 row_ror:1 row_mask:0xf bank_mask:0xf
    v_fmac_f32_dpp v102, v106, v191 row_ror:1 row_mask:0xf bank_mask:0xf
    ds_read_b128 v[76:79], v12 offset:25600
    s_add_u32 m0, s80, 5376
    s_nop 0
    buffer_load_dwordx4 v3, s[16:19], s78 offen offset:768 lds
    s_waitcnt lgkmcnt(6)
    v_mfma_f32_16x16x32_bf16 v[24:27], a[20:23], v[52:55], v[24:27]
    v_fmac_f32_dpp v99, v107, v193 row_ror:1 row_mask:0xf bank_mask:0xf
    v_fmac_f32_dpp v103, v111, v193 row_ror:1 row_mask:0xf bank_mask:0xf
    v_fmac_f32_dpp v99, v111, v195 row_ror:1 row_mask:0xf bank_mask:0xf
    v_fmac_f32_dpp v103, v107, v194 row_ror:1 row_mask:0xf bank_mask:0xf
    v_mfma_f32_16x16x32_bf16 v[28:31], a[100:103], v[52:55], v[28:31]
    v_mov_b32_dpp v88, v96 row_shr:1 row_mask:0xf bank_mask:0xf bound_ctrl:0
    v_mov_b32_dpp v89, v97 row_shr:1 row_mask:0xf bank_mask:0xf bound_ctrl:0
    v_mov_b32_dpp v90, v98 row_shr:1 row_mask:0xf bank_mask:0xf bound_ctrl:0
    v_mov_b32_dpp v91, v99 row_shr:1 row_mask:0xf bank_mask:0xf bound_ctrl:0
    ds_read_b128 v[48:51], v11 offset:26624
    s_waitcnt lgkmcnt(6)
    v_mfma_f32_16x16x32_bf16 v[24:27], a[24:27], v[56:59], v[24:27]
    v_fmac_f32_dpp v96, v100, v138 row_shr:1 row_mask:0xf bank_mask:0xf bound_ctrl:0
    v_fmac_f32_dpp v97, v101, v141 row_shr:1 row_mask:0xf bank_mask:0xf bound_ctrl:0
    v_fmac_f32_dpp v98, v102, v144 row_shr:1 row_mask:0xf bank_mask:0xf bound_ctrl:0
    v_fmac_f32_dpp v99, v103, v147 row_shr:1 row_mask:0xf bank_mask:0xf bound_ctrl:0
    v_mfma_f32_16x16x32_bf16 v[28:31], a[104:107], v[56:59], v[28:31]
    v_fmac_f32_dpp v100, v100, v136 row_shr:1 row_mask:0xf bank_mask:0xf bound_ctrl:0
    v_fmac_f32_dpp v101, v101, v139 row_shr:1 row_mask:0xf bank_mask:0xf bound_ctrl:0
    v_fmac_f32_dpp v102, v102, v142 row_shr:1 row_mask:0xf bank_mask:0xf bound_ctrl:0
    v_fmac_f32_dpp v103, v103, v145 row_shr:1 row_mask:0xf bank_mask:0xf bound_ctrl:0
    ds_read_b128 v[52:55], v12 offset:26624
    s_waitcnt lgkmcnt(6)
    v_mfma_f32_16x16x32_bf16 v[24:27], a[28:31], v[60:63], v[24:27]
    v_fmac_f32 v96, v88, v136
    v_fmac_f32 v97, v89, v139
    v_fmac_f32 v98, v90, v142
    v_fmac_f32 v99, v91, v145
    v_mfma_f32_16x16x32_bf16 v[28:31], a[108:111], v[60:63], v[28:31]
    v_fmac_f32 v100, v88, v137
    v_fmac_f32 v101, v89, v140
    v_fmac_f32 v102, v90, v143
    v_fmac_f32 v103, v91, v146
    ds_read_b128 v[56:59], v11 offset:27648
    s_waitcnt lgkmcnt(6)
    v_mfma_f32_16x16x32_bf16 v[24:27], a[32:35], v[64:67], v[24:27]
    v_mov_b32_dpp v88, v96 row_shr:2 row_mask:0xf bank_mask:0xf bound_ctrl:0
    v_mov_b32_dpp v89, v97 row_shr:2 row_mask:0xf bank_mask:0xf bound_ctrl:0
    v_mov_b32_dpp v90, v98 row_shr:2 row_mask:0xf bank_mask:0xf bound_ctrl:0
    v_mov_b32_dpp v91, v99 row_shr:2 row_mask:0xf bank_mask:0xf bound_ctrl:0
    v_mfma_f32_16x16x32_bf16 v[28:31], a[112:115], v[64:67], v[28:31]
    v_fmac_f32_dpp v96, v100, v150 row_shr:2 row_mask:0xf bank_mask:0xf bound_ctrl:0
    v_fmac_f32_dpp v97, v101, v153 row_shr:2 row_mask:0xf bank_mask:0xf bound_ctrl:0
    v_fmac_f32_dpp v98, v102, v156 row_shr:2 row_mask:0xf bank_mask:0xf bound_ctrl:0
    v_fmac_f32_dpp v99, v103, v159 row_shr:2 row_mask:0xf bank_mask:0xf bound_ctrl:0
    ds_read_b128 v[60:63], v12 offset:27648
    s_add_u32 m0, s80, 6272
    s_nop 0
    buffer_load_dwordx4 v3, s[16:19], s78 offen offset:896 lds
    s_waitcnt lgkmcnt(6)
    v_mfma_f32_16x16x32_bf16 v[24:27], a[36:39], v[68:71], v[24:27]
    v_fmac_f32_dpp v100, v100, v148 row_shr:2 row_mask:0xf bank_mask:0xf bound_ctrl:0
    v_fmac_f32_dpp v101, v101, v151 row_shr:2 row_mask:0xf bank_mask:0xf bound_ctrl:0
    v_fmac_f32_dpp v102, v102, v154 row_shr:2 row_mask:0xf bank_mask:0xf bound_ctrl:0
    v_fmac_f32_dpp v103, v103, v157 row_shr:2 row_mask:0xf bank_mask:0xf bound_ctrl:0
    v_mfma_f32_16x16x32_bf16 v[28:31], a[116:119], v[68:71], v[28:31]
    v_fmac_f32 v96, v88, v148
    v_fmac_f32 v97, v89, v151
    v_fmac_f32 v98, v90, v154
    v_fmac_f32 v99, v91, v157
    ds_read_b128 v[64:67], v11 offset:28672
    s_waitcnt lgkmcnt(6)
    v_mfma_f32_16x16x32_bf16 v[24:27], a[40:43], v[72:75], v[24:27]
    v_fmac_f32 v100, v88, v149
    v_fmac_f32 v101, v89, v152
    v_fmac_f32 v102, v90, v155
    v_fmac_f32 v103, v91, v158
    v_mfma_f32_16x16x32_bf16 v[28:31], a[120:123], v[72:75], v[28:31]
    v_mov_b32_dpp v88, v96 row_shr:4 row_mask:0xf bank_mask:0xf bound_ctrl:0
    v_mov_b32_dpp v89, v97 row_shr:4 row_mask:0xf bank_mask:0xf bound_ctrl:0
    v_mov_b32_dpp v90, v98 row_shr:4 row_mask:0xf bank_mask:0xf bound_ctrl:0
    v_mov_b32_dpp v91, v99 row_shr:4 row_mask:0xf bank_mask:0xf bound_ctrl:0
    ds_read_b128 v[68:71], v12 offset:28672
    s_waitcnt lgkmcnt(6)
    v_mfma_f32_16x16x32_bf16 v[24:27], a[44:47], v[76:79], v[24:27]
    v_fmac_f32_dpp v96, v100, v162 row_shr:4 row_mask:0xf bank_mask:0xf bound_ctrl:0
    v_fmac_f32_dpp v97, v101, v165 row_shr:4 row_mask:0xf bank_mask:0xf bound_ctrl:0
    v_fmac_f32_dpp v98, v102, v168 row_shr:4 row_mask:0xf bank_mask:0xf bound_ctrl:0
    v_fmac_f32_dpp v99, v103, v171 row_shr:4 row_mask:0xf bank_mask:0xf bound_ctrl:0
    v_mfma_f32_16x16x32_bf16 v[28:31], a[124:127], v[76:79], v[28:31]
    v_fmac_f32_dpp v100, v100, v160 row_shr:4 row_mask:0xf bank_mask:0xf bound_ctrl:0
    v_fmac_f32_dpp v101, v101, v163 row_shr:4 row_mask:0xf bank_mask:0xf bound_ctrl:0
    v_fmac_f32_dpp v102, v102, v166 row_shr:4 row_mask:0xf bank_mask:0xf bound_ctrl:0
    ds_read_b128 v[72:75], v11 offset:29696
    s_waitcnt lgkmcnt(6)
    v_mfma_f32_16x16x32_bf16 v[24:27], a[48:51], v[48:51], v[24:27]
    v_fmac_f32_dpp v103, v103, v169 row_shr:4 row_mask:0xf bank_mask:0xf bound_ctrl:0
    v_fmac_f32 v96, v88, v160
    v_fmac_f32 v97, v89, v163
    v_mfma_f32_16x16x32_bf16 v[28:31], a[128:131], v[48:51], v[28:31]
    v_fmac_f32 v98, v90, v166
    v_fmac_f32 v99, v91, v169
    v_fmac_f32 v100, v88, v161
    ds_read_b128 v[76:79], v12 offset:29696
    s_add_u32 m0, s80, 7168
    s_nop 0
    buffer_load_dwordx4 v3, s[16:19], s78 offen offset:1024 lds
    s_waitcnt lgkmcnt(6)
    v_mfma_f32_16x16x32_bf16 v[24:27], a[52:55], v[52:55], v[24:27]
    v_fmac_f32 v101, v89, v164
    v_fmac_f32 v102, v90, v167
    v_fmac_f32 v103, v91, v170
    v_mfma_f32_16x16x32_bf16 v[28:31], a[132:135], v[52:55], v[28:31]
    v_mov_b32_dpp v88, v96 row_shr:8 row_mask:0xf bank_mask:0xf bound_ctrl:0
    v_mov_b32_dpp v89, v97 row_shr:8 row_mask:0xf bank_mask:0xf bound_ctrl:0
    v_mov_b32_dpp v90, v98 row_shr:8 row_mask:0xf bank_mask:0xf bound_ctrl:0
    s_waitcnt lgkmcnt(5)
    v_mfma_f32_16x16x32_bf16 v[24:27], a[56:59], v[56:59], v[24:27]
    v_mov_b32_dpp v91, v99 row_shr:8 row_mask:0xf bank_mask:0xf bound_ctrl:0
    v_fmac_f32_dpp v96, v100, v174 row_shr:8 row_mask:0xf bank_mask:0xf bound_ctrl:0
    v_fmac_f32_dpp v97, v101, v177 row_shr:8 row_mask:0xf bank_mask:0xf bound_ctrl:0
    v_mfma_f32_16x16x32_bf16 v[28:31], a[136:139], v[56:59], v[28:31]
    v_fmac_f32_dpp v98, v102, v180 row_shr:8 row_mask:0xf bank_mask:0xf bound_ctrl:0
    v_fmac_f32_dpp v99, v103, v183 row_shr:8 row_mask:0xf bank_mask:0xf bound_ctrl:0
    v_fmac_f32_dpp v100, v100, v172 row_shr:8 row_mask:0xf bank_mask:0xf bound_ctrl:0
    s_waitcnt lgkmcnt(4)
    v_mfma_f32_16x16x32_bf16 v[24:27], a[60:63], v[60:63], v[24:27]
    v_fmac_f32_dpp v101, v101, v175 row_shr:8 row_mask:0xf bank_mask:0xf bound_ctrl:0
    v_fmac_f32_dpp v102, v102, v178 row_shr:8 row_mask:0xf bank_mask:0xf bound_ctrl:0
    v_fmac_f32_dpp v103, v103, v181 row_shr:8 row_mask:0xf bank_mask:0xf bound_ctrl:0
    v_mfma_f32_16x16x32_bf16 v[28:31], a[140:143], v[60:63], v[28:31]
    v_fmac_f32 v96, v88, v172
    v_fmac_f32 v97, v89, v175
    v_fmac_f32 v98, v90, v178
    s_waitcnt lgkmcnt(3)
    v_mfma_f32_16x16x32_bf16 v[24:27], a[64:67], v[64:67], v[24:27]
    v_fmac_f32 v99, v91, v181
    v_fmac_f32 v100, v88, v173
    v_fmac_f32 v101, v89, v176
    v_mfma_f32_16x16x32_bf16 v[28:31], a[144:147], v[64:67], v[28:31]
    v_fmac_f32 v102, v90, v179
    v_fmac_f32 v103, v91, v182
    v_cvt_pk_bf16_f32 v80, v96, v97
    s_add_u32 m0, s80, 8064
    s_nop 0
    buffer_load_dwordx4 v3, s[16:19], s78 offen offset:1152 lds
    s_waitcnt lgkmcnt(2)
    v_mfma_f32_16x16x32_bf16 v[24:27], a[68:71], v[68:71], v[24:27]
    v_cvt_pk_bf16_f32 v81, v98, v99
    v_cvt_pk_bf16_f32 v82, -v100, -v101
    v_cvt_pk_bf16_f32 v83, -v102, -v103
    v_mfma_f32_16x16x32_bf16 v[28:31], a[148:151], v[68:71], v[28:31]
    buffer_store_dwordx4 v[80:83], v6, s[4:7], s76 offen sc1
    s_mov_b32 s76, s65
    s_add_u32 s65, s65, 40960
    s_waitcnt lgkmcnt(1)
    v_mfma_f32_16x16x32_bf16 v[24:27], a[72:75], v[72:75], v[24:27]
    v_mfma_f32_16x16x32_bf16 v[28:31], a[152:155], v[72:75], v[28:31]
    s_waitcnt lgkmcnt(0)
    v_mfma_f32_16x16x32_bf16 v[24:27], a[76:79], v[76:79], v[24:27]
    v_mfma_f32_16x16x32_bf16 v[28:31], a[156:159], v[76:79], v[28:31]
    s_add_u32 s78, s78, 40960
    s_add_u32 s79, s79, 40960
    s_cmp_eq_u32 s79, 163840
    s_cselect_b32 s79, 0, s79
    s_add_u32 s83, s83, 40960
    s_cmp_eq_u32 s83, 163840
    s_cselect_b32 s83, 0, s83
    s_add_u32 s77, s77, 1
    s_cmp_lt_u32 s77, 64
    s_cbranch_scc1 L_b1_loop
    s_nop 7
    v_mul_f32 v104, v24, v128
    v_mul_f32 v108, v24, v132
    v_fma_f32 v104, -v28, v132, v104
    v_fma_f32 v108, v28, v128, v108
    v_mul_f32 v105, v25, v129
    v_mul_f32 v109, v25, v133
    v_fma_f32 v105, -v29, v133, v105
    v_fma_f32 v109, v29, v129, v109
    v_mul_f32 v106, v26, v130
    v_mul_f32 v110, v26, v134
    v_fma_f32 v106, -v30, v134, v106
    v_fma_f32 v110, v30, v130, v110
    v_mul_f32 v107, v27, v131
    v_mul_f32 v111, v27, v135
    v_fma_f32 v107, -v31, v135, v107
    v_fma_f32 v111, v31, v131, v111
    v_fmac_f32_dpp v104, v96, v184 row_ror:1 row_mask:0xf bank_mask:0xf
    v_fmac_f32_dpp v108, v100, v184 row_ror:1 row_mask:0xf bank_mask:0xf
    v_fmac_f32_dpp v104, v100, v186 row_ror:1 row_mask:0xf bank_mask:0xf
    v_fmac_f32_dpp v108, v96, v185 row_ror:1 row_mask:0xf bank_mask:0xf
    v_fmac_f32_dpp v105, v97, v187 row_ror:1 row_mask:0xf bank_mask:0xf
    v_fmac_f32_dpp v109, v101, v187 row_ror:1 row_mask:0xf bank_mask:0xf
    v_fmac_f32_dpp v105, v101, v189 row_ror:1 row_mask:0xf bank_mask:0xf
    v_fmac_f32_dpp v109, v97, v188 row_ror:1 row_mask:0xf bank_mask:0xf
    v_fmac_f32_dpp v106, v98, v190 row_ror:1 row_mask:0xf bank_mask:0xf
    v_fmac_f32_dpp v110, v102, v190 row_ror:1 row_mask:0xf bank_mask:0xf
    v_fmac_f32_dpp v106, v102, v192 row_ror:1 row_mask:0xf bank_mask:0xf
    v_fmac_f32_dpp v110, v98, v191 row_ror:1 row_mask:0xf bank_mask:0xf
    v_fmac_f32_dpp v107, v99, v193 row_ror:1 row_mask:0xf bank_mask:0xf
    v_fmac_f32_dpp v111, v103, v193 row_ror:1 row_mask:0xf bank_mask:0xf
    v_fmac_f32_dpp v107, v103, v195 row_ror:1 row_mask:0xf bank_mask:0xf
    v_fmac_f32_dpp v111, v99, v194 row_ror:1 row_mask:0xf bank_mask:0xf
    v_mov_b32_dpp v88, v104 row_shr:1 row_mask:0xf bank_mask:0xf bound_ctrl:0
    v_mov_b32_dpp v89, v105 row_shr:1 row_mask:0xf bank_mask:0xf bound_ctrl:0
    v_mov_b32_dpp v90, v106 row_shr:1 row_mask:0xf bank_mask:0xf bound_ctrl:0
    v_mov_b32_dpp v91, v107 row_shr:1 row_mask:0xf bank_mask:0xf bound_ctrl:0
    v_fmac_f32_dpp v104, v108, v138 row_shr:1 row_mask:0xf bank_mask:0xf bound_ctrl:0
    v_fmac_f32_dpp v105, v109, v141 row_shr:1 row_mask:0xf bank_mask:0xf bound_ctrl:0
    v_fmac_f32_dpp v106, v110, v144 row_shr:1 row_mask:0xf bank_mask:0xf bound_ctrl:0
    v_fmac_f32_dpp v107, v111, v147 row_shr:1 row_mask:0xf bank_mask:0xf bound_ctrl:0
    v_fmac_f32_dpp v108, v108, v136 row_shr:1 row_mask:0xf bank_mask:0xf bound_ctrl:0
    v_fmac_f32_dpp v109, v109, v139 row_shr:1 row_mask:0xf bank_mask:0xf bound_ctrl:0
    v_fmac_f32_dpp v110, v110, v142 row_shr:1 row_mask:0xf bank_mask:0xf bound_ctrl:0
    v_fmac_f32_dpp v111, v111, v145 row_shr:1 row_mask:0xf bank_mask:0xf bound_ctrl:0
    v_fmac_f32 v104, v88, v136
    v_fmac_f32 v105, v89, v139
    v_fmac_f32 v106, v90, v142
    v_fmac_f32 v107, v91, v145
    v_fmac_f32 v108, v88, v137
    v_fmac_f32 v109, v89, v140
    v_fmac_f32 v110, v90, v143
    v_fmac_f32 v111, v91, v146
    v_mov_b32_dpp v88, v104 row_shr:2 row_mask:0xf bank_mask:0xf bound_ctrl:0
    v_mov_b32_dpp v89, v105 row_shr:2 row_mask:0xf bank_mask:0xf bound_ctrl:0
    v_mov_b32_dpp v90, v106 row_shr:2 row_mask:0xf bank_mask:0xf bound_ctrl:0
    v_mov_b32_dpp v91, v107 row_shr:2 row_mask:0xf bank_mask:0xf bound_ctrl:0
    v_fmac_f32_dpp v104, v108, v150 row_shr:2 row_mask:0xf bank_mask:0xf bound_ctrl:0
    v_fmac_f32_dpp v105, v109, v153 row_shr:2 row_mask:0xf bank_mask:0xf bound_ctrl:0
    v_fmac_f32_dpp v106, v110, v156 row_shr:2 row_mask:0xf bank_mask:0xf bound_ctrl:0
    v_fmac_f32_dpp v107, v111, v159 row_shr:2 row_mask:0xf bank_mask:0xf bound_ctrl:0
    v_fmac_f32_dpp v108, v108, v148 row_shr:2 row_mask:0xf bank_mask:0xf bound_ctrl:0
    v_fmac_f32_dpp v109, v109, v151 row_shr:2 row_mask:0xf bank_mask:0xf bound_ctrl:0
    v_fmac_f32_dpp v110, v110, v154 row_shr:2 row_mask:0xf bank_mask:0xf bound_ctrl:0
    v_fmac_f32_dpp v111, v111, v157 row_shr:2 row_mask:0xf bank_mask:0xf bound_ctrl:0
    v_fmac_f32 v104, v88, v148
    v_fmac_f32 v105, v89, v151
    v_fmac_f32 v106, v90, v154
    v_fmac_f32 v107, v91, v157
    v_fmac_f32 v108, v88, v149
    v_fmac_f32 v109, v89, v152
    v_fmac_f32 v110, v90, v155
    v_fmac_f32 v111, v91, v158
    v_mov_b32_dpp v88, v104 row_shr:4 row_mask:0xf bank_mask:0xf bound_ctrl:0
    v_mov_b32_dpp v89, v105 row_shr:4 row_mask:0xf bank_mask:0xf bound_ctrl:0
    v_mov_b32_dpp v90, v106 row_shr:4 row_mask:0xf bank_mask:0xf bound_ctrl:0
    v_mov_b32_dpp v91, v107 row_shr:4 row_mask:0xf bank_mask:0xf bound_ctrl:0
    v_fmac_f32_dpp v104, v108, v162 row_shr:4 row_mask:0xf bank_mask:0xf bound_ctrl:0
    v_fmac_f32_dpp v105, v109, v165 row_shr:4 row_mask:0xf bank_mask:0xf bound_ctrl:0
    v_fmac_f32_dpp v106, v110, v168 row_shr:4 row_mask:0xf bank_mask:0xf bound_ctrl:0
    v_fmac_f32_dpp v107, v111, v171 row_shr:4 row_mask:0xf bank_mask:0xf bound_ctrl:0
    v_fmac_f32_dpp v108, v108, v160 row_shr:4 row_mask:0xf bank_mask:0xf bound_ctrl:0
    v_fmac_f32_dpp v109, v109, v163 row_shr:4 row_mask:0xf bank_mask:0xf bound_ctrl:0
    v_fmac_f32_dpp v110, v110, v166 row_shr:4 row_mask:0xf bank_mask:0xf bound_ctrl:0
    v_fmac_f32_dpp v111, v111, v169 row_shr:4 row_mask:0xf bank_mask:0xf bound_ctrl:0
    v_fmac_f32 v104, v88, v160
    v_fmac_f32 v105, v89, v163
    v_fmac_f32 v106, v90, v166
    v_fmac_f32 v107, v91, v169
    v_fmac_f32 v108, v88, v161
    v_fmac_f32 v109, v89, v164
    v_fmac_f32 v110, v90, v167
    v_fmac_f32 v111, v91, v170
    v_mov_b32_dpp v88, v104 row_shr:8 row_mask:0xf bank_mask:0xf bound_ctrl:0
    v_mov_b32_dpp v89, v105 row_shr:8 row_mask:0xf bank_mask:0xf bound_ctrl:0
    v_mov_b32_dpp v90, v106 row_shr:8 row_mask:0xf bank_mask:0xf bound_ctrl:0
    v_mov_b32_dpp v91, v107 row_shr:8 row_mask:0xf bank_mask:0xf bound_ctrl:0
    v_fmac_f32_dpp v104, v108, v174 row_shr:8 row_mask:0xf bank_mask:0xf bound_ctrl:0
    v_fmac_f32_dpp v105, v109, v177 row_shr:8 row_mask:0xf bank_mask:0xf bound_ctrl:0
    v_fmac_f32_dpp v106, v110, v180 row_shr:8 row_mask:0xf bank_mask:0xf bound_ctrl:0
    v_fmac_f32_dpp v107, v111, v183 row_shr:8 row_mask:0xf bank_mask:0xf bound_ctrl:0
    v_fmac_f32_dpp v108, v108, v172 row_shr:8 row_mask:0xf bank_mask:0xf bound_ctrl:0
    v_fmac_f32_dpp v109, v109, v175 row_shr:8 row_mask:0xf bank_mask:0xf bound_ctrl:0
    v_fmac_f32_dpp v110, v110, v178 row_shr:8 row_mask:0xf bank_mask:0xf bound_ctrl:0
    v_fmac_f32_dpp v111, v111, v181 row_shr:8 row_mask:0xf bank_mask:0xf bound_ctrl:0
    v_fmac_f32 v104, v88, v172
    v_fmac_f32 v105, v89, v175
    v_fmac_f32 v106, v90, v178
    v_fmac_f32 v107, v91, v181
    v_fmac_f32 v108, v88, v173
    v_fmac_f32 v109, v89, v176
    v_fmac_f32 v110, v90, v179
    v_fmac_f32 v111, v91, v182
    v_cvt_pk_bf16_f32 v84, v104, v105
    v_cvt_pk_bf16_f32 v85, v106, v107
    v_cvt_pk_bf16_f32 v86, -v108, -v109
    v_cvt_pk_bf16_f32 v87, -v110, -v111
    buffer_store_dwordx4 v[84:87], v6, s[4:7], s76 offen sc1
    s_mov_b32 s76, s65
    s_add_u32 s65, s65, 40960
    s_waitcnt vmcnt(0)
    s_barrier
    s_cmp_eq_u32 s24, 0
    s_cbranch_scc0 L_b1_pube
    v_mov_b32 v13, 64
    s_mov_b64 exec, 1
    buffer_store_dword v13, v10, s[4:7], 0 offen offset:0 sc1
    s_mov_b64 exec, -1
L_b1_pube:
    s_waitcnt vmcnt(0)
    s_endpgm
L_b2:
    s_cmp_ge_u32 s75, 5
    s_cselect_b32 s79, 1, 0
    s_mul_i32 s28, s79, 5
    s_sub_u32 s74, s75, s28
    s_mov_b32 s12, s60
    s_mov_b32 s13, s61
    s_mov_b32 s14, 819200
    s_mov_b32 s15, 0x20000
    s_mov_b32 s20, s62
    s_mov_b32 s21, s63
    s_mov_b32 s22, 819200
    s_mov_b32 s23, 0x20000
    s_mov_b32 s16, s50
    s_mov_b32 s17, s51
    s_mov_b32 s18, 2621440
    s_mov_b32 s19, 0x20000
    s_mov_b32 s32, s68
    s_mov_b32 s33, s69
    s_mov_b32 s34, 10485760
    s_mov_b32 s35, 0x20000
    v_and_b32 v3, 15, v1
    v_mul_u32_u24 v3, 1280, v3
    v_lshrrev_b32 v4, 4, v1
    v_lshl_add_u32 v3, v4, 4, v3
    s_mul_i32 s28, s74, 163840
    s_mul_i32 s29, s24, 320
    s_add_u32 s28, s28, s29
    v_add_u32 v3, s28, v3
    s_mov_b32 s31, 0
    buffer_load_dwordx4 v[16:19], v3, s[12:15], s31 offen offset:0
    buffer_load_dwordx4 v[20:23], v3, s[20:23], s31 offen offset:0
    buffer_load_dwordx4 v[24:27], v3, s[12:15], s31 offen offset:64
    buffer_load_dwordx4 v[28:31], v3, s[20:23], s31 offen offset:64
    buffer_load_dwordx4 v[32:35], v3, s[12:15], s31 offen offset:128
    buffer_load_dwordx4 v[36:39], v3, s[20:23], s31 offen offset:128
    buffer_load_dwordx4 v[40:43], v3, s[12:15], s31 offen offset:192
    buffer_load_dwordx4 v[44:47], v3, s[20:23], s31 offen offset:192
    buffer_load_dwordx4 v[48:51], v3, s[12:15], s31 offen offset:256
    buffer_load_dwordx4 v[52:55], v3, s[20:23], s31 offen offset:256
    s_mov_b32 s31, 20480
    buffer_load_dwordx4 v[56:59], v3, s[12:15], s31 offen offset:0
    buffer_load_dwordx4 v[60:63], v3, s[20:23], s31 offen offset:0
    buffer_load_dwordx4 v[64:67], v3, s[12:15], s31 offen offset:64
    buffer_load_dwordx4 v[68:71], v3, s[20:23], s31 offen offset:64
    buffer_load_dwordx4 v[72:75], v3, s[12:15], s31 offen offset:128
    buffer_load_dwordx4 v[76:79], v3, s[20:23], s31 offen offset:128
    buffer_load_dwordx4 v[80:83], v3, s[12:15], s31 offen offset:192
    buffer_load_dwordx4 v[84:87], v3, s[20:23], s31 offen offset:192
    buffer_load_dwordx4 v[88:91], v3, s[12:15], s31 offen offset:256
    buffer_load_dwordx4 v[92:95], v3, s[20:23], s31 offen offset:256
    s_mov_b32 s31, 40960
    buffer_load_dwordx4 v[96:99], v3, s[12:15], s31 offen offset:0
    buffer_load_dwordx4 v[100:103], v3, s[20:23], s31 offen offset:0
    buffer_load_dwordx4 v[104:107], v3, s[12:15], s31 offen offset:64
    buffer_load_dwordx4 v[108:111], v3, s[20:23], s31 offen offset:64
    buffer_load_dwordx4 v[112:115], v3, s[12:15], s31 offen offset:128
    buffer_load_dwordx4 v[116:119], v3, s[20:23], s31 offen offset:128
    buffer_load_dwordx4 v[120:123], v3, s[12:15], s31 offen offset:192
    buffer_load_dwordx4 v[124:127], v3, s[20:23], s31 offen offset:192
    buffer_load_dwordx4 v[128:131], v3, s[12:15], s31 offen offset:256
    buffer_load_dwordx4 v[132:135], v3, s[20:23], s31 offen offset:256
    s_mov_b32 s31, 61440
    buffer_load_dwordx4 v[136:139], v3, s[12:15], s31 offen offset:0
    buffer_load_dwordx4 v[140:143], v3, s[20:23], s31 offen offset:0
    buffer_load_dwordx4 v[144:147], v3, s[12:15], s31 offen offset:64
    buffer_load_dwordx4 v[148:151], v3, s[20:23], s31 offen offset:64
    buffer_load_dwordx4 v[152:155], v3, s[12:15], s31 offen offset:128
    buffer_load_dwordx4 v[156:159], v3, s[20:23], s31 offen offset:128
    buffer_load_dwordx4 v[160:163], v3, s[12:15], s31 offen offset:192
    buffer_load_dwordx4 v[164:167], v3, s[20:23], s31 offen offset:192
    buffer_load_dwordx4 v[168:171], v3, s[12:15], s31 offen offset:256
    buffer_load_dwordx4 v[172:175], v3, s[20:23], s31 offen offset:256
    s_waitcnt vmcnt(30)
    v_accvgpr_write_b32 a0, v16
    v_accvgpr_write_b32 a1, v17
    v_accvgpr_write_b32 a2, v20
    v_accvgpr_write_b32 a3, v21
    v_accvgpr_write_b32 a4, v18
    v_accvgpr_write_b32 a5, v19
    v_accvgpr_write_b32 a6, v22
    v_accvgpr_write_b32 a7, v23
    v_accvgpr_write_b32 a8, v24
    v_accvgpr_write_b32 a9, v25
    v_accvgpr_write_b32 a10, v28
    v_accvgpr_write_b32 a11, v29
    v_accvgpr_write_b32 a12, v26
    v_accvgpr_write_b32 a13, v27
    v_accvgpr_write_b32 a14, v30
    v_accvgpr_write_b32 a15, v31
    v_accvgpr_write_b32 a16, v32
    v_accvgpr_write_b32 a17, v33
    v_accvgpr_write_b32 a18, v36
    v_accvgpr_write_b32 a19, v37
    v_accvgpr_write_b32 a20, v34
    v_accvgpr_write_b32 a21, v35
    v_accvgpr_write_b32 a22, v38
    v_accvgpr_write_b32 a23, v39
    v_accvgpr_write_b32 a24, v40
    v_accvgpr_write_b32 a25, v41
    v_accvgpr_write_b32 a26, v44
    v_accvgpr_write_b32 a27, v45
    v_accvgpr_write_b32 a28, v42
    v_accvgpr_write_b32 a29, v43
    v_accvgpr_write_b32 a30, v46
    v_accvgpr_write_b32 a31, v47
    v_accvgpr_write_b32 a32, v48
    v_accvgpr_write_b32 a33, v49
    v_accvgpr_write_b32 a34, v52
    v_accvgpr_write_b32 a35, v53
    v_accvgpr_write_b32 a36, v50
    v_accvgpr_write_b32 a37, v51
    v_accvgpr_write_b32 a38, v54
    v_accvgpr_write_b32 a39, v55
    s_mov_b32 s31, 81920
    buffer_load_dwordx4 v[16:19], v3, s[12:15], s31 offen offset:0
    buffer_load_dwordx4 v[20:23], v3, s[20:23], s31 offen offset:0
    buffer_load_dwordx4 v[24:27], v3, s[12:15], s31 offen offset:64
    buffer_load_dwordx4 v[28:31], v3, s[20:23], s31 offen offset:64
    buffer_load_dwordx4 v[32:35], v3, s[12:15], s31 offen offset:128
    buffer_load_dwordx4 v[36:39], v3, s[20:23], s31 offen offset:128
    buffer_load_dwordx4 v[40:43], v3, s[12:15], s31 offen offset:192
    buffer_load_dwordx4 v[44:47], v3, s[20:23], s31 offen offset:192
    buffer_load_dwordx4 v[48:51], v3, s[12:15], s31 offen offset:256
    buffer_load_dwordx4 v[52:55], v3, s[20:23], s31 offen offset:256
    s_waitcnt vmcnt(30)
    v_accvgpr_write_b32 a40, v56
    v_accvgpr_write_b32 a41, v57
    v_accvgpr_write_b32 a42, v60
    v_accvgpr_write_b32 a43, v61
    v_accvgpr_write_b32 a44, v58
    v_accvgpr_write_b32 a45, v59
    v_accvgpr_write_b32 a46, v62
    v_accvgpr_write_b32 a47, v63
    v_accvgpr_write_b32 a48, v64
    v_accvgpr_write_b32 a49, v65
    v_accvgpr_write_b32 a50, v68
    v_accvgpr_write_b32 a51, v69
    v_accvgpr_write_b32 a52, v66
    v_accvgpr_write_b32 a53, v67
    v_accvgpr_write_b32 a54, v70
    v_accvgpr_write_b32 a55, v71
    v_accvgpr_write_b32 a56, v72
    v_accvgpr_write_b32 a57, v73
    v_accvgpr_write_b32 a58, v76
    v_accvgpr_write_b32 a59, v77
    v_accvgpr_write_b32 a60, v74
    v_accvgpr_write_b32 a61, v75
    v_accvgpr_write_b32 a62, v78
    v_accvgpr_write_b32 a63, v79
    v_accvgpr_write_b32 a64, v80
    v_accvgpr_write_b32 a65, v81
    v_accvgpr_write_b32 a66, v84
    v_accvgpr_write_b32 a67, v85
    v_accvgpr_write_b32 a68, v82
    v_accvgpr_write_b32 a69, v83
    v_accvgpr_write_b32 a70, v86
    v_accvgpr_write_b32 a71, v87
    v_accvgpr_write_b32 a72, v88
    v_accvgpr_write_b32 a73, v89
    v_accvgpr_write_b32 a74, v92
    v_accvgpr_write_b32 a75, v93
    v_accvgpr_write_b32 a76, v90
    v_accvgpr_write_b32 a77, v91
    v_accvgpr_write_b32 a78, v94
    v_accvgpr_write_b32 a79, v95
    s_mov_b32 s31, 102400
    buffer_load_dwordx4 v[56:59], v3, s[12:15], s31 offen offset:0
    buffer_load_dwordx4 v[60:63], v3, s[20:23], s31 offen offset:0
    buffer_load_dwordx4 v[64:67], v3, s[12:15], s31 offen offset:64
    buffer_load_dwordx4 v[68:71], v3, s[20:23], s31 offen offset:64
    buffer_load_dwordx4 v[72:75], v3, s[12:15], s31 offen offset:128
    buffer_load_dwordx4 v[76:79], v3, s[20:23], s31 offen offset:128
    buffer_load_dwordx4 v[80:83], v3, s[12:15], s31 offen offset:192
    buffer_load_dwordx4 v[84:87], v3, s[20:23], s31 offen offset:192
    buffer_load_dwordx4 v[88:91], v3, s[12:15], s31 offen offset:256
    buffer_load_dwordx4 v[92:95], v3, s[20:23], s31 offen offset:256
    s_waitcnt vmcnt(30)
    v_accvgpr_write_b32 a80, v96
    v_accvgpr_write_b32 a81, v97
    v_accvgpr_write_b32 a82, v100
    v_accvgpr_write_b32 a83, v101
    v_accvgpr_write_b32 a84, v98
    v_accvgpr_write_b32 a85, v99
    v_accvgpr_write_b32 a86, v102
    v_accvgpr_write_b32 a87, v103
    v_accvgpr_write_b32 a88, v104
    v_accvgpr_write_b32 a89, v105
    v_accvgpr_write_b32 a90, v108
    v_accvgpr_write_b32 a91, v109
    v_accvgpr_write_b32 a92, v106
    v_accvgpr_write_b32 a93, v107
    v_accvgpr_write_b32 a94, v110
    v_accvgpr_write_b32 a95, v111
    v_accvgpr_write_b32 a96, v112
    v_accvgpr_write_b32 a97, v113
    v_accvgpr_write_b32 a98, v116
    v_accvgpr_write_b32 a99, v117
    v_accvgpr_write_b32 a100, v114
    v_accvgpr_write_b32 a101, v115
    v_accvgpr_write_b32 a102, v118
    v_accvgpr_write_b32 a103, v119
    v_accvgpr_write_b32 a104, v120
    v_accvgpr_write_b32 a105, v121
    v_accvgpr_write_b32 a106, v124
    v_accvgpr_write_b32 a107, v125
    v_accvgpr_write_b32 a108, v122
    v_accvgpr_write_b32 a109, v123
    v_accvgpr_write_b32 a110, v126
    v_accvgpr_write_b32 a111, v127
    v_accvgpr_write_b32 a112, v128
    v_accvgpr_write_b32 a113, v129
    v_accvgpr_write_b32 a114, v132
    v_accvgpr_write_b32 a115, v133
    v_accvgpr_write_b32 a116, v130
    v_accvgpr_write_b32 a117, v131
    v_accvgpr_write_b32 a118, v134
    v_accvgpr_write_b32 a119, v135
    s_mov_b32 s31, 122880
    buffer_load_dwordx4 v[96:99], v3, s[12:15], s31 offen offset:0
    buffer_load_dwordx4 v[100:103], v3, s[20:23], s31 offen offset:0
    buffer_load_dwordx4 v[104:107], v3, s[12:15], s31 offen offset:64
    buffer_load_dwordx4 v[108:111], v3, s[20:23], s31 offen offset:64
    buffer_load_dwordx4 v[112:115], v3, s[12:15], s31 offen offset:128
    buffer_load_dwordx4 v[116:119], v3, s[20:23], s31 offen offset:128
    buffer_load_dwordx4 v[120:123], v3, s[12:15], s31 offen offset:192
    buffer_load_dwordx4 v[124:127], v3, s[20:23], s31 offen offset:192
    buffer_load_dwordx4 v[128:131], v3, s[12:15], s31 offen offset:256
    buffer_load_dwordx4 v[132:135], v3, s[20:23], s31 offen offset:256
    s_waitcnt vmcnt(30)
    v_accvgpr_write_b32 a120, v136
    v_accvgpr_write_b32 a121, v137
    v_accvgpr_write_b32 a122, v140
    v_accvgpr_write_b32 a123, v141
    v_accvgpr_write_b32 a124, v138
    v_accvgpr_write_b32 a125, v139
    v_accvgpr_write_b32 a126, v142
    v_accvgpr_write_b32 a127, v143
    v_accvgpr_write_b32 a128, v144
    v_accvgpr_write_b32 a129, v145
    v_accvgpr_write_b32 a130, v148
    v_accvgpr_write_b32 a131, v149
    v_accvgpr_write_b32 a132, v146
    v_accvgpr_write_b32 a133, v147
    v_accvgpr_write_b32 a134, v150
    v_accvgpr_write_b32 a135, v151
    v_accvgpr_write_b32 a136, v152
    v_accvgpr_write_b32 a137, v153
    v_accvgpr_write_b32 a138, v156
    v_accvgpr_write_b32 a139, v157
    v_accvgpr_write_b32 a140, v154
    v_accvgpr_write_b32 a141, v155
    v_accvgpr_write_b32 a142, v158
    v_accvgpr_write_b32 a143, v159
    v_accvgpr_write_b32 a144, v160
    v_accvgpr_write_b32 a145, v161
    v_accvgpr_write_b32 a146, v164
    v_accvgpr_write_b32 a147, v165
    v_accvgpr_write_b32 a148, v162
    v_accvgpr_write_b32 a149, v163
    v_accvgpr_write_b32 a150, v166
    v_accvgpr_write_b32 a151, v167
    v_accvgpr_write_b32 a152, v168
    v_accvgpr_write_b32 a153, v169
    v_accvgpr_write_b32 a154, v172
    v_accvgpr_write_b32 a155, v173
    v_accvgpr_write_b32 a156, v170
    v_accvgpr_write_b32 a157, v171
    v_accvgpr_write_b32 a158, v174
    v_accvgpr_write_b32 a159, v175
    s_mov_b32 s31, 143360
    buffer_load_dwordx4 v[136:139], v3, s[12:15], s31 offen offset:0
    buffer_load_dwordx4 v[140:143], v3, s[20:23], s31 offen offset:0
    buffer_load_dwordx4 v[144:147], v3, s[12:15], s31 offen offset:64
    buffer_load_dwordx4 v[148:151], v3, s[20:23], s31 offen offset:64
    buffer_load_dwordx4 v[152:155], v3, s[12:15], s31 offen offset:128
    buffer_load_dwordx4 v[156:159], v3, s[20:23], s31 offen offset:128
    buffer_load_dwordx4 v[160:163], v3, s[12:15], s31 offen offset:192
    buffer_load_dwordx4 v[164:167], v3, s[20:23], s31 offen offset:192
    buffer_load_dwordx4 v[168:171], v3, s[12:15], s31 offen offset:256
    buffer_load_dwordx4 v[172:175], v3, s[20:23], s31 offen offset:256
    s_waitcnt vmcnt(30)
    v_accvgpr_write_b32 a160, v16
    v_accvgpr_write_b32 a161, v17
    v_accvgpr_write_b32 a162, v20
    v_accvgpr_write_b32 a163, v21
    v_accvgpr_write_b32 a164, v18
    v_accvgpr_write_b32 a165, v19
    v_accvgpr_write_b32 a166, v22
    v_accvgpr_write_b32 a167, v23
    v_accvgpr_write_b32 a168, v24
    v_accvgpr_write_b32 a169, v25
    v_accvgpr_write_b32 a170, v28
    v_accvgpr_write_b32 a171, v29
    v_accvgpr_write_b32 a172, v26
    v_accvgpr_write_b32 a173, v27
    v_accvgpr_write_b32 a174, v30
    v_accvgpr_write_b32 a175, v31
    v_accvgpr_write_b32 a176, v32
    v_accvgpr_write_b32 a177, v33
    v_accvgpr_write_b32 a178, v36
    v_accvgpr_write_b32 a179, v37
    v_accvgpr_write_b32 a180, v34
    v_accvgpr_write_b32 a181, v35
    v_accvgpr_write_b32 a182, v38
    v_accvgpr_write_b32 a183, v39
    v_accvgpr_write_b32 a184, v40
    v_accvgpr_write_b32 a185, v41
    v_accvgpr_write_b32 a186, v44
    v_accvgpr_write_b32 a187, v45
    v_accvgpr_write_b32 a188, v42
    v_accvgpr_write_b32 a189, v43
    v_accvgpr_write_b32 a190, v46
    v_accvgpr_write_b32 a191, v47
    v_accvgpr_write_b32 a192, v48
    v_accvgpr_write_b32 a193, v49
    v_accvgpr_write_b32 a194, v52
    v_accvgpr_write_b32 a195, v53
    v_accvgpr_write_b32 a196, v50
    v_accvgpr_write_b32 a197, v51
    v_accvgpr_write_b32 a198, v54
    v_accvgpr_write_b32 a199, v55
    s_waitcnt vmcnt(20)
    v_accvgpr_write_b32 a200, v56
    v_accvgpr_write_b32 a201, v57
    v_accvgpr_write_b32 a202, v60
    v_accvgpr_write_b32 a203, v61
    v_accvgpr_write_b32 a204, v58
    v_accvgpr_write_b32 a205, v59
    v_accvgpr_write_b32 a206, v62
    v_accvgpr_write_b32 a207, v63
    v_accvgpr_write_b32 a208, v64
    v_accvgpr_write_b32 a209, v65
    v_accvgpr_write_b32 a210, v68
    v_accvgpr_write_b32 a211, v69
    v_accvgpr_write_b32 a212, v66
    v_accvgpr_write_b32 a213, v67
    v_accvgpr_write_b32 a214, v70
    v_accvgpr_write_b32 a215, v71
    v_accvgpr_write_b32 a216, v72
    v_accvgpr_write_b32 a217, v73
    v_accvgpr_write_b32 a218, v76
    v_accvgpr_write_b32 a219, v77
    v_accvgpr_write_b32 a220, v74
    v_accvgpr_write_b32 a221, v75
    v_accvgpr_write_b32 a222, v78
    v_accvgpr_write_b32 a223, v79
    v_accvgpr_write_b32 a224, v80
    v_accvgpr_write_b32 a225, v81
    v_accvgpr_write_b32 a226, v84
    v_accvgpr_write_b32 a227, v85
    v_accvgpr_write_b32 a228, v82
    v_accvgpr_write_b32 a229, v83
    v_accvgpr_write_b32 a230, v86
    v_accvgpr_write_b32 a231, v87
    v_accvgpr_write_b32 a232, v88
    v_accvgpr_write_b32 a233, v89
    v_accvgpr_write_b32 a234, v92
    v_accvgpr_write_b32 a235, v93
    v_accvgpr_write_b32 a236, v90
    v_accvgpr_write_b32 a237, v91
    v_accvgpr_write_b32 a238, v94
    v_accvgpr_write_b32 a239, v95
    s_waitcnt vmcnt(10)
    v_accvgpr_write_b32 a240, v96
    v_accvgpr_write_b32 a241, v97
    v_accvgpr_write_b32 a242, v100
    v_accvgpr_write_b32 a243, v101
    v_accvgpr_write_b32 a244, v98
    v_accvgpr_write_b32 a245, v99
    v_accvgpr_write_b32 a246, v102
    v_accvgpr_write_b32 a247, v103
    v_accvgpr_write_b32 a248, v104
    v_accvgpr_write_b32 a249, v105
    v_accvgpr_write_b32 a250, v108
    v_accvgpr_write_b32 a251, v109
    v_accvgpr_write_b32 a252, v106
    v_accvgpr_write_b32 a253, v107
    v_accvgpr_write_b32 a254, v110
    v_accvgpr_write_b32 a255, v111
    v_mov_b32 v192, v112
    v_mov_b32 v193, v113
    v_mov_b32 v194, v116
    v_mov_b32 v195, v117
    v_mov_b32 v196, v114
    v_mov_b32 v197, v115
    v_mov_b32 v198, v118
    v_mov_b32 v199, v119
    v_mov_b32 v200, v120
    v_mov_b32 v201, v121
    v_mov_b32 v202, v124
    v_mov_b32 v203, v125
    v_mov_b32 v204, v122
    v_mov_b32 v205, v123
    v_mov_b32 v206, v126
    v_mov_b32 v207, v127
    v_mov_b32 v208, v128
    v_mov_b32 v209, v129
    v_mov_b32 v210, v132
    v_mov_b32 v211, v133
    v_mov_b32 v212, v130
    v_mov_b32 v213, v131
    v_mov_b32 v214, v134
    v_mov_b32 v215, v135
    s_waitcnt vmcnt(0)
    v_mov_b32 v216, v136
    v_mov_b32 v217, v137
    v_mov_b32 v218, v140
    v_mov_b32 v219, v141
    v_mov_b32 v220, v138
    v_mov_b32 v221, v139
    v_mov_b32 v222, v142
    v_mov_b32 v223, v143
    v_mov_b32 v224, v144
    v_mov_b32 v225, v145
    v_mov_b32 v226, v148
    v_mov_b32 v227, v149
    v_mov_b32 v228, v146
    v_mov_b32 v229, v147
    v_mov_b32 v230, v150
    v_mov_b32 v231, v151
    v_mov_b32 v232, v152
    v_mov_b32 v233, v153
    v_mov_b32 v234, v156
    v_mov_b32 v235, v157
    v_mov_b32 v236, v154
    v_mov_b32 v237, v155
    v_mov_b32 v238, v158
    v_mov_b32 v239, v159
    v_mov_b32 v240, v160
    v_mov_b32 v241, v161
    v_mov_b32 v242, v164
    v_mov_b32 v243, v165
    v_mov_b32 v244, v162
    v_mov_b32 v245, v163
    v_mov_b32 v246, v166
    v_mov_b32 v247, v167
    v_mov_b32 v248, v168
    v_mov_b32 v249, v169
    v_mov_b32 v250, v172
    v_mov_b32 v251, v173
    v_mov_b32 v252, v170
    v_mov_b32 v253, v171
    v_mov_b32 v254, v174
    v_mov_b32 v255, v175
    s_mov_b32 s12, s66
    s_mov_b32 s13, s67
    s_mov_b32 s14, 1280
    s_mov_b32 s15, 0x20000
    s_lshl_b32 s28, s74, 7
    s_lshl_b32 s29, s24, 5
    s_add_u32 s28, s28, s29
    v_lshlrev_b32 v5, 2, v4
    v_add_u32 v5, s28, v5
    v_lshlrev_b32 v6, 1, v5
    buffer_load_dwordx2 v[16:17], v6, s[12:15], 0 offen
    buffer_load_dwordx2 v[18:19], v6, s[12:15], 0 offen offset:32
    v_and_b32 v7, 15, v1
    v_mul_u32_u24 v8, 1280, v7
    v_add_u32 v8, v8, v6
    v_mul_u32_u24 v9, 5120, v7
    v_lshl_add_u32 v9, v5, 2, v9
    v_add_u32 v9, 2560, v9
    s_mul_i32 s28, s24, 10240
    s_add_u32 s28, s28, 186646528
    v_add_u32 v3, s28, v2
    v_add_u32 v4, 4096, v3
    v_add_u32 v5, 8192, v3
    v_min_u32 v10, 9, v1
    v_lshlrev_b32 v10, 7, v10
    v_add_u32 v10, 192435200, v10
    s_lshl_b32 s28, s24, 13
    v_add_u32 v6, s28, v2
    s_lshl_b32 s28, s24, 11
    v_add_u32 v7, s28, v2
    s_waitcnt vmcnt(0)
    v_lshlrev_b32 v176, 16, v16
    v_and_b32 v177, 0xffff0000, v16
    v_lshlrev_b32 v178, 16, v17
    v_and_b32 v179, 0xffff0000, v17
    v_lshlrev_b32 v180, 16, v18
    v_and_b32 v181, 0xffff0000, v18
    v_lshlrev_b32 v182, 16, v19
    v_and_b32 v183, 0xffff0000, v19
    v_and_b32 v12, 3, v1
    v_lshlrev_b32 v12, 2, v12
    v_bfe_u32 v13, v1, 2, 1
    v_lshl_add_u32 v12, v13, 7, v12
    v_cmp_lt_u32 vcc, 7, v1
    v_mov_b32 v13, 16
    s_nop 0
    v_cndmask_b32 v12, v12, v13, vcc
L_b2_st:
    buffer_load_dword v13, v12, s[8:11], 0 offen sc1
    s_waitcnt vmcnt(0)
    v_cmp_gt_u32 vcc, 32, v13
    v_readlane_b32 s28, v13, 8
    s_cbranch_vccnz L_b2_st_no
    s_cmp_ge_u32 s28, 64
    s_cbranch_scc1 L_b2_st_ok
L_b2_st_no:
    s_sleep 4
    s_sub_u32 s27, s27, 1
    s_cbranch_scc1 L_fail
    s_branch L_b2_st
L_b2_st_ok:
    s_mov_b32 s77, s79
    s_mov_b32 s78, 0
    s_add_u32 s64, s77, 1
    s_mul_i32 s76, s77, 81920
    s_mul_i32 s80, s77, 40960
    s_mul_i32 s81, s77, 163840
    s_cmp_ge_u32 s78, s64
    s_cbranch_scc1 L_b2_w0_ok
L_b2_w0:
    buffer_load_dword v12, v10, s[4:7], 0 offen sc1
    s_waitcnt vmcnt(0)
    s_nop 1
    v_min_u32_dpp v12, v12, v12 row_shr:1 row_mask:0xf bank_mask:0xf
    s_nop 1
    v_min_u32_dpp v12, v12, v12 row_shr:2 row_mask:0xf bank_mask:0xf
    s_nop 1
    v_min_u32_dpp v12, v12, v12 row_shr:4 row_mask:0xf bank_mask:0xf
    s_nop 1
    v_min_u32_dpp v12, v12, v12 row_shr:8 row_mask:0xf bank_mask:0xf
    s_nop 1
    v_min_u32_dpp v12, v12, v12 row_bcast:15 row_mask:0xa bank_mask:0xf
    s_nop 1
    v_min_u32_dpp v12, v12, v12 row_bcast:31 row_mask:0xc bank_mask:0xf
    s_nop 0
    v_readlane_b32 s78, v12, 63
    s_nop 3
    s_cmp_ge_u32 s78, s64
    s_cbranch_scc1 L_b2_w0_ok
    s_sleep 2
    s_sub_u32 s27, s27, 1
    s_cbranch_scc1 L_fail
    s_branch L_b2_w0
L_b2_w0_ok:
    buffer_load_dwordx4 v[16:19], v3, s[4:7], s76 offen offset:0 sc1
    buffer_load_dwordx4 v[20:23], v3, s[4:7], s76 offen offset:1024 sc1
    buffer_load_dwordx4 v[24:27], v3, s[4:7], s76 offen offset:2048 sc1
    buffer_load_dwordx4 v[28:31], v3, s[4:7], s76 offen offset:3072 sc1
    buffer_load_dwordx4 v[32:35], v4, s[4:7], s76 offen offset:0 sc1
    buffer_load_dwordx4 v[36:39], v4, s[4:7], s76 offen offset:1024 sc1
    buffer_load_dwordx4 v[40:43], v4, s[4:7], s76 offen offset:2048 sc1
    buffer_load_dwordx4 v[44:47], v4, s[4:7], s76 offen offset:3072 sc1
    buffer_load_dwordx4 v[48:51], v5, s[4:7], s76 offen offset:0 sc1
    buffer_load_dwordx4 v[52:55], v5, s[4:7], s76 offen offset:1024 sc1
    s_add_u32 s76, s76, 40960
    buffer_load_dwordx2 v[96:97], v8, s[16:19], s80 offen
    buffer_load_dwordx2 v[98:99], v8, s[16:19], s80 offen offset:32
    s_add_u32 s80, s80, 20480
    buffer_load_dwordx4 v[56:59], v3, s[4:7], s76 offen offset:0 sc1
    buffer_load_dwordx4 v[60:63], v3, s[4:7], s76 offen offset:1024 sc1
    buffer_load_dwordx4 v[64:67], v3, s[4:7], s76 offen offset:2048 sc1
    buffer_load_dwordx4 v[68:71], v3, s[4:7], s76 offen offset:3072 sc1
    buffer_load_dwordx4 v[72:75], v4, s[4:7], s76 offen offset:0 sc1
    buffer_load_dwordx4 v[76:79], v4, s[4:7], s76 offen offset:1024 sc1
    buffer_load_dwordx4 v[80:83], v4, s[4:7], s76 offen offset:2048 sc1
    buffer_load_dwordx4 v[84:87], v4, s[4:7], s76 offen offset:3072 sc1
    buffer_load_dwordx4 v[88:91], v5, s[4:7], s76 offen offset:0 sc1
    buffer_load_dwordx4 v[92:95], v5, s[4:7], s76 offen offset:1024 sc1
    s_add_u32 s76, s76, 122880
    buffer_load_dwordx2 v[100:101], v8, s[16:19], s80 offen
    buffer_load_dwordx2 v[102:103], v8, s[16:19], s80 offen offset:32
    s_add_u32 s80, s80, 61440
    s_waitcnt vmcnt(0)
L_b2_loop:
    s_waitcnt vmcnt(14)
    v_mfma_f32_16x16x32_bf16 v[104:107], a[0:3], v[16:19], 0
    v_mfma_f32_16x16x32_bf16 v[108:111], a[40:43], v[16:19], 0
    v_mfma_f32_16x16x32_bf16 v[112:115], a[80:83], v[16:19], 0
    v_mfma_f32_16x16x32_bf16 v[116:119], a[120:123], v[16:19], 0
    v_mfma_f32_16x16x32_bf16 v[120:123], a[160:163], v[16:19], 0
    v_mfma_f32_16x16x32_bf16 v[124:127], a[200:203], v[16:19], 0
    v_mfma_f32_16x16x32_bf16 v[128:131], a[240:243], v[16:19], 0
    v_mfma_f32_16x16x32_bf16 v[132:135], v[216:219], v[16:19], 0
    v_mfma_f32_16x16x32_bf16 v[104:107], a[4:7], v[20:23], v[104:107]
    v_mfma_f32_16x16x32_bf16 v[108:111], a[44:47], v[20:23], v[108:111]
    v_mfma_f32_16x16x32_bf16 v[112:115], a[84:87], v[20:23], v[112:115]
    v_mfma_f32_16x16x32_bf16 v[116:119], a[124:127], v[20:23], v[116:119]
    v_mfma_f32_16x16x32_bf16 v[120:123], a[164:167], v[20:23], v[120:123]
    v_mfma_f32_16x16x32_bf16 v[124:127], a[204:207], v[20:23], v[124:127]
    v_mfma_f32_16x16x32_bf16 v[128:131], a[244:247], v[20:23], v[128:131]
    v_mfma_f32_16x16x32_bf16 v[132:135], v[220:223], v[20:23], v[132:135]
    v_mfma_f32_16x16x32_bf16 v[104:107], a[8:11], v[24:27], v[104:107]
    v_mfma_f32_16x16x32_bf16 v[108:111], a[48:51], v[24:27], v[108:111]
    v_mfma_f32_16x16x32_bf16 v[112:115], a[88:91], v[24:27], v[112:115]
    v_mfma_f32_16x16x32_bf16 v[116:119], a[128:131], v[24:27], v[116:119]
    v_mfma_f32_16x16x32_bf16 v[120:123], a[168:171], v[24:27], v[120:123]
    v_mfma_f32_16x16x32_bf16 v[124:127], a[208:211], v[24:27], v[124:127]
    v_mfma_f32_16x16x32_bf16 v[128:131], a[248:251], v[24:27], v[128:131]
    v_mfma_f32_16x16x32_bf16 v[132:135], v[224:227], v[24:27], v[132:135]
    v_mfma_f32_16x16x32_bf16 v[104:107], a[12:15], v[28:31], v[104:107]
    v_mfma_f32_16x16x32_bf16 v[108:111], a[52:55], v[28:31], v[108:111]
    v_mfma_f32_16x16x32_bf16 v[112:115], a[92:95], v[28:31], v[112:115]
    v_mfma_f32_16x16x32_bf16 v[116:119], a[132:135], v[28:31], v[116:119]
    v_mfma_f32_16x16x32_bf16 v[120:123], a[172:175], v[28:31], v[120:123]
    v_mfma_f32_16x16x32_bf16 v[124:127], a[212:215], v[28:31], v[124:127]
    v_mfma_f32_16x16x32_bf16 v[128:131], a[252:255], v[28:31], v[128:131]
    v_mfma_f32_16x16x32_bf16 v[132:135], v[228:231], v[28:31], v[132:135]
    v_mfma_f32_16x16x32_bf16 v[104:107], a[16:19], v[32:35], v[104:107]
    v_mfma_f32_16x16x32_bf16 v[108:111], a[56:59], v[32:35], v[108:111]
    v_mfma_f32_16x16x32_bf16 v[112:115], a[96:99], v[32:35], v[112:115]
    v_mfma_f32_16x16x32_bf16 v[116:119], a[136:139], v[32:35], v[116:119]
    v_mfma_f32_16x16x32_bf16 v[120:123], a[176:179], v[32:35], v[120:123]
    v_mfma_f32_16x16x32_bf16 v[124:127], a[216:219], v[32:35], v[124:127]
    v_mfma_f32_16x16x32_bf16 v[128:131], v[192:195], v[32:35], v[128:131]
    v_mfma_f32_16x16x32_bf16 v[132:135], v[232:235], v[32:35], v[132:135]
    v_mfma_f32_16x16x32_bf16 v[104:107], a[20:23], v[36:39], v[104:107]
    v_mfma_f32_16x16x32_bf16 v[108:111], a[60:63], v[36:39], v[108:111]
    v_mfma_f32_16x16x32_bf16 v[112:115], a[100:103], v[36:39], v[112:115]
    v_mfma_f32_16x16x32_bf16 v[116:119], a[140:143], v[36:39], v[116:119]
    v_mfma_f32_16x16x32_bf16 v[120:123], a[180:183], v[36:39], v[120:123]
    v_mfma_f32_16x16x32_bf16 v[124:127], a[220:223], v[36:39], v[124:127]
    v_mfma_f32_16x16x32_bf16 v[128:131], v[196:199], v[36:39], v[128:131]
    v_mfma_f32_16x16x32_bf16 v[132:135], v[236:239], v[36:39], v[132:135]
    v_mfma_f32_16x16x32_bf16 v[104:107], a[24:27], v[40:43], v[104:107]
    v_mfma_f32_16x16x32_bf16 v[108:111], a[64:67], v[40:43], v[108:111]
    v_mfma_f32_16x16x32_bf16 v[112:115], a[104:107], v[40:43], v[112:115]
    v_mfma_f32_16x16x32_bf16 v[116:119], a[144:147], v[40:43], v[116:119]
    v_mfma_f32_16x16x32_bf16 v[120:123], a[184:187], v[40:43], v[120:123]
    v_mfma_f32_16x16x32_bf16 v[124:127], a[224:227], v[40:43], v[124:127]
    v_mfma_f32_16x16x32_bf16 v[128:131], v[200:203], v[40:43], v[128:131]
    v_mfma_f32_16x16x32_bf16 v[132:135], v[240:243], v[40:43], v[132:135]
    v_mfma_f32_16x16x32_bf16 v[104:107], a[28:31], v[44:47], v[104:107]
    v_mfma_f32_16x16x32_bf16 v[108:111], a[68:71], v[44:47], v[108:111]
    v_mfma_f32_16x16x32_bf16 v[112:115], a[108:111], v[44:47], v[112:115]
    v_mfma_f32_16x16x32_bf16 v[116:119], a[148:151], v[44:47], v[116:119]
    v_mfma_f32_16x16x32_bf16 v[120:123], a[188:191], v[44:47], v[120:123]
    v_mfma_f32_16x16x32_bf16 v[124:127], a[228:231], v[44:47], v[124:127]
    v_mfma_f32_16x16x32_bf16 v[128:131], v[204:207], v[44:47], v[128:131]
    v_mfma_f32_16x16x32_bf16 v[132:135], v[244:247], v[44:47], v[132:135]
    v_mfma_f32_16x16x32_bf16 v[104:107], a[32:35], v[48:51], v[104:107]
    v_mfma_f32_16x16x32_bf16 v[108:111], a[72:75], v[48:51], v[108:111]
    v_mfma_f32_16x16x32_bf16 v[112:115], a[112:115], v[48:51], v[112:115]
    v_mfma_f32_16x16x32_bf16 v[116:119], a[152:155], v[48:51], v[116:119]
    v_mfma_f32_16x16x32_bf16 v[120:123], a[192:195], v[48:51], v[120:123]
    v_mfma_f32_16x16x32_bf16 v[124:127], a[232:235], v[48:51], v[124:127]
    v_mfma_f32_16x16x32_bf16 v[128:131], v[208:211], v[48:51], v[128:131]
    v_mfma_f32_16x16x32_bf16 v[132:135], v[248:251], v[48:51], v[132:135]
    v_mfma_f32_16x16x32_bf16 v[104:107], a[36:39], v[52:55], v[104:107]
    v_mfma_f32_16x16x32_bf16 v[108:111], a[76:79], v[52:55], v[108:111]
    v_mfma_f32_16x16x32_bf16 v[112:115], a[116:119], v[52:55], v[112:115]
    v_mfma_f32_16x16x32_bf16 v[116:119], a[156:159], v[52:55], v[116:119]
    v_mfma_f32_16x16x32_bf16 v[120:123], a[196:199], v[52:55], v[120:123]
    v_mfma_f32_16x16x32_bf16 v[124:127], a[236:239], v[52:55], v[124:127]
    v_mfma_f32_16x16x32_bf16 v[128:131], v[212:215], v[52:55], v[128:131]
    v_mfma_f32_16x16x32_bf16 v[132:135], v[252:255], v[52:55], v[132:135]
    s_add_u32 s64, s77, 3
    s_min_u32 s64, s64, 64
    s_cmp_ge_u32 s78, s64
    s_cbranch_scc1 L_b2_w_ok
L_b2_w:
    buffer_load_dword v12, v10, s[4:7], 0 offen sc1
    s_waitcnt vmcnt(0)
    s_nop 1
    v_min_u32_dpp v12, v12, v12 row_shr:1 row_mask:0xf bank_mask:0xf
    s_nop 1
    v_min_u32_dpp v12, v12, v12 row_shr:2 row_mask:0xf bank_mask:0xf
    s_nop 1
    v_min_u32_dpp v12, v12, v12 row_shr:4 row_mask:0xf bank_mask:0xf
    s_nop 1
    v_min_u32_dpp v12, v12, v12 row_shr:8 row_mask:0xf bank_mask:0xf
    s_nop 1
    v_min_u32_dpp v12, v12, v12 row_bcast:15 row_mask:0xa bank_mask:0xf
    s_nop 1
    v_min_u32_dpp v12, v12, v12 row_bcast:31 row_mask:0xc bank_mask:0xf
    s_nop 0
    v_readlane_b32 s78, v12, 63
    s_nop 3
    s_cmp_ge_u32 s78, s64
    s_cbranch_scc1 L_b2_w_ok
    s_sleep 2
    s_sub_u32 s27, s27, 1
    s_cbranch_scc1 L_fail
    s_branch L_b2_w
L_b2_w_ok:
    buffer_load_dwordx4 v[16:19], v3, s[4:7], s76 offen offset:0 sc1
    buffer_load_dwordx4 v[20:23], v3, s[4:7], s76 offen offset:1024 sc1
    buffer_load_dwordx4 v[24:27], v3, s[4:7], s76 offen offset:2048 sc1
    buffer_load_dwordx4 v[28:31], v3, s[4:7], s76 offen offset:3072 sc1
    buffer_load_dwordx4 v[32:35], v4, s[4:7], s76 offen offset:0 sc1
    buffer_load_dwordx4 v[36:39], v4, s[4:7], s76 offen offset:1024 sc1
    buffer_load_dwordx4 v[40:43], v4, s[4:7], s76 offen offset:2048 sc1
    buffer_load_dwordx4 v[44:47], v4, s[4:7], s76 offen offset:3072 sc1
    buffer_load_dwordx4 v[48:51], v5, s[4:7], s76 offen offset:0 sc1
    buffer_load_dwordx4 v[52:55], v5, s[4:7], s76 offen offset:1024 sc1
    s_add_u32 s76, s76, 40960
    s_nop 1
    ds_write_b128 v6, v[104:107] offset:0
    ds_write_b128 v6, v[108:111] offset:1024
    ds_write_b128 v6, v[112:115] offset:2048
    ds_write_b128 v6, v[116:119] offset:3072
    ds_write_b128 v6, v[120:123] offset:4096
    ds_write_b128 v6, v[124:127] offset:5120
    ds_write_b128 v6, v[128:131] offset:6144
    s_nop 1
    ds_write_b128 v6, v[132:135] offset:7168
    s_waitcnt lgkmcnt(0)
    s_barrier
    ds_read_b128 v[136:139], v7 offset:0
    ds_read_b128 v[140:143], v7 offset:1024
    ds_read_b128 v[144:147], v7 offset:8192
    ds_read_b128 v[148:151], v7 offset:9216
    ds_read_b128 v[152:155], v7 offset:16384
    ds_read_b128 v[156:159], v7 offset:17408
    ds_read_b128 v[160:163], v7 offset:24576
    ds_read_b128 v[164:167], v7 offset:25600
    v_lshlrev_b32 v168, 16, v96
    v_and_b32 v169, 0xffff0000, v96
    v_lshlrev_b32 v170, 16, v97
    v_and_b32 v171, 0xffff0000, v97
    v_lshlrev_b32 v172, 16, v98
    v_and_b32 v173, 0xffff0000, v98
    v_lshlrev_b32 v174, 16, v99
    v_and_b32 v175, 0xffff0000, v99
    v_mul_f32 v168, v168, v176
    v_mul_f32 v169, v169, v177
    v_mul_f32 v170, v170, v178
    v_mul_f32 v171, v171, v179
    v_mul_f32 v172, v172, v180
    v_mul_f32 v173, v173, v181
    v_mul_f32 v174, v174, v182
    v_mul_f32 v175, v175, v183
    v_cvt_pk_bf16_f32 v184, v168, v169
    v_cvt_pk_bf16_f32 v185, v170, v171
    v_cvt_pk_bf16_f32 v186, v172, v173
    v_cvt_pk_bf16_f32 v187, v174, v175
    v_lshlrev_b32 v168, 16, v184
    v_and_b32 v169, 0xffff0000, v184
    v_lshlrev_b32 v170, 16, v185
    v_and_b32 v171, 0xffff0000, v185
    v_lshlrev_b32 v172, 16, v186
    v_and_b32 v173, 0xffff0000, v186
    v_lshlrev_b32 v174, 16, v187
    v_and_b32 v175, 0xffff0000, v187
    s_waitcnt lgkmcnt(0)
    v_add_f32 v136, v136, v144
    v_add_f32 v152, v152, v160
    v_add_f32 v137, v137, v145
    v_add_f32 v153, v153, v161
    v_add_f32 v138, v138, v146
    v_add_f32 v154, v154, v162
    v_add_f32 v139, v139, v147
    v_add_f32 v155, v155, v163
    v_add_f32 v140, v140, v148
    v_add_f32 v156, v156, v164
    v_add_f32 v141, v141, v149
    v_add_f32 v157, v157, v165
    v_add_f32 v142, v142, v150
    v_add_f32 v158, v158, v166
    v_add_f32 v143, v143, v151
    v_add_f32 v159, v159, v167
    v_add_f32 v136, v136, v152
    v_add_f32 v136, v136, v168
    v_add_f32 v137, v137, v153
    v_add_f32 v137, v137, v169
    v_add_f32 v138, v138, v154
    v_add_f32 v138, v138, v170
    v_add_f32 v139, v139, v155
    v_add_f32 v139, v139, v171
    v_add_f32 v140, v140, v156
    v_add_f32 v140, v140, v172
    v_add_f32 v141, v141, v157
    v_add_f32 v141, v141, v173
    v_add_f32 v142, v142, v158
    v_add_f32 v142, v142, v174
    v_add_f32 v143, v143, v159
    v_add_f32 v143, v143, v175
    buffer_store_dwordx4 v[136:139], v9, s[32:35], s81 offen
    buffer_store_dwordx4 v[140:143], v9, s[32:35], s81 offen offset:64
    s_add_u32 s81, s81, 81920
    buffer_load_dwordx2 v[96:97], v8, s[16:19], s80 offen
    buffer_load_dwordx2 v[98:99], v8, s[16:19], s80 offen offset:32
    s_add_u32 s80, s80, 20480
    s_waitcnt vmcnt(14)
    v_mfma_f32_16x16x32_bf16 v[104:107], a[0:3], v[56:59], 0
    v_mfma_f32_16x16x32_bf16 v[108:111], a[40:43], v[56:59], 0
    v_mfma_f32_16x16x32_bf16 v[112:115], a[80:83], v[56:59], 0
    v_mfma_f32_16x16x32_bf16 v[116:119], a[120:123], v[56:59], 0
    v_mfma_f32_16x16x32_bf16 v[120:123], a[160:163], v[56:59], 0
    v_mfma_f32_16x16x32_bf16 v[124:127], a[200:203], v[56:59], 0
    v_mfma_f32_16x16x32_bf16 v[128:131], a[240:243], v[56:59], 0
    v_mfma_f32_16x16x32_bf16 v[132:135], v[216:219], v[56:59], 0
    v_mfma_f32_16x16x32_bf16 v[104:107], a[4:7], v[60:63], v[104:107]
    v_mfma_f32_16x16x32_bf16 v[108:111], a[44:47], v[60:63], v[108:111]
    v_mfma_f32_16x16x32_bf16 v[112:115], a[84:87], v[60:63], v[112:115]
    v_mfma_f32_16x16x32_bf16 v[116:119], a[124:127], v[60:63], v[116:119]
    v_mfma_f32_16x16x32_bf16 v[120:123], a[164:167], v[60:63], v[120:123]
    v_mfma_f32_16x16x32_bf16 v[124:127], a[204:207], v[60:63], v[124:127]
    v_mfma_f32_16x16x32_bf16 v[128:131], a[244:247], v[60:63], v[128:131]
    v_mfma_f32_16x16x32_bf16 v[132:135], v[220:223], v[60:63], v[132:135]
    v_mfma_f32_16x16x32_bf16 v[104:107], a[8:11], v[64:67], v[104:107]
    v_mfma_f32_16x16x32_bf16 v[108:111], a[48:51], v[64:67], v[108:111]
    v_mfma_f32_16x16x32_bf16 v[112:115], a[88:91], v[64:67], v[112:115]
    v_mfma_f32_16x16x32_bf16 v[116:119], a[128:131], v[64:67], v[116:119]
    v_mfma_f32_16x16x32_bf16 v[120:123], a[168:171], v[64:67], v[120:123]
    v_mfma_f32_16x16x32_bf16 v[124:127], a[208:211], v[64:67], v[124:127]
    v_mfma_f32_16x16x32_bf16 v[128:131], a[248:251], v[64:67], v[128:131]
    v_mfma_f32_16x16x32_bf16 v[132:135], v[224:227], v[64:67], v[132:135]
    v_mfma_f32_16x16x32_bf16 v[104:107], a[12:15], v[68:71], v[104:107]
    v_mfma_f32_16x16x32_bf16 v[108:111], a[52:55], v[68:71], v[108:111]
    v_mfma_f32_16x16x32_bf16 v[112:115], a[92:95], v[68:71], v[112:115]
    v_mfma_f32_16x16x32_bf16 v[116:119], a[132:135], v[68:71], v[116:119]
    v_mfma_f32_16x16x32_bf16 v[120:123], a[172:175], v[68:71], v[120:123]
    v_mfma_f32_16x16x32_bf16 v[124:127], a[212:215], v[68:71], v[124:127]
    v_mfma_f32_16x16x32_bf16 v[128:131], a[252:255], v[68:71], v[128:131]
    v_mfma_f32_16x16x32_bf16 v[132:135], v[228:231], v[68:71], v[132:135]
    v_mfma_f32_16x16x32_bf16 v[104:107], a[16:19], v[72:75], v[104:107]
    v_mfma_f32_16x16x32_bf16 v[108:111], a[56:59], v[72:75], v[108:111]
    v_mfma_f32_16x16x32_bf16 v[112:115], a[96:99], v[72:75], v[112:115]
    v_mfma_f32_16x16x32_bf16 v[116:119], a[136:139], v[72:75], v[116:119]
    v_mfma_f32_16x16x32_bf16 v[120:123], a[176:179], v[72:75], v[120:123]
    v_mfma_f32_16x16x32_bf16 v[124:127], a[216:219], v[72:75], v[124:127]
    v_mfma_f32_16x16x32_bf16 v[128:131], v[192:195], v[72:75], v[128:131]
    v_mfma_f32_16x16x32_bf16 v[132:135], v[232:235], v[72:75], v[132:135]
    v_mfma_f32_16x16x32_bf16 v[104:107], a[20:23], v[76:79], v[104:107]
    v_mfma_f32_16x16x32_bf16 v[108:111], a[60:63], v[76:79], v[108:111]
    v_mfma_f32_16x16x32_bf16 v[112:115], a[100:103], v[76:79], v[112:115]
    v_mfma_f32_16x16x32_bf16 v[116:119], a[140:143], v[76:79], v[116:119]
    v_mfma_f32_16x16x32_bf16 v[120:123], a[180:183], v[76:79], v[120:123]
    v_mfma_f32_16x16x32_bf16 v[124:127], a[220:223], v[76:79], v[124:127]
    v_mfma_f32_16x16x32_bf16 v[128:131], v[196:199], v[76:79], v[128:131]
    v_mfma_f32_16x16x32_bf16 v[132:135], v[236:239], v[76:79], v[132:135]
    v_mfma_f32_16x16x32_bf16 v[104:107], a[24:27], v[80:83], v[104:107]
    v_mfma_f32_16x16x32_bf16 v[108:111], a[64:67], v[80:83], v[108:111]
    v_mfma_f32_16x16x32_bf16 v[112:115], a[104:107], v[80:83], v[112:115]
    v_mfma_f32_16x16x32_bf16 v[116:119], a[144:147], v[80:83], v[116:119]
    v_mfma_f32_16x16x32_bf16 v[120:123], a[184:187], v[80:83], v[120:123]
    v_mfma_f32_16x16x32_bf16 v[124:127], a[224:227], v[80:83], v[124:127]
    v_mfma_f32_16x16x32_bf16 v[128:131], v[200:203], v[80:83], v[128:131]
    v_mfma_f32_16x16x32_bf16 v[132:135], v[240:243], v[80:83], v[132:135]
    v_mfma_f32_16x16x32_bf16 v[104:107], a[28:31], v[84:87], v[104:107]
    v_mfma_f32_16x16x32_bf16 v[108:111], a[68:71], v[84:87], v[108:111]
    v_mfma_f32_16x16x32_bf16 v[112:115], a[108:111], v[84:87], v[112:115]
    v_mfma_f32_16x16x32_bf16 v[116:119], a[148:151], v[84:87], v[116:119]
    v_mfma_f32_16x16x32_bf16 v[120:123], a[188:191], v[84:87], v[120:123]
    v_mfma_f32_16x16x32_bf16 v[124:127], a[228:231], v[84:87], v[124:127]
    v_mfma_f32_16x16x32_bf16 v[128:131], v[204:207], v[84:87], v[128:131]
    v_mfma_f32_16x16x32_bf16 v[132:135], v[244:247], v[84:87], v[132:135]
    v_mfma_f32_16x16x32_bf16 v[104:107], a[32:35], v[88:91], v[104:107]
    v_mfma_f32_16x16x32_bf16 v[108:111], a[72:75], v[88:91], v[108:111]
    v_mfma_f32_16x16x32_bf16 v[112:115], a[112:115], v[88:91], v[112:115]
    v_mfma_f32_16x16x32_bf16 v[116:119], a[152:155], v[88:91], v[116:119]
    v_mfma_f32_16x16x32_bf16 v[120:123], a[192:195], v[88:91], v[120:123]
    v_mfma_f32_16x16x32_bf16 v[124:127], a[232:235], v[88:91], v[124:127]
    v_mfma_f32_16x16x32_bf16 v[128:131], v[208:211], v[88:91], v[128:131]
    v_mfma_f32_16x16x32_bf16 v[132:135], v[248:251], v[88:91], v[132:135]
    v_mfma_f32_16x16x32_bf16 v[104:107], a[36:39], v[92:95], v[104:107]
    v_mfma_f32_16x16x32_bf16 v[108:111], a[76:79], v[92:95], v[108:111]
    v_mfma_f32_16x16x32_bf16 v[112:115], a[116:119], v[92:95], v[112:115]
    v_mfma_f32_16x16x32_bf16 v[116:119], a[156:159], v[92:95], v[116:119]
    v_mfma_f32_16x16x32_bf16 v[120:123], a[196:199], v[92:95], v[120:123]
    v_mfma_f32_16x16x32_bf16 v[124:127], a[236:239], v[92:95], v[124:127]
    v_mfma_f32_16x16x32_bf16 v[128:131], v[212:215], v[92:95], v[128:131]
    v_mfma_f32_16x16x32_bf16 v[132:135], v[252:255], v[92:95], v[132:135]
    buffer_load_dwordx4 v[56:59], v3, s[4:7], s76 offen offset:0 sc1
    buffer_load_dwordx4 v[60:63], v3, s[4:7], s76 offen offset:1024 sc1
    buffer_load_dwordx4 v[64:67], v3, s[4:7], s76 offen offset:2048 sc1
    buffer_load_dwordx4 v[68:71], v3, s[4:7], s76 offen offset:3072 sc1
    buffer_load_dwordx4 v[72:75], v4, s[4:7], s76 offen offset:0 sc1
    buffer_load_dwordx4 v[76:79], v4, s[4:7], s76 offen offset:1024 sc1
    buffer_load_dwordx4 v[80:83], v4, s[4:7], s76 offen offset:2048 sc1
    buffer_load_dwordx4 v[84:87], v4, s[4:7], s76 offen offset:3072 sc1
    buffer_load_dwordx4 v[88:91], v5, s[4:7], s76 offen offset:0 sc1
    buffer_load_dwordx4 v[92:95], v5, s[4:7], s76 offen offset:1024 sc1
    s_add_u32 s76, s76, 122880
    s_nop 1
    ds_write_b128 v6, v[104:107] offset:32768
    ds_write_b128 v6, v[108:111] offset:33792
    ds_write_b128 v6, v[112:115] offset:34816
    ds_write_b128 v6, v[116:119] offset:35840
    ds_write_b128 v6, v[120:123] offset:36864
    ds_write_b128 v6, v[124:127] offset:37888
    ds_write_b128 v6, v[128:131] offset:38912
    s_nop 1
    ds_write_b128 v6, v[132:135] offset:39936
    s_waitcnt lgkmcnt(0)
    s_barrier
    ds_read_b128 v[136:139], v7 offset:32768
    ds_read_b128 v[140:143], v7 offset:33792
    ds_read_b128 v[144:147], v7 offset:40960
    ds_read_b128 v[148:151], v7 offset:41984
    ds_read_b128 v[152:155], v7 offset:49152
    ds_read_b128 v[156:159], v7 offset:50176
    ds_read_b128 v[160:163], v7 offset:57344
    ds_read_b128 v[164:167], v7 offset:58368
    v_lshlrev_b32 v168, 16, v100
    v_and_b32 v169, 0xffff0000, v100
    v_lshlrev_b32 v170, 16, v101
    v_and_b32 v171, 0xffff0000, v101
    v_lshlrev_b32 v172, 16, v102
    v_and_b32 v173, 0xffff0000, v102
    v_lshlrev_b32 v174, 16, v103
    v_and_b32 v175, 0xffff0000, v103
    v_mul_f32 v168, v168, v176
    v_mul_f32 v169, v169, v177
    v_mul_f32 v170, v170, v178
    v_mul_f32 v171, v171, v179
    v_mul_f32 v172, v172, v180
    v_mul_f32 v173, v173, v181
    v_mul_f32 v174, v174, v182
    v_mul_f32 v175, v175, v183
    v_cvt_pk_bf16_f32 v184, v168, v169
    v_cvt_pk_bf16_f32 v185, v170, v171
    v_cvt_pk_bf16_f32 v186, v172, v173
    v_cvt_pk_bf16_f32 v187, v174, v175
    v_lshlrev_b32 v168, 16, v184
    v_and_b32 v169, 0xffff0000, v184
    v_lshlrev_b32 v170, 16, v185
    v_and_b32 v171, 0xffff0000, v185
    v_lshlrev_b32 v172, 16, v186
    v_and_b32 v173, 0xffff0000, v186
    v_lshlrev_b32 v174, 16, v187
    v_and_b32 v175, 0xffff0000, v187
    s_waitcnt lgkmcnt(0)
    v_add_f32 v136, v136, v144
    v_add_f32 v152, v152, v160
    v_add_f32 v137, v137, v145
    v_add_f32 v153, v153, v161
    v_add_f32 v138, v138, v146
    v_add_f32 v154, v154, v162
    v_add_f32 v139, v139, v147
    v_add_f32 v155, v155, v163
    v_add_f32 v140, v140, v148
    v_add_f32 v156, v156, v164
    v_add_f32 v141, v141, v149
    v_add_f32 v157, v157, v165
    v_add_f32 v142, v142, v150
    v_add_f32 v158, v158, v166
    v_add_f32 v143, v143, v151
    v_add_f32 v159, v159, v167
    v_add_f32 v136, v136, v152
    v_add_f32 v136, v136, v168
    v_add_f32 v137, v137, v153
    v_add_f32 v137, v137, v169
    v_add_f32 v138, v138, v154
    v_add_f32 v138, v138, v170
    v_add_f32 v139, v139, v155
    v_add_f32 v139, v139, v171
    v_add_f32 v140, v140, v156
    v_add_f32 v140, v140, v172
    v_add_f32 v141, v141, v157
    v_add_f32 v141, v141, v173
    v_add_f32 v142, v142, v158
    v_add_f32 v142, v142, v174
    v_add_f32 v143, v143, v159
    v_add_f32 v143, v143, v175
    buffer_store_dwordx4 v[136:139], v9, s[32:35], s81 offen
    buffer_store_dwordx4 v[140:143], v9, s[32:35], s81 offen offset:64
    s_add_u32 s81, s81, 245760
    buffer_load_dwordx2 v[100:101], v8, s[16:19], s80 offen
    buffer_load_dwordx2 v[102:103], v8, s[16:19], s80 offen offset:32
    s_add_u32 s80, s80, 61440
    s_add_u32 s77, s77, 2
    s_cmp_lt_u32 s77, 64
    s_cbranch_scc1 L_b2_loop
    s_waitcnt vmcnt(0)
    s_endpgm
L_fail:
    s_mov_b64 exec, 1
    v_mov_b32 v4, 24
    v_mov_b32 v5, 1
    buffer_atomic_add v5, v4, s[8:11], 0 offen
    s_waitcnt vmcnt(0)
L_exit:
    s_endpgm
L_code_end:
.section .rodata,"a"
.p2align 6
.amdhsa_kernel concat_heads__memory_aug_recurrent_mem_tr__ssm_conv_s5__prompt_kernel
  .amdhsa_next_free_vgpr 512
  .amdhsa_next_free_sgpr 102
  .amdhsa_accum_offset 256
  .amdhsa_group_segment_fixed_size 0
  .amdhsa_kernarg_size 152
  .amdhsa_user_sgpr_count 2
  .amdhsa_user_sgpr_kernarg_segment_ptr 1
  .amdhsa_system_sgpr_workgroup_id_x 1
  .amdhsa_float_denorm_mode_32 3
  .amdhsa_float_denorm_mode_16_64 3
.end_amdhsa_kernel
```
